```python
import torch

def _softmax(x, axis=-1):
    return torch.softmax(x, dim=axis)
def _gelu(x):
    return torch.nn.functional.gelu(x, approximate="tanh")
def _silu(x):
    return torch.nn.functional.silu(x)
def _sigmoid(x):
    return torch.sigmoid(x)
def _layernorm(x, axis=-1, eps=1e-5):
    m = x.mean(dim=axis, keepdim=True)
    v = x.var(dim=axis, keepdim=True, unbiased=False)
    return (x - m) / torch.sqrt(v + eps)
def _scatter_add(tgt, idx, src, axis=0):
    return tgt.clone().index_add_(axis, idx, src)
def _segment_sum(src, seg, n):
    out = torch.zeros((n,) + src.shape[1:], dtype=src.dtype)
    return out.index_add_(0, seg, src)
def _pad(x, pw):
    flat = tuple(v for pair in reversed(pw) for v in pair)
    return torch.nn.functional.pad(x, flat)

kernel_name = 'interleave_layers__linear_attn_block__mixer_channel_mlp__prompt'

def setup_inputs():

    _w = (lambda a: (lambda t: t.to(torch.bfloat16) if t.is_floating_point() else t)(torch.as_tensor(a)))
    def _A_setup():
        B, S, D = 1, 2048, 448
        return {
            "x": _w((lambda *s: torch.randn(*s, dtype=torch.bfloat16) * 0.05)(B, S, D)),
            "wqkv": _w((lambda *s: torch.randn(*s, dtype=torch.bfloat16) * 0.1)(D, 3 * D)),
            "wo": _w((lambda *s: torch.randn(*s, dtype=torch.bfloat16) * 0.05)(D, D)),
        }
    _A_in = _A_setup()

    def _B_setup():
        B, S, D, F = 1, 2048, 448, 1792
        return {
            "x": _w((lambda *s: torch.randn(*s, dtype=torch.bfloat16) * 0.05)(B, S, D)),
            "w1": _w((lambda *s: torch.randn(*s, dtype=torch.bfloat16) * 3.2)(D, F) * (D ** -0.5)),
            "b1": _w((lambda *s: torch.randn(*s, dtype=torch.bfloat16) * 0.8)(F)),
            "w2": _w((lambda *s: torch.randn(*s, dtype=torch.bfloat16) * 0.8)(F, D) * (F ** -0.5)),
            "b2": _w((lambda *s: torch.randn(*s, dtype=torch.bfloat16) * 0.8)(D)),
        }
    _B_in = _B_setup()

    return {
        "A_x": _A_in["x"],
        "A_wqkv": _A_in["wqkv"],
        "A_wo": _A_in["wo"],
        "B_x": _B_in["x"],
        "B_w1": _B_in["w1"],
        "B_b1": _B_in["b1"],
        "B_w2": _B_in["w2"],
        "B_b2": _B_in["b2"],
    }

def reference(A_x, A_wqkv, A_wo, B_x, B_w1, B_b1, B_w2, B_b2):
    def _A_ref(x, wqkv, wo):
        B, S, D = x.shape
        H = 16; Dh = D // H
        qkv = (lambda x, *d: x.permute(*d))((x @ wqkv).reshape(B, S, 3, H, Dh), 2, 0, 3, 1, 4)
        q, k, v = qkv[0], qkv[1], qkv[2]
        phi = lambda t: torch.where(t > 0, t + 1, torch.exp(t)) + 1e-6
        pq, pk = phi(q), phi(k)
        kv = torch.einsum("bhsd,bhse->bhde", pk, v)
        z = torch.einsum("bhsd->bhd", pk)
        num = torch.einsum("bhqd,bhde->bhqe", pq, kv)
        den = torch.einsum("bhqd,bhd->bhq", pq, z)[..., None] + 1e-6
        o = num / den
        return (lambda x, *d: x.permute(*d))(o, 0, 2, 1, 3).reshape(B, S, D) @ wo

    def _B_ref(x, w1, b1, w2, b2):
        y = _layernorm(x, axis=-1)
        h = _gelu(torch.einsum("bsd,df->bsf", y, w1) + b1)
        return torch.einsum("bsf,fd->bsd", h, w2) + b2

    x = A_x
    x = x + _A_ref(_layernorm(x, axis=-1), A_wqkv, A_wo)
    x = x + _B_ref(_layernorm(x, axis=-1), B_w1, B_b1, B_w2, B_b2)
    x = x + _A_ref(_layernorm(x, axis=-1), A_wqkv, A_wo)
    x = x + _B_ref(_layernorm(x, axis=-1), B_w1, B_b1, B_w2, B_b2)
    return x
```

```asm
; @launch grid=(256,1,1) block=(256,1,1) lds=163840
.amdgcn_target "amdgcn-amd-amdhsa--gfx950"
.text
.globl interleave_layers__linear_attn_block__mixer_channel_mlp__prompt_kernel
.p2align 8
.type interleave_layers__linear_attn_block__mixer_channel_mlp__prompt_kernel,@function
interleave_layers__linear_attn_block__mixer_channel_mlp__prompt_kernel:
    s_cmp_ge_u32 s2, 256
    s_cbranch_scc1 L_end
    s_load_dwordx16 s[68:83], s[0:1], 0
    s_load_dwordx4 s[84:87], s[0:1], 64
    s_load_dwordx2 s[88:89], s[0:1], 80
    v_lshrrev_b32 v11, 6, v0
    v_and_b32 v0, 63, v0
    v_readfirstlane_b32 s46, v11
    s_lshr_b32 s45, s2, 3
    s_lshl_b32 s59, s45, 2
    s_add_u32 s59, s59, s46
    s_getpc_b64 s[92:93]
L_pc:
    s_lshl_b32 s51, s59, 9
    v_lshlrev_b32 v11, 7, v0
    v_add_u32 v11, s51, v11
    v_min_u32 v11, L_code_end-L_pc-4, v11
    s_mov_b64 exec, 15
    global_load_dword v2, v11, s[92:93]
    s_mov_b64 exec, -1
    s_and_b32 s44, s2, 7
    s_lshr_b32 s51, s45, 4
    s_lshl_b32 s51, s51, 3
    s_add_u32 s44, s44, s51
    s_and_b32 s45, s45, 15
    v_lshlrev_b32 v1, 4, v0
    s_lshl_b32 s49, s44, 2
    s_add_u32 s49, s49, s46
    s_mul_i32 s49, s49, 28672
    v_lshrrev_b32 v164, 5, v0
    v_and_b32 v11, 31, v0
    v_xor_b32 v163, v11, v164
    v_lshlrev_b32 v163, 4, v163
    v_mul_u32_u24 v164, 896, v164
    s_lshl_b32 s56, s46, 14
    s_add_u32 s56, s56, 86016
    s_waitcnt lgkmcnt(0)
    s_mov_b32 s20, s68
    s_mov_b32 s21, s69
    s_mov_b32 s22, 1835008
    s_mov_b32 s23, 0x20000
    s_mov_b32 s4, s70
    s_mov_b32 s5, s71
    s_mov_b32 s6, 1204224
    s_mov_b32 s7, 0x20000
    v_lshlrev_b32 v165, 7, v0
    s_lshl_b32 s51, s45, 2
    s_add_u32 s51, s51, s46
    s_mul_i32 s51, s51, 1792
    s_mul_i32 s52, s44, 114688
    s_add_u32 s51, s51, s52
    s_mul_i32 s52, s59, 49
    v_add_u32 v11, s52, v0
    v_mul_u32_u24 v166, 37450, v11
    v_lshrrev_b32 v166, 19, v166
    v_mul_u32_u24 v166, 896, v166
    v_lshl_add_u32 v166, v11, 7, v166
    s_mov_b64 exec, 0x3fff
    buffer_load_dword v2, v165, s[20:23], s51 offen
    s_mov_b32 exec_lo, -1
    s_mov_b32 exec_hi, 0x1ffff
    buffer_load_dword v2, v166, s[4:7], 0 offen offset:896
    s_mov_b64 exec, -1
    s_mov_b32 s53, 0
L_xa:
    s_add_u32 s55, s45, s53
    s_and_b32 s55, s55, 15
    s_lshl_b32 s51, s55, 5
    s_and_b32 s51, s51, 0xf0
    v_xad_u32 v165, v163, s51, v164
    s_mul_i32 s52, s55, 1792
    s_add_u32 s52, s52, s49
    s_lshl_b32 s55, s55, 10
    s_add_u32 m0, s55, s56
    s_add_u32 s53, s53, 1
    s_cmp_lt_u32 s53, 16
    buffer_load_dwordx4 v165, s[20:23], s52 offen lds
    s_cbranch_scc1 L_xa
    s_load_dword s47, s[88:89], 0
    s_mov_b32 s24, s84
    s_mov_b32 s25, s85
    s_mov_b32 s26, 1835008
    s_mov_b32 s27, 0x20000
    s_mul_i32 s87, s45, 56
    s_add_u32 s86, s87, 896
    v_lshrrev_b32 v160, 3, v0
    v_mul_u32_u24 v160, 2688, v160
    v_and_b32 v11, 3, v0
    v_lshl_add_u32 v160, v11, 4, v160
    v_lshrrev_b32 v11, 2, v0
    v_xor_b32 v11, v11, v0
    v_bfe_u32 v11, v11, 2, 1
    v_mul_u32_u24 v11, 896, v11
    v_add3_u32 v160, v160, v11, s86
    s_mul_i32 s85, s46, 21504
    s_lshl_b32 s87, s46, 10
    s_add_u32 m0, s87, 0
    s_add_u32 s86, s85, 0
    buffer_load_dwordx4 v160, s[4:7], s86 offen lds
    s_add_u32 m0, s87, 4096
    s_add_u32 s86, s85, 86016
    buffer_load_dwordx4 v160, s[4:7], s86 offen lds
    s_add_u32 m0, s87, 8192
    s_add_u32 s86, s85, 172032
    buffer_load_dwordx4 v160, s[4:7], s86 offen lds
    s_add_u32 m0, s87, 12288
    s_add_u32 s86, s85, 258048
    buffer_load_dwordx4 v160, s[4:7], s86 offen lds
    s_add_u32 m0, s87, 16384
    s_add_u32 s86, s85, 344064
    buffer_load_dwordx4 v160, s[4:7], s86 offen lds
    s_add_u32 m0, s87, 20480
    s_add_u32 s86, s85, 430080
    buffer_load_dwordx4 v160, s[4:7], s86 offen lds
    s_add_u32 m0, s87, 24576
    s_add_u32 s86, s85, 516096
    buffer_load_dwordx4 v160, s[4:7], s86 offen lds
    s_add_u32 m0, s87, 28672
    s_add_u32 s86, s85, 602112
    buffer_load_dwordx4 v160, s[4:7], s86 offen lds
    s_mov_b32 s8, s72
    s_mov_b32 s9, s73
    s_mov_b32 s10, 401408
    s_mov_b32 s11, 0x20000
    s_mov_b32 s12, s76
    s_mov_b32 s13, s77
    s_mov_b32 s14, 1605632
    s_mov_b32 s15, 0x20000
    s_mov_b32 s28, s78
    s_mov_b32 s29, s79
    s_mov_b32 s30, 3584
    s_mov_b32 s31, 0x20000
    s_mov_b32 s16, s80
    s_mov_b32 s17, s81
    s_mov_b32 s18, 1605632
    s_mov_b32 s19, 0x20000
    s_mov_b32 s32, s82
    s_mov_b32 s33, s83
    s_mov_b32 s34, 896
    s_mov_b32 s35, 0x20000
    s_mov_b32 s40, s88
    s_mov_b32 s41, s89
    s_mov_b32 s42, 4194304
    s_mov_b32 s43, 0x20000
    s_lshl_b32 s51, s44, 21
    s_add_u32 s51, s51, 4194304
    s_add_u32 s36, s88, s51
    s_addc_u32 s37, s89, 0
    s_mov_b32 s38, 0x200000
    s_mov_b32 s39, 0x20000
    s_mov_b32 s57, 0x3f317218
    s_mov_b32 s62, 0
    s_mov_b32 s63, -1
    s_mov_b32 s60, 0x10000000
    s_mov_b32 s61, 0x10000000
    s_mov_b32 s50, 0
    s_getreg_b32 s58, hwreg(HW_REG_XCC_ID, 0, 4)
    s_and_b32 s68, s45, 1
    s_sub_u32 s69, 3, s68
    s_cmp_eq_u32 s46, 3
    s_cselect_b32 s65, -1, 0
    s_mov_b32 s64, 0
    s_lshr_b32 s67, s44, 3
    s_mov_b32 s70, 0xc0135761
    s_mov_b32 s71, 0xbdd2d3e8
    s_lshr_b32 s73, s45, 1
    s_lshl_b32 s73, s73, 2
    s_and_b32 s51, s46, 1
    s_lshl_b32 s51, s51, 1
    s_add_u32 s73, s73, s51
    s_lshr_b32 s51, s46, 1
    s_add_u32 s73, s73, s51
    s_lshl_b32 s74, s46, 15
    s_lshl_b32 s75, s45, 11
    s_add_u32 s75, s75, s74
    s_lshl_b32 s76, s46, 7
    s_add_u32 s76, s76, 884736
    s_lshl_b32 s51, s45, 2
    s_add_u32 s77, s76, s51
    s_lshl_b32 s52, s45, 2
    s_add_u32 s52, s52, s46
    s_mul_i32 s78, s52, 9216
    s_add_u32 s78, s78, 2097152
    s_lshl_b32 s79, s44, 9
    s_add_u32 s79, s79, s78
    s_lshl_b32 s84, s52, 11
    s_add_u32 s84, s84, 262144
    s_lshl_b32 s52, s46, 11
    s_add_u32 s52, s52, 262144
    s_mul_i32 s80, s68, 114688
    s_add_u32 s80, s80, s52
    s_mul_i32 s81, s69, 114688
    s_add_u32 s81, s81, s52
    s_lshl_b32 s82, s68, 9
    s_add_u32 s82, s82, s76
    s_add_u32 s82, s82, 1536
    s_lshl_b32 s83, s69, 9
    s_add_u32 s83, s83, s76
    s_add_u32 s83, s83, 1536
    v_and_b32 v11, 15, v0
    v_lshrrev_b32 v167, 5, v0
    v_xor_b32 v167, v167, v11
    v_lshlrev_b32 v167, 4, v167
    v_and_b32 v11, 31, v0
    v_lshl_add_u32 v167, v11, 9, v167
    v_add_u32 v167, s56, v167
    v_and_b32 v170, 15, v0
    v_lshlrev_b32 v170, 4, v170
    v_lshrrev_b32 v11, 5, v0
    v_lshl_add_u32 v170, v11, 3, v170
    v_and_b32 v11, 31, v0
    v_lshl_add_u32 v170, v11, 9, v170
    v_add_u32 v170, s56, v170
    s_and_b32 s51, s45, 7
    s_lshl_b32 s51, s51, 6
    v_xor_b32 v170, s51, v170
    s_waitcnt lgkmcnt(0)
    s_add_u32 s47, s47, 0x01010101
    v_mov_b32 v4, s47
    s_lshl_b32 s53, s44, 4
    s_add_u32 s53, s53, s45
    s_lshl_b32 s53, s53, 7
    s_add_u32 s53, s53, 32768
    s_add_u32 s54, s47, s58
    v_mov_b32 v11, s54
    s_mov_b64 exec, 1
    buffer_store_dword v11, off, s[40:43], s53 sc1
    s_mov_b64 exec, -1
    v_lshrrev_b32 v3, 5, v0
    v_mul_u32_u24 v3, 8, v3
    v_bfe_u32 v11, v0, 2, 2
    v_add_u32 v3, v3, v11
    v_mul_u32_u24 v3, 128, v3
    v_bfe_u32 v11, v0, 4, 1
    v_lshl_add_u32 v3, v11, 5, v3
    v_and_b32 v11, 3, v0
    v_lshl_add_u32 v3, v11, 3, v3
    v_bfe_u32 v11, v0, 3, 1
    v_lshl_add_u32 v3, v11, 6, v3
    v_xor_b32 v14, 64, v3
    s_waitcnt vmcnt(9)
    v_xor_b32 v168, 0, v167
    ds_read_b128 v[16:19], v168
    v_xor_b32 v169, 32, v167
    ds_read_b128 v[20:23], v169
    v_xor_b32 v168, 64, v167
    ds_read_b128 v[24:27], v168
    v_xor_b32 v169, 96, v167
    ds_read_b128 v[28:31], v169
    v_xor_b32 v168, 128, v167
    ds_read_b128 v[32:35], v168
    v_xor_b32 v169, 160, v167
    ds_read_b128 v[36:39], v169
    v_xor_b32 v168, 192, v167
    ds_read_b128 v[40:43], v168
    v_xor_b32 v169, 224, v167
    ds_read_b128 v[44:47], v169
    v_xor_b32 v168, 256, v167
    ds_read_b128 v[48:51], v168
    v_xor_b32 v169, 288, v167
    ds_read_b128 v[52:55], v169
    v_xor_b32 v168, 320, v167
    ds_read_b128 v[56:59], v168
    v_xor_b32 v169, 352, v167
    ds_read_b128 v[60:63], v169
    v_xor_b32 v168, 384, v167
    ds_read_b128 v[64:67], v168
    v_xor_b32 v169, 416, v167
    ds_read_b128 v[68:71], v169
    v_xor_b32 v168, 448, v167
    ds_read_b128 v[72:75], v168
    v_xor_b32 v169, 480, v167
    ds_read_b128 v[76:79], v169
    s_cmp_ge_u32 s45, 8
    s_cbranch_scc1 Lres_1
    v_xor_b32 v171, 0, v170
    ds_read_b64 a[216:217], v171
    v_xor_b32 v171, 16, v170
    ds_read_b64 a[218:219], v171
    v_xor_b32 v171, 32, v170
    ds_read_b64 a[220:221], v171
    v_xor_b32 v171, 48, v170
    ds_read_b64 a[222:223], v171
Lres_1:
    v_mov_b32 v174, 0x3f803f80
    s_waitcnt lgkmcnt(0)
    s_mov_b32 s51, 0
    v_xad_u32 v165, v163, s51, v164
    s_add_u32 s52, s49, 512
    s_add_u32 m0, s56, 0
    s_mov_b32 exec_lo, 0xffffff
    s_mov_b32 exec_hi, 0xffffff
    buffer_load_dwordx4 v165, s[20:23], s52 offen lds
    s_mov_b64 exec, -1
    v_dot2_f32_bf16 v172, v16, v174, 0
    v_dot2_f32_bf16 v173, v16, v16, 0
    v_dot2_f32_bf16 v172, v17, v174, v172
    v_dot2_f32_bf16 v173, v17, v17, v173
    v_dot2_f32_bf16 v172, v18, v174, v172
    v_dot2_f32_bf16 v173, v18, v18, v173
    v_dot2_f32_bf16 v172, v19, v174, v172
    v_dot2_f32_bf16 v173, v19, v19, v173
    v_dot2_f32_bf16 v172, v20, v174, v172
    v_dot2_f32_bf16 v173, v20, v20, v173
    v_dot2_f32_bf16 v172, v21, v174, v172
    s_mov_b32 s51, 32
    v_xad_u32 v166, v163, s51, v164
    s_add_u32 s52, s49, 2304
    s_add_u32 m0, s56, 1024
    s_mov_b32 exec_lo, 0xffffff
    s_mov_b32 exec_hi, 0xffffff
    buffer_load_dwordx4 v166, s[20:23], s52 offen lds
    s_mov_b64 exec, -1
    v_dot2_f32_bf16 v173, v21, v21, v173
    v_dot2_f32_bf16 v172, v22, v174, v172
    v_dot2_f32_bf16 v173, v22, v22, v173
    v_dot2_f32_bf16 v172, v23, v174, v172
    v_dot2_f32_bf16 v173, v23, v23, v173
    v_dot2_f32_bf16 v172, v24, v174, v172
    v_dot2_f32_bf16 v173, v24, v24, v173
    v_dot2_f32_bf16 v172, v25, v174, v172
    v_dot2_f32_bf16 v173, v25, v25, v173
    v_dot2_f32_bf16 v172, v26, v174, v172
    s_mov_b32 s51, 64
    v_xad_u32 v165, v163, s51, v164
    s_add_u32 s52, s49, 4096
    s_add_u32 m0, s56, 2048
    s_mov_b32 exec_lo, 0xffffff
    s_mov_b32 exec_hi, 0xffffff
    buffer_load_dwordx4 v165, s[20:23], s52 offen lds
    s_mov_b64 exec, -1
    v_dot2_f32_bf16 v173, v26, v26, v173
    v_dot2_f32_bf16 v172, v27, v174, v172
    v_dot2_f32_bf16 v173, v27, v27, v173
    v_dot2_f32_bf16 v172, v28, v174, v172
    v_dot2_f32_bf16 v173, v28, v28, v173
    v_dot2_f32_bf16 v172, v29, v174, v172
    v_dot2_f32_bf16 v173, v29, v29, v173
    v_dot2_f32_bf16 v172, v30, v174, v172
    v_dot2_f32_bf16 v173, v30, v30, v173
    v_dot2_f32_bf16 v172, v31, v174, v172
    v_dot2_f32_bf16 v173, v31, v31, v173
    s_mov_b32 s51, 96
    v_xad_u32 v166, v163, s51, v164
    s_add_u32 s52, s49, 5888
    s_add_u32 m0, s56, 3072
    s_mov_b32 exec_lo, 0xffffff
    s_mov_b32 exec_hi, 0xffffff
    buffer_load_dwordx4 v166, s[20:23], s52 offen lds
    s_mov_b64 exec, -1
    v_dot2_f32_bf16 v172, v32, v174, v172
    v_dot2_f32_bf16 v173, v32, v32, v173
    v_dot2_f32_bf16 v172, v33, v174, v172
    v_dot2_f32_bf16 v173, v33, v33, v173
    v_dot2_f32_bf16 v172, v34, v174, v172
    v_dot2_f32_bf16 v173, v34, v34, v173
    v_dot2_f32_bf16 v172, v35, v174, v172
    v_dot2_f32_bf16 v173, v35, v35, v173
    v_dot2_f32_bf16 v172, v36, v174, v172
    v_dot2_f32_bf16 v173, v36, v36, v173
    v_dot2_f32_bf16 v172, v37, v174, v172
    s_mov_b32 s51, 128
    v_xad_u32 v165, v163, s51, v164
    s_add_u32 s52, s49, 7680
    s_add_u32 m0, s56, 4096
    s_mov_b32 exec_lo, 0xff00ffff
    s_mov_b32 exec_hi, 0xff00ffff
    buffer_load_dwordx4 v165, s[20:23], s52 offen lds
    s_mov_b64 exec, -1
    v_dot2_f32_bf16 v173, v37, v37, v173
    v_dot2_f32_bf16 v172, v38, v174, v172
    v_dot2_f32_bf16 v173, v38, v38, v173
    v_dot2_f32_bf16 v172, v39, v174, v172
    v_dot2_f32_bf16 v173, v39, v39, v173
    v_dot2_f32_bf16 v172, v40, v174, v172
    v_dot2_f32_bf16 v173, v40, v40, v173
    v_dot2_f32_bf16 v172, v41, v174, v172
    v_dot2_f32_bf16 v173, v41, v41, v173
    v_dot2_f32_bf16 v172, v42, v174, v172
    s_mov_b32 s51, 160
    v_xad_u32 v166, v163, s51, v164
    s_add_u32 s52, s49, 9472
    s_add_u32 m0, s56, 5120
    s_mov_b32 exec_lo, 0xff00ffff
    s_mov_b32 exec_hi, 0xff00ffff
    buffer_load_dwordx4 v166, s[20:23], s52 offen lds
    s_mov_b64 exec, -1
    v_dot2_f32_bf16 v173, v42, v42, v173
    v_dot2_f32_bf16 v172, v43, v174, v172
    v_dot2_f32_bf16 v173, v43, v43, v173
    v_dot2_f32_bf16 v172, v44, v174, v172
    v_dot2_f32_bf16 v173, v44, v44, v173
    v_dot2_f32_bf16 v172, v45, v174, v172
    v_dot2_f32_bf16 v173, v45, v45, v173
    v_dot2_f32_bf16 v172, v46, v174, v172
    v_dot2_f32_bf16 v173, v46, v46, v173
    v_dot2_f32_bf16 v172, v47, v174, v172
    v_dot2_f32_bf16 v173, v47, v47, v173
    s_mov_b32 s51, 192
    v_xad_u32 v165, v163, s51, v164
    s_add_u32 s52, s49, 11264
    s_add_u32 m0, s56, 6144
    s_mov_b32 exec_lo, 0xff00ffff
    s_mov_b32 exec_hi, 0xff00ffff
    buffer_load_dwordx4 v165, s[20:23], s52 offen lds
    s_mov_b64 exec, -1
    v_dot2_f32_bf16 v172, v48, v174, v172
    v_dot2_f32_bf16 v173, v48, v48, v173
    v_dot2_f32_bf16 v172, v49, v174, v172
    v_dot2_f32_bf16 v173, v49, v49, v173
    v_dot2_f32_bf16 v172, v50, v174, v172
    v_dot2_f32_bf16 v173, v50, v50, v173
    v_dot2_f32_bf16 v172, v51, v174, v172
    v_dot2_f32_bf16 v173, v51, v51, v173
    v_dot2_f32_bf16 v172, v52, v174, v172
    v_dot2_f32_bf16 v173, v52, v52, v173
    v_dot2_f32_bf16 v172, v53, v174, v172
    s_mov_b32 s51, 224
    v_xad_u32 v166, v163, s51, v164
    s_add_u32 s52, s49, 13056
    s_add_u32 m0, s56, 7168
    s_mov_b32 exec_lo, 0xff00ffff
    s_mov_b32 exec_hi, 0xff00ffff
    buffer_load_dwordx4 v166, s[20:23], s52 offen lds
    s_mov_b64 exec, -1
    v_dot2_f32_bf16 v173, v53, v53, v173
    v_dot2_f32_bf16 v172, v54, v174, v172
    v_dot2_f32_bf16 v173, v54, v54, v173
    v_dot2_f32_bf16 v172, v55, v174, v172
    v_dot2_f32_bf16 v173, v55, v55, v173
    v_dot2_f32_bf16 v172, v56, v174, v172
    v_dot2_f32_bf16 v173, v56, v56, v173
    v_dot2_f32_bf16 v172, v57, v174, v172
    v_dot2_f32_bf16 v173, v57, v57, v173
    v_dot2_f32_bf16 v172, v58, v174, v172
    s_mov_b32 s51, 0
    v_xad_u32 v165, v163, s51, v164
    s_add_u32 s52, s49, 14848
    s_add_u32 m0, s56, 8192
    s_mov_b32 exec_lo, 0xffffff
    s_mov_b32 exec_hi, 0xffffff
    buffer_load_dwordx4 v165, s[20:23], s52 offen lds
    s_mov_b64 exec, -1
    v_dot2_f32_bf16 v173, v58, v58, v173
    v_dot2_f32_bf16 v172, v59, v174, v172
    v_dot2_f32_bf16 v173, v59, v59, v173
    v_dot2_f32_bf16 v172, v60, v174, v172
    v_dot2_f32_bf16 v173, v60, v60, v173
    v_dot2_f32_bf16 v172, v61, v174, v172
    v_dot2_f32_bf16 v173, v61, v61, v173
    v_dot2_f32_bf16 v172, v62, v174, v172
    v_dot2_f32_bf16 v173, v62, v62, v173
    v_dot2_f32_bf16 v172, v63, v174, v172
    v_dot2_f32_bf16 v173, v63, v63, v173
    s_mov_b32 s51, 32
    v_xad_u32 v166, v163, s51, v164
    s_add_u32 s52, s49, 16640
    s_add_u32 m0, s56, 9216
    s_mov_b32 exec_lo, 0xffffff
    s_mov_b32 exec_hi, 0xffffff
    buffer_load_dwordx4 v166, s[20:23], s52 offen lds
    s_mov_b64 exec, -1
    v_dot2_f32_bf16 v172, v64, v174, v172
    v_dot2_f32_bf16 v173, v64, v64, v173
    v_dot2_f32_bf16 v172, v65, v174, v172
    v_dot2_f32_bf16 v173, v65, v65, v173
    v_dot2_f32_bf16 v172, v66, v174, v172
    v_dot2_f32_bf16 v173, v66, v66, v173
    v_dot2_f32_bf16 v172, v67, v174, v172
    v_dot2_f32_bf16 v173, v67, v67, v173
    v_dot2_f32_bf16 v172, v68, v174, v172
    v_dot2_f32_bf16 v173, v68, v68, v173
    v_dot2_f32_bf16 v172, v69, v174, v172
    s_mov_b32 s51, 64
    v_xad_u32 v165, v163, s51, v164
    s_add_u32 s52, s49, 18432
    s_add_u32 m0, s56, 10240
    s_mov_b32 exec_lo, 0xffffff
    s_mov_b32 exec_hi, 0xffffff
    buffer_load_dwordx4 v165, s[20:23], s52 offen lds
    s_mov_b64 exec, -1
    v_dot2_f32_bf16 v173, v69, v69, v173
    v_dot2_f32_bf16 v172, v70, v174, v172
    v_dot2_f32_bf16 v173, v70, v70, v173
    v_dot2_f32_bf16 v172, v71, v174, v172
    v_dot2_f32_bf16 v173, v71, v71, v173
    v_dot2_f32_bf16 v172, v72, v174, v172
    v_dot2_f32_bf16 v173, v72, v72, v173
    v_dot2_f32_bf16 v172, v73, v174, v172
    v_dot2_f32_bf16 v173, v73, v73, v173
    v_dot2_f32_bf16 v172, v74, v174, v172
    s_mov_b32 s51, 96
    v_xad_u32 v166, v163, s51, v164
    s_add_u32 s52, s49, 20224
    s_add_u32 m0, s56, 11264
    s_mov_b32 exec_lo, 0xffffff
    s_mov_b32 exec_hi, 0xffffff
    buffer_load_dwordx4 v166, s[20:23], s52 offen lds
    s_mov_b64 exec, -1
    v_dot2_f32_bf16 v173, v74, v74, v173
    v_dot2_f32_bf16 v172, v75, v174, v172
    v_dot2_f32_bf16 v173, v75, v75, v173
    v_dot2_f32_bf16 v172, v76, v174, v172
    v_dot2_f32_bf16 v173, v76, v76, v173
    v_dot2_f32_bf16 v172, v77, v174, v172
    v_dot2_f32_bf16 v173, v77, v77, v173
    v_dot2_f32_bf16 v172, v78, v174, v172
    v_dot2_f32_bf16 v173, v78, v78, v173
    v_dot2_f32_bf16 v172, v79, v174, v172
    v_dot2_f32_bf16 v173, v79, v79, v173
    s_waitcnt vmcnt(13)
    s_barrier
    ds_read_b64_tr_b16 v[144:145], v3 offset:0
    ds_read_b64_tr_b16 v[146:147], v3 offset:512
    ds_read_b64_tr_b16 v[148:149], v14 offset:0
    ds_read_b64_tr_b16 v[150:151], v14 offset:512
    ds_read_b64_tr_b16 v[152:153], v3 offset:2048
    ds_read_b64_tr_b16 v[154:155], v3 offset:2560
    ds_read_b64_tr_b16 v[156:157], v14 offset:2048
    ds_read_b64_tr_b16 v[158:159], v14 offset:2560
    v_and_b32 v10, 31, v0
    v_lshlrev_b32 v10, 3, v10
    v_add_u32 v10, 162048, v10
    s_waitcnt lgkmcnt(4)
    v_mfma_f32_32x32x16_bf16 v[96:111], v[16:19], v[144:147], 0
    ds_read_b64_tr_b16 v[144:145], v3 offset:4096
    ds_read_b64_tr_b16 v[146:147], v3 offset:4608
    s_mov_b32 s51, 128
    v_xad_u32 v165, v163, s51, v164
    s_add_u32 s52, s49, 22016
    s_add_u32 m0, s56, 12288
    s_mov_b32 exec_lo, 0xff00ffff
    s_mov_b32 exec_hi, 0xff00ffff
    buffer_load_dwordx4 v165, s[20:23], s52 offen lds
    s_mov_b64 exec, -1
    v_mfma_f32_32x32x16_bf16 v[112:127], v[16:19], v[148:151], 0
    ds_read_b64_tr_b16 v[148:149], v14 offset:4096
    ds_read_b64_tr_b16 v[150:151], v14 offset:4608
    s_mov_b32 s51, 160
    v_xad_u32 v166, v163, s51, v164
    s_add_u32 s52, s49, 23808
    s_add_u32 m0, s56, 13312
    s_mov_b32 exec_lo, 0xff00ffff
    s_mov_b32 exec_hi, 0xff00ffff
    buffer_load_dwordx4 v166, s[20:23], s52 offen lds
    s_mov_b64 exec, -1
    s_waitcnt lgkmcnt(4)
    v_mfma_f32_32x32x16_bf16 v[96:111], v[20:23], v[152:155], v[96:111]
    ds_read_b64_tr_b16 v[152:153], v3 offset:6144
    ds_read_b64_tr_b16 v[154:155], v3 offset:6656
    s_mov_b32 s51, 192
    v_xad_u32 v165, v163, s51, v164
    s_add_u32 s52, s49, 25600
    s_add_u32 m0, s56, 14336
    s_mov_b32 exec_lo, 0xff00ffff
    s_mov_b32 exec_hi, 0xff00ffff
    buffer_load_dwordx4 v165, s[20:23], s52 offen lds
    s_mov_b64 exec, -1
    v_mfma_f32_32x32x16_bf16 v[112:127], v[20:23], v[156:159], v[112:127]
    ds_read_b64_tr_b16 v[156:157], v14 offset:6144
    ds_read_b64_tr_b16 v[158:159], v14 offset:6656
    s_waitcnt lgkmcnt(4)
    v_mfma_f32_32x32x16_bf16 v[96:111], v[24:27], v[144:147], v[96:111]
    ds_read_b64_tr_b16 v[144:145], v3 offset:8192
    ds_read_b64_tr_b16 v[146:147], v3 offset:8704
    s_mov_b32 s51, 224
    v_xad_u32 v166, v163, s51, v164
    s_add_u32 s52, s49, 27392
    s_add_u32 m0, s56, 15360
    s_mov_b32 exec_lo, 0xff00ffff
    s_mov_b32 exec_hi, 0xff00ffff
    buffer_load_dwordx4 v166, s[20:23], s52 offen lds
    s_mov_b64 exec, -1
    v_mfma_f32_32x32x16_bf16 v[112:127], v[24:27], v[148:151], v[112:127]
    ds_read_b64_tr_b16 v[148:149], v14 offset:8192
    ds_read_b64_tr_b16 v[150:151], v14 offset:8704
    s_add_u32 m0, s87, 32768
    s_add_u32 s86, s85, 688128
    buffer_load_dwordx4 v160, s[4:7], s86 offen lds
    s_waitcnt lgkmcnt(4)
    v_mfma_f32_32x32x16_bf16 v[96:111], v[28:31], v[152:155], v[96:111]
    ds_read_b64_tr_b16 v[152:153], v3 offset:10240
    ds_read_b64_tr_b16 v[154:155], v3 offset:10752
    v_mfma_f32_32x32x16_bf16 v[112:127], v[28:31], v[156:159], v[112:127]
    ds_read_b64_tr_b16 v[156:157], v14 offset:10240
    ds_read_b64_tr_b16 v[158:159], v14 offset:10752
    s_add_u32 m0, s87, 36864
    s_add_u32 s86, s85, 774144
    buffer_load_dwordx4 v160, s[4:7], s86 offen lds
    s_waitcnt lgkmcnt(4)
    v_mfma_f32_32x32x16_bf16 v[96:111], v[32:35], v[144:147], v[96:111]
    ds_read_b64_tr_b16 v[144:145], v3 offset:12288
    ds_read_b64_tr_b16 v[146:147], v3 offset:12800
    s_add_u32 m0, s87, 40960
    s_add_u32 s86, s85, 860160
    buffer_load_dwordx4 v160, s[4:7], s86 offen lds
    v_mfma_f32_32x32x16_bf16 v[112:127], v[32:35], v[148:151], v[112:127]
    ds_read_b64_tr_b16 v[148:149], v14 offset:12288
    ds_read_b64_tr_b16 v[150:151], v14 offset:12800
    s_add_u32 m0, s87, 45056
    s_add_u32 s86, s85, 946176
    buffer_load_dwordx4 v160, s[4:7], s86 offen lds
    s_waitcnt lgkmcnt(4)
    v_mfma_f32_32x32x16_bf16 v[96:111], v[36:39], v[152:155], v[96:111]
    ds_read_b64_tr_b16 v[152:153], v3 offset:14336
    ds_read_b64_tr_b16 v[154:155], v3 offset:14848
    v_mfma_f32_32x32x16_bf16 v[112:127], v[36:39], v[156:159], v[112:127]
    ds_read_b64_tr_b16 v[156:157], v14 offset:14336
    ds_read_b64_tr_b16 v[158:159], v14 offset:14848
    s_add_u32 m0, s87, 49152
    s_add_u32 s86, s85, 1032192
    buffer_load_dwordx4 v160, s[4:7], s86 offen lds
    s_waitcnt lgkmcnt(4)
    v_mfma_f32_32x32x16_bf16 v[96:111], v[40:43], v[144:147], v[96:111]
    ds_read_b64_tr_b16 v[144:145], v3 offset:16384
    ds_read_b64_tr_b16 v[146:147], v3 offset:16896
    s_add_u32 m0, s87, 53248
    s_add_u32 s86, s85, 1118208
    buffer_load_dwordx4 v160, s[4:7], s86 offen lds
    v_mfma_f32_32x32x16_bf16 v[112:127], v[40:43], v[148:151], v[112:127]
    ds_read_b64_tr_b16 v[148:149], v14 offset:16384
    ds_read_b64_tr_b16 v[150:151], v14 offset:16896
    s_waitcnt lgkmcnt(4)
    v_mfma_f32_32x32x16_bf16 v[96:111], v[44:47], v[152:155], v[96:111]
    ds_read_b64_tr_b16 v[152:153], v3 offset:18432
    ds_read_b64_tr_b16 v[154:155], v3 offset:18944
    v_mfma_f32_32x32x16_bf16 v[112:127], v[44:47], v[156:159], v[112:127]
    ds_read_b64_tr_b16 v[156:157], v14 offset:18432
    ds_read_b64_tr_b16 v[158:159], v14 offset:18944
    s_waitcnt lgkmcnt(4)
    v_mfma_f32_32x32x16_bf16 v[96:111], v[48:51], v[144:147], v[96:111]
    ds_read_b64_tr_b16 v[144:145], v3 offset:20480
    ds_read_b64_tr_b16 v[146:147], v3 offset:20992
    v_mfma_f32_32x32x16_bf16 v[112:127], v[48:51], v[148:151], v[112:127]
    ds_read_b64_tr_b16 v[148:149], v14 offset:20480
    ds_read_b64_tr_b16 v[150:151], v14 offset:20992
    s_waitcnt lgkmcnt(4)
    v_mfma_f32_32x32x16_bf16 v[96:111], v[52:55], v[152:155], v[96:111]
    ds_read_b64_tr_b16 v[152:153], v3 offset:22528
    ds_read_b64_tr_b16 v[154:155], v3 offset:23040
    v_mfma_f32_32x32x16_bf16 v[112:127], v[52:55], v[156:159], v[112:127]
    ds_read_b64_tr_b16 v[156:157], v14 offset:22528
    ds_read_b64_tr_b16 v[158:159], v14 offset:23040
    s_waitcnt lgkmcnt(4)
    v_mfma_f32_32x32x16_bf16 v[96:111], v[56:59], v[144:147], v[96:111]
    ds_read_b64_tr_b16 v[144:145], v3 offset:24576
    ds_read_b64_tr_b16 v[146:147], v3 offset:25088
    v_mfma_f32_32x32x16_bf16 v[112:127], v[56:59], v[148:151], v[112:127]
    ds_read_b64_tr_b16 v[148:149], v14 offset:24576
    ds_read_b64_tr_b16 v[150:151], v14 offset:25088
    s_waitcnt vmcnt(6)
    v_xor_b32 v168, 0, v167
    ds_read_b128 v[80:83], v168
    v_xor_b32 v169, 32, v167
    ds_read_b128 v[84:87], v169
    s_waitcnt lgkmcnt(6)
    v_mfma_f32_32x32x16_bf16 v[96:111], v[60:63], v[152:155], v[96:111]
    ds_read_b64_tr_b16 v[152:153], v3 offset:26624
    ds_read_b64_tr_b16 v[154:155], v3 offset:27136
    v_xor_b32 v168, 64, v167
    ds_read_b128 v[88:91], v168
    v_xor_b32 v169, 96, v167
    ds_read_b128 v[92:95], v169
    v_mfma_f32_32x32x16_bf16 v[112:127], v[60:63], v[156:159], v[112:127]
    ds_read_b64_tr_b16 v[156:157], v14 offset:26624
    ds_read_b64_tr_b16 v[158:159], v14 offset:27136
    v_xor_b32 v168, 128, v167
    ds_read_b128 v[176:179], v168
    v_xor_b32 v169, 160, v167
    ds_read_b128 v[180:183], v169
    s_waitcnt lgkmcnt(10)
    v_mfma_f32_32x32x16_bf16 v[96:111], v[64:67], v[144:147], v[96:111]
    ds_read_b64_tr_b16 v[144:145], v3 offset:28672
    ds_read_b64_tr_b16 v[146:147], v3 offset:29184
    v_xor_b32 v168, 192, v167
    ds_read_b128 v[184:187], v168
    v_xor_b32 v169, 224, v167
    ds_read_b128 v[188:191], v169
    v_mfma_f32_32x32x16_bf16 v[112:127], v[64:67], v[148:151], v[112:127]
    ds_read_b64_tr_b16 v[148:149], v14 offset:28672
    ds_read_b64_tr_b16 v[150:151], v14 offset:29184
    v_xor_b32 v168, 256, v167
    ds_read_b128 v[192:195], v168
    v_xor_b32 v169, 288, v167
    ds_read_b128 v[196:199], v169
    s_waitcnt lgkmcnt(10)
    v_mfma_f32_32x32x16_bf16 v[96:111], v[68:71], v[152:155], v[96:111]
    ds_read_b64_tr_b16 v[152:153], v3 offset:30720
    ds_read_b64_tr_b16 v[154:155], v3 offset:31232
    v_xor_b32 v168, 320, v167
    ds_read_b128 v[200:203], v168
    v_xor_b32 v169, 352, v167
    ds_read_b128 v[204:207], v169
    v_mfma_f32_32x32x16_bf16 v[112:127], v[68:71], v[156:159], v[112:127]
    ds_read_b64_tr_b16 v[156:157], v14 offset:30720
    ds_read_b64_tr_b16 v[158:159], v14 offset:31232
    s_cmp_lt_u32 s45, 8
    s_cbranch_scc1 Lres_2
    v_xor_b32 v171, 0, v170
    ds_read_b64 a[216:217], v171
    v_xor_b32 v171, 16, v170
    ds_read_b64 a[218:219], v171
    v_xor_b32 v171, 32, v170
    ds_read_b64 a[220:221], v171
    v_xor_b32 v171, 48, v170
    ds_read_b64 a[222:223], v171
Lres_2:
    s_waitcnt lgkmcnt(8)
    v_mfma_f32_32x32x16_bf16 v[96:111], v[72:75], v[144:147], v[96:111]
    v_dot2_f32_bf16 v172, v80, v174, v172
    v_dot2_f32_bf16 v173, v80, v80, v173
    v_dot2_f32_bf16 v172, v81, v174, v172
    v_dot2_f32_bf16 v173, v81, v81, v173
    v_dot2_f32_bf16 v172, v82, v174, v172
    v_dot2_f32_bf16 v173, v82, v82, v173
    v_dot2_f32_bf16 v172, v83, v174, v172
    v_dot2_f32_bf16 v173, v83, v83, v173
    v_dot2_f32_bf16 v172, v84, v174, v172
    v_dot2_f32_bf16 v173, v84, v84, v173
    v_dot2_f32_bf16 v172, v85, v174, v172
    v_dot2_f32_bf16 v173, v85, v85, v173
    v_dot2_f32_bf16 v172, v86, v174, v172
    v_dot2_f32_bf16 v173, v86, v86, v173
    v_dot2_f32_bf16 v172, v87, v174, v172
    v_dot2_f32_bf16 v173, v87, v87, v173
    v_dot2_f32_bf16 v172, v88, v174, v172
    v_dot2_f32_bf16 v173, v88, v88, v173
    v_dot2_f32_bf16 v172, v89, v174, v172
    v_dot2_f32_bf16 v173, v89, v89, v173
    v_dot2_f32_bf16 v172, v90, v174, v172
    v_dot2_f32_bf16 v173, v90, v90, v173
    v_dot2_f32_bf16 v172, v91, v174, v172
    v_dot2_f32_bf16 v173, v91, v91, v173
    v_dot2_f32_bf16 v172, v92, v174, v172
    v_dot2_f32_bf16 v173, v92, v92, v173
    v_dot2_f32_bf16 v172, v93, v174, v172
    v_dot2_f32_bf16 v173, v93, v93, v173
    v_dot2_f32_bf16 v172, v94, v174, v172
    v_dot2_f32_bf16 v173, v94, v94, v173
    v_dot2_f32_bf16 v172, v95, v174, v172
    v_dot2_f32_bf16 v173, v95, v95, v173
    v_dot2_f32_bf16 v172, v176, v174, v172
    v_dot2_f32_bf16 v173, v176, v176, v173
    v_dot2_f32_bf16 v172, v177, v174, v172
    v_dot2_f32_bf16 v173, v177, v177, v173
    v_dot2_f32_bf16 v172, v178, v174, v172
    v_dot2_f32_bf16 v173, v178, v178, v173
    v_dot2_f32_bf16 v172, v179, v174, v172
    v_dot2_f32_bf16 v173, v179, v179, v173
    v_dot2_f32_bf16 v172, v180, v174, v172
    v_dot2_f32_bf16 v173, v180, v180, v173
    v_dot2_f32_bf16 v172, v181, v174, v172
    v_dot2_f32_bf16 v173, v181, v181, v173
    v_dot2_f32_bf16 v172, v182, v174, v172
    v_dot2_f32_bf16 v173, v182, v182, v173
    v_dot2_f32_bf16 v172, v183, v174, v172
    v_dot2_f32_bf16 v173, v183, v183, v173
    v_dot2_f32_bf16 v172, v184, v174, v172
    v_dot2_f32_bf16 v173, v184, v184, v173
    v_dot2_f32_bf16 v172, v185, v174, v172
    v_dot2_f32_bf16 v173, v185, v185, v173
    v_dot2_f32_bf16 v172, v186, v174, v172
    v_dot2_f32_bf16 v173, v186, v186, v173
    v_dot2_f32_bf16 v172, v187, v174, v172
    v_dot2_f32_bf16 v173, v187, v187, v173
    v_dot2_f32_bf16 v172, v188, v174, v172
    v_dot2_f32_bf16 v173, v188, v188, v173
    v_dot2_f32_bf16 v172, v189, v174, v172
    v_dot2_f32_bf16 v173, v189, v189, v173
    v_dot2_f32_bf16 v172, v190, v174, v172
    v_dot2_f32_bf16 v173, v190, v190, v173
    v_dot2_f32_bf16 v172, v191, v174, v172
    v_dot2_f32_bf16 v173, v191, v191, v173
    s_waitcnt lgkmcnt(7)
    v_dot2_f32_bf16 v172, v192, v174, v172
    v_dot2_f32_bf16 v173, v192, v192, v173
    v_dot2_f32_bf16 v172, v193, v174, v172
    v_dot2_f32_bf16 v173, v193, v193, v173
    v_dot2_f32_bf16 v172, v194, v174, v172
    v_dot2_f32_bf16 v173, v194, v194, v173
    v_dot2_f32_bf16 v172, v195, v174, v172
    v_dot2_f32_bf16 v173, v195, v195, v173
    s_waitcnt lgkmcnt(6)
    v_dot2_f32_bf16 v172, v196, v174, v172
    v_dot2_f32_bf16 v173, v196, v196, v173
    v_dot2_f32_bf16 v172, v197, v174, v172
    v_dot2_f32_bf16 v173, v197, v197, v173
    v_dot2_f32_bf16 v172, v198, v174, v172
    v_dot2_f32_bf16 v173, v198, v198, v173
    v_dot2_f32_bf16 v172, v199, v174, v172
    v_dot2_f32_bf16 v173, v199, v199, v173
    s_waitcnt lgkmcnt(3)
    v_dot2_f32_bf16 v172, v200, v174, v172
    v_dot2_f32_bf16 v173, v200, v200, v173
    v_dot2_f32_bf16 v172, v201, v174, v172
    v_dot2_f32_bf16 v173, v201, v201, v173
    v_dot2_f32_bf16 v172, v202, v174, v172
    v_dot2_f32_bf16 v173, v202, v202, v173
    v_dot2_f32_bf16 v172, v203, v174, v172
    v_dot2_f32_bf16 v173, v203, v203, v173
    s_waitcnt lgkmcnt(2)
    v_dot2_f32_bf16 v172, v204, v174, v172
    v_dot2_f32_bf16 v173, v204, v204, v173
    v_dot2_f32_bf16 v172, v205, v174, v172
    v_dot2_f32_bf16 v173, v205, v205, v173
    v_dot2_f32_bf16 v172, v206, v174, v172
    v_dot2_f32_bf16 v173, v206, v206, v173
    v_dot2_f32_bf16 v172, v207, v174, v172
    v_dot2_f32_bf16 v173, v207, v207, v173
    s_nop 2
    v_permlane32_swap_b32 v172, v173
    v_add_f32 v172, v172, v173
    s_waitcnt vmcnt(0)
    s_waitcnt lgkmcnt(0)
    s_barrier
    s_mul_i32 s51, s46, 14336
    v_add_u32 v164, s51, v3
    v_add_u32 v165, s51, v14
    ds_read_b64_tr_b16 v[144:145], v164 offset:0
    ds_read_b64_tr_b16 v[146:147], v164 offset:512
    v_mfma_f32_32x32x16_bf16 v[112:127], v[72:75], v[148:151], v[112:127]
    ds_read_b64_tr_b16 v[148:149], v165 offset:0
    ds_read_b64_tr_b16 v[150:151], v165 offset:512
    v_mov_b32 v160, 0x3f803f80
    v_mov_b32 v161, 0x3f803f80
    v_mov_b32 v162, 0x3f803f80
    v_mov_b32 v163, 0x3f803f80
    v_mfma_f32_32x32x16_bf16 v[96:111], v[76:79], v[152:155], v[96:111]
    ds_read_b64_tr_b16 v[152:153], v164 offset:2048
    ds_read_b64_tr_b16 v[154:155], v164 offset:2560
    v_mov_b32 v12, v172
    v_mov_b32 v5, v172
    s_nop 1
    v_permlane32_swap_b32 v5, v12
    v_mul_f32 v5, 0x3b124925, v5
    v_mfma_f32_32x32x16_bf16 v[112:127], v[76:79], v[156:159], v[112:127]
    ds_read_b64_tr_b16 v[156:157], v165 offset:2048
    ds_read_b64_tr_b16 v[158:159], v165 offset:2560
    v_mul_f32 v12, 0x3b124925, v12
    v_fma_f32 v12, -v5, v5, v12
    v_max_f32 v12, 0, v12
    v_add_f32 v13, 0x3727c5ac, v12
    s_waitcnt lgkmcnt(4)
    v_mfma_f32_32x32x16_bf16 v[208:223], v[160:163], v[144:147], 0
    ds_read_b64_tr_b16 v[144:145], v164 offset:4096
    ds_read_b64_tr_b16 v[146:147], v164 offset:4608
    v_rsq_f32 v6, v13
    s_nop 0
    v_mul_f32 v6, 0x3fb8aa3b, v6
    s_lshl_b32 s55, s46, 12
    s_add_u32 s55, s55, 143616
    v_mfma_f32_32x32x16_bf16 v[224:239], v[160:163], v[148:151], 0
    ds_read_b64_tr_b16 v[148:149], v165 offset:4096
    ds_read_b64_tr_b16 v[150:151], v165 offset:4608
    v_and_b32 v12, 31, v0
    v_lshl_add_u32 v12, v12, 2, s55
    ds_write_b32 v12, v6
    v_sub_f32 v5, 0, v5
    s_waitcnt lgkmcnt(5)
    v_mfma_f32_32x32x16_bf16 v[208:223], v[160:163], v[152:155], v[208:223]
    ds_read_b64_tr_b16 v[152:153], v164 offset:6144
    ds_read_b64_tr_b16 v[154:155], v164 offset:6656
    v_cvt_pk_bf16_f32 v169, v5, v5
    v_and_b32 v11, 0xffff0000, v169
    v_sub_f32 v11, v5, v11
    v_cvt_pk_bf16_f32 v168, v5, v11
    v_mfma_f32_32x32x16_bf16 v[224:239], v[160:163], v[156:159], v[224:239]
    ds_read_b64_tr_b16 v[156:157], v165 offset:6144
    ds_read_b64_tr_b16 v[158:159], v165 offset:6656
    v_and_b32 v169, 0xffff, v169
    v_cndmask_b32 v169, v169, 0, s[62:63]
    v_cndmask_b32 v168, v168, 0, s[62:63]
    v_mov_b32 v170, 0
    s_waitcnt lgkmcnt(5)
    v_mfma_f32_32x32x16_bf16 v[208:223], v[160:163], v[144:147], v[208:223]
    ds_read_b64_tr_b16 v[144:145], v164 offset:8192
    ds_read_b64_tr_b16 v[146:147], v164 offset:8704
    v_mov_b32 v171, 0
    v_mfma_f32_32x32x16_bf16 v[224:239], v[160:163], v[148:151], v[224:239]
    ds_read_b64_tr_b16 v[148:149], v165 offset:8192
    ds_read_b64_tr_b16 v[150:151], v165 offset:8704
    s_mul_i32 s87, s45, 56
    s_add_u32 s86, s87, 896
    v_lshrrev_b32 v175, 2, v0
    v_mul_u32_u24 v175, 2688, v175
    v_and_b32 v11, 3, v0
    v_lshl_add_u32 v175, v11, 4, v175
    v_add_u32 v175, s87, v175
    s_mul_i32 s85, s46, 43008
    s_lshl_b32 s87, s46, 10
    s_waitcnt lgkmcnt(4)
    v_mfma_f32_32x32x16_bf16 v[208:223], v[160:163], v[152:155], v[208:223]
    ds_read_b64_tr_b16 v[152:153], v164 offset:10240
    ds_read_b64_tr_b16 v[154:155], v164 offset:10752
    s_add_u32 m0, s87, 57344
    s_add_u32 s86, s85, 0
    buffer_load_dwordx4 v175, s[4:7], s86 offen lds
    v_mfma_f32_32x32x16_bf16 v[224:239], v[160:163], v[156:159], v[224:239]
    ds_read_b64_tr_b16 v[156:157], v165 offset:10240
    ds_read_b64_tr_b16 v[158:159], v165 offset:10752
    s_add_u32 m0, s87, 61440
    s_add_u32 s86, s85, 172032
    buffer_load_dwordx4 v175, s[4:7], s86 offen lds
    s_waitcnt lgkmcnt(4)
    v_mfma_f32_32x32x16_bf16 v[208:223], v[160:163], v[144:147], v[208:223]
    ds_read_b64_tr_b16 v[144:145], v164 offset:12288
    ds_read_b64_tr_b16 v[146:147], v164 offset:12800
    s_add_u32 m0, s87, 65536
    s_add_u32 s86, s85, 344064
    buffer_load_dwordx4 v175, s[4:7], s86 offen lds
    v_mfma_f32_32x32x16_bf16 v[224:239], v[160:163], v[148:151], v[224:239]
    ds_read_b64_tr_b16 v[148:149], v165 offset:12288
    ds_read_b64_tr_b16 v[150:151], v165 offset:12800
    s_add_u32 m0, s87, 69632
    s_add_u32 s86, s85, 516096
    buffer_load_dwordx4 v175, s[4:7], s86 offen lds
    s_waitcnt lgkmcnt(4)
    v_mfma_f32_32x32x16_bf16 v[208:223], v[160:163], v[152:155], v[208:223]
    ds_read_b64_tr_b16 v[152:153], v3 offset:32768
    ds_read_b64_tr_b16 v[154:155], v3 offset:33280
    s_add_u32 m0, s87, 73728
    s_add_u32 s86, s85, 688128
    buffer_load_dwordx4 v175, s[4:7], s86 offen lds
    v_mfma_f32_32x32x16_bf16 v[224:239], v[160:163], v[156:159], v[224:239]
    ds_read_b64_tr_b16 v[156:157], v14 offset:32768
    ds_read_b64_tr_b16 v[158:159], v14 offset:33280
    s_add_u32 m0, s87, 77824
    s_add_u32 s86, s85, 860160
    buffer_load_dwordx4 v175, s[4:7], s86 offen lds
    s_waitcnt lgkmcnt(4)
    v_mfma_f32_32x32x16_bf16 v[208:223], v[160:163], v[144:147], v[208:223]
    ds_read_b64_tr_b16 v[144:145], v3 offset:34816
    ds_read_b64_tr_b16 v[146:147], v3 offset:35328
    s_add_u32 m0, s87, 81920
    s_add_u32 s86, s85, 1032192
    buffer_load_dwordx4 v175, s[4:7], s86 offen lds
    v_mfma_f32_32x32x16_bf16 v[224:239], v[160:163], v[148:151], v[224:239]
    ds_read_b64_tr_b16 v[148:149], v14 offset:34816
    ds_read_b64_tr_b16 v[150:151], v14 offset:35328
    s_waitcnt lgkmcnt(4)
    v_mfma_f32_32x32x16_bf16 v[96:111], v[80:83], v[152:155], v[96:111]
    ds_read_b64_tr_b16 v[152:153], v3 offset:36864
    ds_read_b64_tr_b16 v[154:155], v3 offset:37376
    v_lshlrev_b32 v11, 7, v0
    s_mul_i32 s53, s59, 3200
    s_add_u32 s53, s53, 0
    s_mov_b32 exec_lo, 0x1ffffff
    s_mov_b32 exec_hi, 0x0
    buffer_load_dword v2, v11, s[8:11], s53 offen
    s_mov_b64 exec, -1
    s_lshr_b32 s52, s45, 2
    s_lshl_b32 s52, s52, 10
    s_add_u32 s52, s52, s74
    s_add_u32 s52, s52, 159744
    s_add_u32 s54, s75, 131072
    s_mul_i32 s51, s46, 896
    s_cmp_lt_u32 s45, 14
    s_cselect_b32 s52, s52, s75
    s_cselect_b32 s54, s54, s75
    v_lshlrev_b32 v11, 7, v0
    s_mov_b64 exec, 0xffff
    s_add_u32 s53, s75, 0
    buffer_load_dword v2, v11, s[36:39], s53 offen sc1
    s_add_u32 s53, s54, 0
    buffer_load_dword v2, v11, s[36:39], s53 offen sc1
    s_mov_b64 exec, 0xff
    s_add_u32 s53, s52, 0
    buffer_load_dword v2, v11, s[36:39], s53 offen sc1
    s_mov_b64 exec, 0x7f
    s_add_u32 s53, s51, 884736
    buffer_load_dword v2, v11, s[36:39], s53 offen sc1
    s_mov_b64 exec, -1
    v_mfma_f32_32x32x16_bf16 v[112:127], v[80:83], v[156:159], v[112:127]
    ds_read_b64_tr_b16 v[156:157], v14 offset:36864
    ds_read_b64_tr_b16 v[158:159], v14 offset:37376
    v_and_b32 v164, 31, v0
    v_lshlrev_b32 v164, 2, v164
    s_lshl_b32 s51, s46, 8
    v_add_u32 v164, 160000, v164
    v_add_u32 v165, s51, v164
    s_waitcnt lgkmcnt(4)
    v_mfma_f32_32x32x16_bf16 v[96:111], v[84:87], v[144:147], v[96:111]
    ds_read_b64_tr_b16 v[144:145], v3 offset:38912
    ds_read_b64_tr_b16 v[146:147], v3 offset:39424
    ds_write_b32 v165, v208 offset:0
    ds_write_b32 v165, v224 offset:128
    v_mfma_f32_32x32x16_bf16 v[112:127], v[84:87], v[148:151], v[112:127]
    ds_read_b64_tr_b16 v[148:149], v14 offset:38912
    ds_read_b64_tr_b16 v[150:151], v14 offset:39424
    s_waitcnt lgkmcnt(6)
    v_mfma_f32_32x32x16_bf16 v[96:111], v[88:91], v[152:155], v[96:111]
    ds_read_b64_tr_b16 v[152:153], v3 offset:40960
    ds_read_b64_tr_b16 v[154:155], v3 offset:41472
    s_waitcnt lgkmcnt(0)
    s_barrier
    ds_read_b32 v160, v164 offset:0
    ds_read_b32 v161, v164 offset:256
    ds_read_b32 v162, v164 offset:512
    ds_read_b32 v163, v164 offset:768
    v_mfma_f32_32x32x16_bf16 v[112:127], v[88:91], v[156:159], v[112:127]
    ds_read_b64_tr_b16 v[156:157], v14 offset:40960
    ds_read_b64_tr_b16 v[158:159], v14 offset:41472
    v_mfma_f32_32x32x16_bf16 v[96:111], v[92:95], v[144:147], v[96:111]
    ds_read_b64_tr_b16 v[144:145], v3 offset:43008
    ds_read_b64_tr_b16 v[146:147], v3 offset:43520
    v_mfma_f32_32x32x16_bf16 v[112:127], v[92:95], v[148:151], v[112:127]
    ds_read_b64_tr_b16 v[148:149], v14 offset:43008
    ds_read_b64_tr_b16 v[150:151], v14 offset:43520
    s_waitcnt lgkmcnt(8)
    v_add_f32 v160, v160, v161
    s_waitcnt lgkmcnt(6)
    v_add_f32 v162, v162, v163
    v_add_f32 v160, v160, v162
    s_waitcnt lgkmcnt(4)
    v_mfma_f32_32x32x16_bf16 v[96:111], v[176:179], v[152:155], v[96:111]
    ds_read_b64_tr_b16 v[152:153], v3 offset:45056
    ds_read_b64_tr_b16 v[154:155], v3 offset:45568
    v_cvt_pk_bf16_f32 v162, v160, v160
    v_and_b32 v161, 0xffff0000, v162
    v_sub_f32 v161, v160, v161
    v_cvt_pk_bf16_f32 v163, v161, 0
    ds_write_b64 v10, v[162:163] offset:256
    v_mfma_f32_32x32x16_bf16 v[112:127], v[176:179], v[156:159], v[112:127]
    ds_read_b64_tr_b16 v[156:157], v14 offset:45056
    ds_read_b64_tr_b16 v[158:159], v14 offset:45568
    ds_read_b32 v160, v164 offset:128
    ds_read_b32 v161, v164 offset:384
    ds_read_b32 v162, v164 offset:640
    ds_read_b32 v163, v164 offset:896
    s_waitcnt lgkmcnt(9)
    v_mfma_f32_32x32x16_bf16 v[96:111], v[180:183], v[144:147], v[96:111]
    ds_read_b64_tr_b16 v[144:145], v3 offset:47104
    ds_read_b64_tr_b16 v[146:147], v3 offset:47616
    v_mfma_f32_32x32x16_bf16 v[112:127], v[180:183], v[148:151], v[112:127]
    ds_read_b64_tr_b16 v[148:149], v14 offset:47104
    ds_read_b64_tr_b16 v[150:151], v14 offset:47616
    s_waitcnt lgkmcnt(8)
    v_mfma_f32_32x32x16_bf16 v[96:111], v[184:187], v[152:155], v[96:111]
    ds_read_b64_tr_b16 v[152:153], v3 offset:49152
    ds_read_b64_tr_b16 v[154:155], v3 offset:49664
    s_waitcnt lgkmcnt(8)
    v_add_f32 v160, v160, v161
    s_waitcnt lgkmcnt(6)
    v_add_f32 v162, v162, v163
    v_add_f32 v160, v160, v162
    v_mfma_f32_32x32x16_bf16 v[112:127], v[184:187], v[156:159], v[112:127]
    ds_read_b64_tr_b16 v[156:157], v14 offset:49152
    ds_read_b64_tr_b16 v[158:159], v14 offset:49664
    v_cvt_pk_bf16_f32 v162, v160, v160
    v_and_b32 v161, 0xffff0000, v162
    v_sub_f32 v161, v160, v161
    v_cvt_pk_bf16_f32 v163, v161, 0
    ds_write_b64 v10, v[162:163] offset:512
    s_waitcnt lgkmcnt(5)
    v_mfma_f32_32x32x16_bf16 v[96:111], v[188:191], v[144:147], v[96:111]
    ds_read_b64_tr_b16 v[144:145], v3 offset:51200
    ds_read_b64_tr_b16 v[146:147], v3 offset:51712
    v_and_b32 v173, 31, v0
    v_lshrrev_b32 v172, 5, v0
    v_lshrrev_b32 v174, 3, v173
    v_mfma_f32_32x32x16_bf16 v[112:127], v[188:191], v[148:151], v[112:127]
    ds_read_b64_tr_b16 v[148:149], v14 offset:51200
    ds_read_b64_tr_b16 v[150:151], v14 offset:51712
    v_sub_u32 v174, v173, v174
    v_lshl_add_u32 v172, v172, 5, v174
    s_lshl_b32 s53, s46, 10
    s_waitcnt lgkmcnt(5)
    v_mfma_f32_32x32x16_bf16 v[96:111], v[192:195], v[152:155], v[96:111]
    ds_read_b64_tr_b16 v[152:153], v3 offset:53248
    ds_read_b64_tr_b16 v[154:155], v3 offset:53760
    v_lshlrev_b32 v172, 4, v172
    v_add_u32 v172, s53, v172
    v_and_b32 v173, 1, v174
    v_mfma_f32_32x32x16_bf16 v[112:127], v[192:195], v[156:159], v[112:127]
    ds_read_b64_tr_b16 v[156:157], v14 offset:53248
    ds_read_b64_tr_b16 v[158:159], v14 offset:53760
    v_lshlrev_b32 v173, 9, v173
    v_lshrrev_b32 v174, 1, v174
    v_cmp_gt_u32 vcc, 4, v174
    s_waitcnt lgkmcnt(4)
    v_mfma_f32_32x32x16_bf16 v[96:111], v[196:199], v[144:147], v[96:111]
    ds_read_b64_tr_b16 v[144:145], v3 offset:55296
    ds_read_b64_tr_b16 v[146:147], v3 offset:55808
    v_lshl_add_u32 v173, v174, 10, v173
    v_add_u32 v173, 448, v173
    s_and_b64 vcc, vcc, s[64:65]
    v_mfma_f32_32x32x16_bf16 v[112:127], v[196:199], v[148:151], v[112:127]
    ds_read_b64_tr_b16 v[148:149], v14 offset:55296
    ds_read_b64_tr_b16 v[150:151], v14 offset:55808
    v_cndmask_b32 v172, v172, v173, vcc
    v_add_u32 v172, 143616, v172
    s_waitcnt lgkmcnt(4)
    v_mfma_f32_32x32x16_bf16 v[96:111], v[200:203], v[152:155], v[96:111]
    ds_read_b64 v[152:153], v10 offset:256
    v_mov_b32 v154, 0
    v_mov_b32 v155, 0
    v_mfma_f32_32x32x16_bf16 v[112:127], v[200:203], v[156:159], v[112:127]
    ds_read_b64 v[156:157], v10 offset:512
    v_mov_b32 v158, 0
    v_mov_b32 v159, 0
    v_lshrrev_b32 v13, 5, v0
    v_lshl_add_u32 v13, v13, 4, s55
    s_waitcnt lgkmcnt(2)
    v_mfma_f32_32x32x16_bf16 v[96:111], v[204:207], v[144:147], v[96:111]
    ds_read_b128 v[144:147], v13 offset:0
    v_mfma_f32_32x32x16_bf16 v[112:127], v[204:207], v[148:151], v[112:127]
    ds_read_b128 v[148:151], v13 offset:32
    s_waitcnt lgkmcnt(2)
    v_mfma_f32_32x32x16_bf16 v[96:111], v[168:171], v[152:155], v[96:111]
    ds_read_b128 v[152:155], v13 offset:64
    v_mfma_f32_32x32x16_bf16 v[112:127], v[168:171], v[156:159], v[112:127]
    ds_read_b128 v[156:159], v13 offset:96
    v_mov_b32 v9, 0x3f803f80
    v_add_u32 v11, s55, v1
    v_mov_b32 v12, 0x358637bd
    s_waitcnt lgkmcnt(3)
    s_nop 4
    v_pk_mul_f32 v[96:97], v[96:97], v[144:145]
    v_pk_mul_f32 v[98:99], v[98:99], v[146:147]
    s_waitcnt lgkmcnt(2)
    v_pk_mul_f32 v[100:101], v[100:101], v[148:149]
    v_pk_mul_f32 v[102:103], v[102:103], v[150:151]
    v_exp_f32 v160, v96 clamp
    v_max_f32 v96, 0, v96
    v_exp_f32 v161, v97 clamp
    v_max_f32 v97, 0, v97
    v_exp_f32 v162, v98 clamp
    v_max_f32 v98, 0, v98
    v_exp_f32 v163, v99 clamp
    v_max_f32 v99, 0, v99
    v_exp_f32 v164, v100 clamp
    v_max_f32 v100, 0, v100
    v_exp_f32 v165, v101 clamp
    v_max_f32 v101, 0, v101
    v_exp_f32 v166, v102 clamp
    v_max_f32 v102, 0, v102
    v_exp_f32 v167, v103 clamp
    v_max_f32 v103, 0, v103
    v_pk_fma_f32 v[96:97], v[96:97], s[56:57], v[160:161] op_sel:[0,1,0] op_sel_hi:[1,1,1]
    v_pk_fma_f32 v[98:99], v[98:99], s[56:57], v[162:163] op_sel:[0,1,0] op_sel_hi:[1,1,1]
    v_pk_fma_f32 v[100:101], v[100:101], s[56:57], v[164:165] op_sel:[0,1,0] op_sel_hi:[1,1,1]
    v_pk_fma_f32 v[102:103], v[102:103], s[56:57], v[166:167] op_sel:[0,1,0] op_sel_hi:[1,1,1]
    v_pk_add_f32 v[96:97], v[96:97], v[12:13] op_sel_hi:[1,0]
    v_pk_add_f32 v[98:99], v[98:99], v[12:13] op_sel_hi:[1,0]
    v_pk_add_f32 v[100:101], v[100:101], v[12:13] op_sel_hi:[1,0]
    v_pk_add_f32 v[102:103], v[102:103], v[12:13] op_sel_hi:[1,0]
    v_cvt_pk_bf16_f32 v96, v96, v97
    v_cvt_pk_bf16_f32 v97, v98, v99
    v_cvt_pk_bf16_f32 v98, v100, v101
    v_cvt_pk_bf16_f32 v99, v102, v103
    v_pk_mul_f32 v[112:113], v[112:113], v[144:145]
    v_pk_mul_f32 v[114:115], v[114:115], v[146:147]
    v_pk_mul_f32 v[116:117], v[116:117], v[148:149]
    v_pk_mul_f32 v[118:119], v[118:119], v[150:151]
    v_cvt_pk_bf16_f32 v112, v112, v113
    v_cvt_pk_bf16_f32 v113, v114, v115
    v_cvt_pk_bf16_f32 v114, v116, v117
    v_cvt_pk_bf16_f32 v115, v118, v119
    v_cndmask_b32 v112, v112, v9, s[60:61]
    v_cndmask_b32 v113, v113, v9, s[60:61]
    v_cndmask_b32 v114, v114, v9, s[60:61]
    v_cndmask_b32 v115, v115, v9, s[60:61]
    s_waitcnt lgkmcnt(1)
    v_pk_mul_f32 v[104:105], v[104:105], v[152:153]
    v_pk_mul_f32 v[106:107], v[106:107], v[154:155]
    s_waitcnt lgkmcnt(0)
    v_pk_mul_f32 v[108:109], v[108:109], v[156:157]
    v_pk_mul_f32 v[110:111], v[110:111], v[158:159]
    v_exp_f32 v160, v104 clamp
    v_max_f32 v104, 0, v104
    v_exp_f32 v161, v105 clamp
    v_max_f32 v105, 0, v105
    v_exp_f32 v162, v106 clamp
    v_max_f32 v106, 0, v106
    v_exp_f32 v163, v107 clamp
    v_max_f32 v107, 0, v107
    v_exp_f32 v164, v108 clamp
    v_max_f32 v108, 0, v108
    v_exp_f32 v165, v109 clamp
    v_max_f32 v109, 0, v109
    v_exp_f32 v166, v110 clamp
    v_max_f32 v110, 0, v110
    v_exp_f32 v167, v111 clamp
    v_max_f32 v111, 0, v111
    v_pk_fma_f32 v[104:105], v[104:105], s[56:57], v[160:161] op_sel:[0,1,0] op_sel_hi:[1,1,1]
    v_pk_fma_f32 v[106:107], v[106:107], s[56:57], v[162:163] op_sel:[0,1,0] op_sel_hi:[1,1,1]
    v_pk_fma_f32 v[108:109], v[108:109], s[56:57], v[164:165] op_sel:[0,1,0] op_sel_hi:[1,1,1]
    v_pk_fma_f32 v[110:111], v[110:111], s[56:57], v[166:167] op_sel:[0,1,0] op_sel_hi:[1,1,1]
    v_pk_add_f32 v[104:105], v[104:105], v[12:13] op_sel_hi:[1,0]
    v_pk_add_f32 v[106:107], v[106:107], v[12:13] op_sel_hi:[1,0]
    v_pk_add_f32 v[108:109], v[108:109], v[12:13] op_sel_hi:[1,0]
    v_pk_add_f32 v[110:111], v[110:111], v[12:13] op_sel_hi:[1,0]
    v_cvt_pk_bf16_f32 v100, v104, v105
    v_cvt_pk_bf16_f32 v101, v106, v107
    v_cvt_pk_bf16_f32 v102, v108, v109
    v_cvt_pk_bf16_f32 v103, v110, v111
    v_pk_mul_f32 v[120:121], v[120:121], v[152:153]
    v_pk_mul_f32 v[122:123], v[122:123], v[154:155]
    v_pk_mul_f32 v[124:125], v[124:125], v[156:157]
    v_pk_mul_f32 v[126:127], v[126:127], v[158:159]
    v_cvt_pk_bf16_f32 v116, v120, v121
    v_cvt_pk_bf16_f32 v117, v122, v123
    v_cvt_pk_bf16_f32 v118, v124, v125
    v_cvt_pk_bf16_f32 v119, v126, v127
    v_cndmask_b32 v116, v116, v9, s[60:61]
    v_cndmask_b32 v117, v117, v9, s[60:61]
    v_cndmask_b32 v118, v118, v9, s[60:61]
    v_cndmask_b32 v119, v119, v9, s[60:61]
    v_mfma_f32_32x32x16_bf16 v[144:159], v[96:99], v[112:115], 0
    s_nop 0
    v_mfma_f32_32x32x16_bf16 v[144:159], v[100:103], v[116:119], v[144:159]
    s_mov_b32 s52, 0x80808080
    s_mov_b32 s53, 0x80808080
    s_nop 9
    ds_write_b128 v11, v[144:147] offset:0
    ds_write_b128 v11, v[148:151] offset:1024
    ds_write_b128 v11, v[152:155] offset:2048
    ds_write_b128 v11, v[156:159] offset:3072
    v_lshlrev_b32 v11, 3, v0
    s_waitcnt lgkmcnt(0)
    s_barrier
    ds_read_b128 v[96:99], v172 offset:0
    ds_read_b128 v[100:103], v172 offset:4096
    ds_read_b128 v[104:107], v172 offset:8192
    ds_read_b128 v[108:111], v172 offset:12288
    s_waitcnt lgkmcnt(2)
    v_pk_add_f32 v[96:97], v[96:97], v[100:101]
    v_pk_add_f32 v[98:99], v[98:99], v[102:103]
    s_waitcnt lgkmcnt(0)
    v_pk_add_f32 v[104:105], v[104:105], v[108:109]
    v_pk_add_f32 v[106:107], v[106:107], v[110:111]
    v_pk_add_f32 v[96:97], v[96:97], v[104:105]
    v_pk_add_f32 v[98:99], v[98:99], v[106:107]
    v_cvt_pk_bf16_f32 v96, v96, v97
    v_cvt_pk_bf16_f32 v97, v98, v99
    v_cndmask_b32 v96, v96, v4, s[52:53]
    v_cndmask_b32 v97, v97, v4, s[52:53]
    buffer_store_dwordx2 v[96:97], v11, s[40:43], s79 offen sc1
    v_lshrrev_b32 v13, 5, v0
    v_mul_u32_u24 v13, 8, v13
    v_bfe_u32 v11, v0, 2, 2
    v_add_u32 v13, v13, v11
    v_mul_u32_u24 v13, 64, v13
    v_bfe_u32 v11, v0, 4, 1
    v_lshl_add_u32 v13, v11, 5, v13
    v_and_b32 v11, 3, v0
    v_lshl_add_u32 v13, v11, 3, v13
    v_add_u32 v13, 57344, v13
    v_mov_b32 v224, 0x3f803f80
    v_mov_b32 v225, 0x3f803f80
    v_mov_b32 v226, 0x3f803f80
    v_mov_b32 v227, 0x3f803f80
    s_mul_i32 s51, s46, 7168
    v_add_u32 v3, s51, v13
    s_cmp_lt_u32 s45, 14
    s_cselect_b32 s14, s14, 0
    v_lshrrev_b32 v112, 2, v0
    v_mul_u32_u24 v112, 3584, v112
    v_and_b32 v11, 3, v0
    v_lshl_add_u32 v112, v11, 4, v112
    s_lshl_b32 s56, s45, 2
    s_add_u32 s56, s56, s46
    s_lshl_b32 s56, s56, 6
    v_add_u32 v112, s56, v112
    s_mul_i32 s54, s46, 14336
    s_add_u32 s54, s54, 86016
    s_mul_i32 s87, s46, 21504
    s_mul_i32 s59, s67, 802816
    s_and_b32 s51, s44, 1
    s_mul_i32 s4, s51, 7168
    s_mul_i32 s5, s51, 401408
    s_sub_u32 s6, 7168, s4
    s_sub_u32 s7, 401408, s5
    s_add_u32 s4, s4, s54
    s_add_u32 s6, s6, s54
    s_add_u32 s5, s5, s59
    s_add_u32 s7, s7, s59
    s_add_u32 m0, s4, 0
    s_add_u32 s86, s5, 0
    buffer_load_dwordx4 v112, s[12:15], s86 offen lds
    s_add_u32 m0, s4, 1024
    s_add_u32 s86, s5, 57344
    buffer_load_dwordx4 v112, s[12:15], s86 offen lds
    s_add_u32 m0, s4, 2048
    s_add_u32 s86, s5, 114688
    buffer_load_dwordx4 v112, s[12:15], s86 offen lds
    s_add_u32 m0, s4, 3072
    s_add_u32 s86, s5, 172032
    buffer_load_dwordx4 v112, s[12:15], s86 offen lds
    s_add_u32 m0, s4, 4096
    s_add_u32 s86, s5, 229376
    buffer_load_dwordx4 v112, s[12:15], s86 offen lds
    s_add_u32 m0, s4, 5120
    s_add_u32 s86, s5, 286720
    buffer_load_dwordx4 v112, s[12:15], s86 offen lds
    s_add_u32 m0, s4, 6144
    s_add_u32 s86, s5, 344064
    buffer_load_dwordx4 v112, s[12:15], s86 offen lds
    s_waitcnt vmcnt(13)
    s_barrier
    ds_read_b64_tr_b16 v[144:145], v13 offset:0
    ds_read_b64_tr_b16 v[146:147], v13 offset:256
    ds_read_b64_tr_b16 v[148:149], v13 offset:1024
    ds_read_b64_tr_b16 v[150:151], v13 offset:1280
    ds_read_b64_tr_b16 v[152:153], v13 offset:2048
    ds_read_b64_tr_b16 v[154:155], v13 offset:2304
    ds_read_b64_tr_b16 v[156:157], v13 offset:3072
    ds_read_b64_tr_b16 v[158:159], v13 offset:3328
    s_waitcnt lgkmcnt(4)
    v_mfma_f32_32x32x16_bf16 v[128:143], v[144:147], v[16:19], 0
    ds_read_b64_tr_b16 v[144:145], v13 offset:4096
    ds_read_b64_tr_b16 v[146:147], v13 offset:4352
    v_accvgpr_read_b32 v160, a216
    v_accvgpr_read_b32 v161, a217
    v_mfma_f32_32x32x16_bf16 v[128:143], v[148:151], v[20:23], v[128:143]
    ds_read_b64_tr_b16 v[148:149], v13 offset:5120
    ds_read_b64_tr_b16 v[150:151], v13 offset:5376
    v_accvgpr_read_b32 v162, a218
    v_accvgpr_read_b32 v163, a219
    s_waitcnt lgkmcnt(4)
    v_mfma_f32_32x32x16_bf16 v[128:143], v[152:155], v[24:27], v[128:143]
    ds_read_b64_tr_b16 v[152:153], v13 offset:6144
    ds_read_b64_tr_b16 v[154:155], v13 offset:6400
    v_accvgpr_read_b32 v164, a220
    v_accvgpr_read_b32 v165, a221
    v_mfma_f32_32x32x16_bf16 v[128:143], v[156:159], v[28:31], v[128:143]
    ds_read_b64_tr_b16 v[156:157], v13 offset:7168
    ds_read_b64_tr_b16 v[158:159], v13 offset:7424
    v_accvgpr_read_b32 v166, a222
    v_accvgpr_read_b32 v167, a223
    s_waitcnt lgkmcnt(4)
    v_mfma_f32_32x32x16_bf16 v[128:143], v[144:147], v[32:35], v[128:143]
    ds_read_b64_tr_b16 v[144:145], v13 offset:8192
    ds_read_b64_tr_b16 v[146:147], v13 offset:8448
    s_add_u32 m0, s6, 0
    s_add_u32 s86, s7, 0
    buffer_load_dwordx4 v112, s[12:15], s86 offen lds
    v_add_u32 v115, s87, v1
    ds_read_b128 a[140:143], v115 offset:0
    v_mfma_f32_32x32x16_bf16 v[128:143], v[148:151], v[36:39], v[128:143]
    ds_read_b64_tr_b16 v[148:149], v13 offset:9216
    ds_read_b64_tr_b16 v[150:151], v13 offset:9472
    ds_read_b128 a[144:147], v115 offset:1024
    ds_read_b128 a[148:151], v115 offset:2048
    ds_read_b128 a[152:155], v115 offset:3072
    s_waitcnt lgkmcnt(8)
    v_mfma_f32_32x32x16_bf16 v[128:143], v[152:155], v[40:43], v[128:143]
    ds_read_b64_tr_b16 v[152:153], v13 offset:10240
    ds_read_b64_tr_b16 v[154:155], v13 offset:10496
    s_add_u32 m0, s6, 1024
    s_add_u32 s86, s7, 57344
    buffer_load_dwordx4 v112, s[12:15], s86 offen lds
    ds_read_b128 a[156:159], v115 offset:4096
    ds_read_b128 a[160:163], v115 offset:5120
    v_mfma_f32_32x32x16_bf16 v[128:143], v[156:159], v[44:47], v[128:143]
    ds_read_b64_tr_b16 v[156:157], v13 offset:11264
    ds_read_b64_tr_b16 v[158:159], v13 offset:11520
    ds_read_b128 a[164:167], v115 offset:6144
    ds_read_b128 a[168:171], v115 offset:7168
    s_waitcnt lgkmcnt(11)
    v_mfma_f32_32x32x16_bf16 v[128:143], v[144:147], v[48:51], v[128:143]
    ds_read_b64_tr_b16 v[144:145], v13 offset:12288
    ds_read_b64_tr_b16 v[146:147], v13 offset:12544
    s_add_u32 m0, s6, 2048
    s_add_u32 s86, s7, 114688
    buffer_load_dwordx4 v112, s[12:15], s86 offen lds
    ds_read_b128 a[172:175], v115 offset:8192
    ds_read_b128 a[176:179], v115 offset:9216
    v_mfma_f32_32x32x16_bf16 v[128:143], v[148:151], v[52:55], v[128:143]
    ds_read_b64_tr_b16 v[148:149], v13 offset:13312
    ds_read_b64_tr_b16 v[150:151], v13 offset:13568
    ds_read_b128 a[180:183], v115 offset:10240
    ds_read_b128 a[184:187], v115 offset:11264
    s_waitcnt lgkmcnt(10)
    v_mfma_f32_32x32x16_bf16 v[128:143], v[152:155], v[56:59], v[128:143]
    ds_read_b64_tr_b16 v[152:153], v13 offset:14336
    ds_read_b64_tr_b16 v[154:155], v13 offset:14592
    s_add_u32 m0, s6, 3072
    s_add_u32 s86, s7, 172032
    buffer_load_dwordx4 v112, s[12:15], s86 offen lds
    ds_read_b128 a[188:191], v115 offset:12288
    ds_read_b128 a[192:195], v115 offset:13312
    v_mfma_f32_32x32x16_bf16 v[128:143], v[156:159], v[60:63], v[128:143]
    ds_read_b64_tr_b16 v[156:157], v13 offset:15360
    ds_read_b64_tr_b16 v[158:159], v13 offset:15616
    ds_read_b128 a[196:199], v115 offset:14336
    ds_read_b128 a[200:203], v115 offset:15360
    s_waitcnt lgkmcnt(10)
    v_mfma_f32_32x32x16_bf16 v[128:143], v[144:147], v[64:67], v[128:143]
    ds_read_b64_tr_b16 v[144:145], v13 offset:16384
    ds_read_b64_tr_b16 v[146:147], v13 offset:16640
    s_add_u32 m0, s6, 4096
    s_add_u32 s86, s7, 229376
    buffer_load_dwordx4 v112, s[12:15], s86 offen lds
    ds_read_b128 a[204:207], v115 offset:16384
    ds_read_b128 a[208:211], v115 offset:17408
    v_mfma_f32_32x32x16_bf16 v[128:143], v[148:151], v[68:71], v[128:143]
    ds_read_b64_tr_b16 v[148:149], v13 offset:17408
    ds_read_b64_tr_b16 v[150:151], v13 offset:17664
    ds_read_b128 a[212:215], v115 offset:18432
    ds_read_b128 a[216:219], v115 offset:19456
    s_waitcnt lgkmcnt(10)
    v_mfma_f32_32x32x16_bf16 v[128:143], v[152:155], v[72:75], v[128:143]
    ds_read_b64_tr_b16 v[152:153], v13 offset:18432
    ds_read_b64_tr_b16 v[154:155], v13 offset:18688
    s_add_u32 m0, s6, 5120
    s_add_u32 s86, s7, 286720
    buffer_load_dwordx4 v112, s[12:15], s86 offen lds
    ds_read_b128 a[220:223], v115 offset:20480
    v_mfma_f32_32x32x16_bf16 v[128:143], v[156:159], v[76:79], v[128:143]
    ds_read_b64_tr_b16 v[156:157], v13 offset:19456
    ds_read_b64_tr_b16 v[158:159], v13 offset:19712
    s_cmp_eq_u32 s46, 3
    s_cselect_b32 s88, 0xffff0000, 0
    s_cselect_b32 s89, 0xffff0000, 0
    s_waitcnt lgkmcnt(7)
    v_mfma_f32_32x32x16_bf16 v[128:143], v[144:147], v[80:83], v[128:143]
    ds_read_b64_tr_b16 v[144:145], v13 offset:20480
    ds_read_b64_tr_b16 v[146:147], v13 offset:20736
    s_add_u32 m0, s6, 6144
    s_add_u32 s86, s7, 344064
    buffer_load_dwordx4 v112, s[12:15], s86 offen lds
    v_lshrrev_b32 v101, 5, v0
    v_and_b32 v102, 15, v0
    v_mfma_f32_32x32x16_bf16 v[128:143], v[148:151], v[84:87], v[128:143]
    ds_read_b64_tr_b16 v[148:149], v13 offset:21504
    ds_read_b64_tr_b16 v[150:151], v13 offset:21760
    v_lshl_add_u32 v101, v102, 1, v101
    v_bfe_u32 v100, v0, 4, 1
    v_lshrrev_b32 v102, 3, v101
    s_waitcnt lgkmcnt(4)
    v_mfma_f32_32x32x16_bf16 v[128:143], v[152:155], v[88:91], v[128:143]
    ds_read_b64_tr_b16 v[152:153], v13 offset:22528
    ds_read_b64_tr_b16 v[154:155], v13 offset:22784
    v_sub_u32 v102, v101, v102
    v_and_b32 v101, 7, v101
    v_mfma_f32_32x32x16_bf16 v[128:143], v[156:159], v[92:95], v[128:143]
    ds_read_b64_tr_b16 v[156:157], v13 offset:23552
    ds_read_b64_tr_b16 v[158:159], v13 offset:23808
    v_cmp_eq_u32 vcc, 7, v101
    s_nop 1
    v_cndmask_b32 v102, v102, 31, vcc
    s_waitcnt lgkmcnt(4)
    v_mfma_f32_32x32x16_bf16 v[128:143], v[144:147], v[176:179], v[128:143]
    ds_read_b64_tr_b16 v[144:145], v13 offset:24576
    ds_read_b64_tr_b16 v[146:147], v13 offset:24832
    v_lshl_add_u32 v100, v100, 5, v102
    s_lshl_b32 s53, s46, 3
    v_mfma_f32_32x32x16_bf16 v[128:143], v[148:151], v[180:183], v[128:143]
    ds_read_b64_tr_b16 v[148:149], v13 offset:25600
    ds_read_b64_tr_b16 v[150:151], v13 offset:25856
    v_lshlrev_b32 v100, 5, v100
    v_add_u32 v100, s53, v100
    s_waitcnt lgkmcnt(4)
    v_mfma_f32_32x32x16_bf16 v[128:143], v[152:155], v[184:187], v[128:143]
    ds_read_b64_tr_b16 v[152:153], v13 offset:26624
    ds_read_b64_tr_b16 v[154:155], v13 offset:26880
    v_and_b32 v101, 1, v102
    v_lshlrev_b32 v101, 10, v101
    v_mfma_f32_32x32x16_bf16 v[128:143], v[156:159], v[188:191], v[128:143]
    ds_read_b64_tr_b16 v[156:157], v13 offset:27648
    ds_read_b64_tr_b16 v[158:159], v13 offset:27904
    v_lshrrev_b32 v102, 1, v102
    v_cmp_gt_u32 vcc, 4, v102
    s_waitcnt lgkmcnt(4)
    v_mfma_f32_32x32x16_bf16 v[128:143], v[144:147], v[192:195], v[128:143]
    ds_read_b64_tr_b16 v[144:145], v3 offset:0
    ds_read_b64_tr_b16 v[146:147], v3 offset:256
    v_lshl_add_u32 v101, v102, 3, v101
    v_add_u32 v101, 896, v101
    v_mfma_f32_32x32x16_bf16 v[128:143], v[148:151], v[196:199], v[128:143]
    ds_read_b64_tr_b16 v[148:149], v3 offset:1024
    ds_read_b64_tr_b16 v[150:151], v3 offset:1280
    s_and_b64 vcc, vcc, s[88:89]
    v_cndmask_b32 v100, v100, v101, vcc
    s_waitcnt lgkmcnt(4)
    v_mfma_f32_32x32x16_bf16 v[128:143], v[152:155], v[200:203], v[128:143]
    ds_read_b64_tr_b16 v[152:153], v3 offset:2048
    ds_read_b64_tr_b16 v[154:155], v3 offset:2304
    v_add_u32 v100, 160000, v100
    v_bfe_u32 v101, v0, 3, 1
    v_mfma_f32_32x32x16_bf16 v[128:143], v[156:159], v[204:207], v[128:143]
    ds_read_b64_tr_b16 v[156:157], v3 offset:3072
    ds_read_b64_tr_b16 v[158:159], v3 offset:3328
    v_and_b32 v102, 3, v0
    v_lshl_add_u32 v101, v101, 2, v102
    s_waitcnt lgkmcnt(4)
    v_mfma_f32_32x32x16_bf16 v[208:223], v[224:227], v[144:147], 0
    ds_read_b64_tr_b16 v[144:145], v3 offset:4096
    ds_read_b64_tr_b16 v[146:147], v3 offset:4352
    v_cmp_eq_u32 vcc, 7, v101
    v_bfe_u32 v102, v0, 4, 1
    v_mfma_f32_32x32x16_bf16 v[208:223], v[224:227], v[148:151], v[208:223]
    ds_read_b64_tr_b16 v[148:149], v3 offset:5120
    ds_read_b64_tr_b16 v[150:151], v3 offset:5376
    v_mad_u32_u24 v101, v102, 14, v101
    v_bfe_u32 v102, v0, 2, 1
    v_mad_u32_u24 v101, v102, 7, v101
    s_waitcnt lgkmcnt(4)
    v_mfma_f32_32x32x16_bf16 v[208:223], v[224:227], v[152:155], v[208:223]
    ds_read_b64_tr_b16 v[152:153], v3 offset:6144
    ds_read_b64_tr_b16 v[154:155], v3 offset:6400
    v_cndmask_b32 v101, v101, 28, vcc
    v_and_b32 v102, 32, v0
    v_mfma_f32_32x32x16_bf16 v[208:223], v[224:227], v[156:159], v[208:223]
    v_add_u32 v101, v101, v102
    v_lshlrev_b32 v101, 5, v101
    s_waitcnt lgkmcnt(2)
    v_mfma_f32_32x32x16_bf16 v[208:223], v[224:227], v[144:147], v[208:223]
    v_add_u32 v101, 160000, v101
    s_and_b32 s22, s47, 0x1fff
    v_mfma_f32_32x32x16_bf16 v[208:223], v[224:227], v[148:151], v[208:223]
    s_or_b32 s22, s22, 0x4000
    s_lshl_b32 s23, s22, 16
    s_waitcnt lgkmcnt(0)
    v_mfma_f32_32x32x16_bf16 v[208:223], v[224:227], v[152:155], v[208:223]
    v_mov_b32 v98, 0x3f80
    v_mov_b32 v99, 0x3f800000
    v_and_b32 v228, 31, v0
    v_lshlrev_b32 v228, 2, v228
    v_add_u32 v228, 143616, v228
    s_lshl_b32 s51, s46, 7
    v_add_u32 v229, s51, v228
    s_nop 4
    ds_write_b32 v229, v208
    v_mov_b32 v230, v10
    s_lshl_b32 s55, s44, 11
    s_add_u32 s55, s55, 32768
    v_and_b32 v10, 15, v0
    v_lshlrev_b32 v10, 7, v10
    buffer_load_dword v9, v10, s[40:43], s55 offen sc1
    s_waitcnt lgkmcnt(0)
    s_barrier
    s_cmp_ge_u32 s45, 14
    s_cbranch_scc1 Lnw_5
    s_add_u32 m0, s87, 0
    s_sub_u32 s86, 802816, s59
    buffer_load_dwordx4 v112, s[12:15], s86 offen lds
Lnw_5:
    ds_read_b32 v148, v228 offset:0
    ds_read_b32 v149, v228 offset:128
    ds_read_b32 v150, v228 offset:256
    ds_read_b32 v151, v228 offset:384
    s_waitcnt lgkmcnt(2)
    v_add_f32 v148, v148, v149
    s_waitcnt lgkmcnt(0)
    v_add_f32 v150, v150, v151
    v_add_f32 v148, v148, v150
    v_cvt_pk_bf16_f32 v144, v148, v148
    v_and_b32 v149, 0xffff0000, v144
    v_sub_f32 v149, v148, v149
    v_cvt_pk_bf16_f32 v145, v149, 0
    v_mov_b32 v146, 0
    v_mov_b32 v147, 0
    ds_write_b64 v230, v[144:145]
    s_nop 0
    v_mfma_f32_32x32x16_bf16 v[128:143], v[144:147], v[168:171], v[128:143]
    s_nop 11
    v_pk_mul_f32 v[128:129], v[128:129], v[6:7] op_sel_hi:[1,0]
    v_pk_mul_f32 v[130:131], v[130:131], v[6:7] op_sel_hi:[1,0]
    v_pk_mul_f32 v[132:133], v[132:133], v[6:7] op_sel_hi:[1,0]
    v_pk_mul_f32 v[134:135], v[134:135], v[6:7] op_sel_hi:[1,0]
    v_exp_f32 v32, v128 clamp
    v_max_f32 v128, 0, v128
    v_exp_f32 v33, v129 clamp
    v_max_f32 v129, 0, v129
    v_exp_f32 v34, v130 clamp
    s_cmp_ge_u32 s45, 14
    s_cbranch_scc1 Lnw_6
    s_add_u32 m0, s87, 1024
    s_sub_u32 s86, 860160, s59
    buffer_load_dwordx4 v112, s[12:15], s86 offen lds
Lnw_6:
    v_max_f32 v130, 0, v130
    v_exp_f32 v35, v131 clamp
    v_max_f32 v131, 0, v131
    v_exp_f32 v36, v132 clamp
    v_max_f32 v132, 0, v132
    v_exp_f32 v37, v133 clamp
    v_max_f32 v133, 0, v133
    v_exp_f32 v38, v134 clamp
    v_max_f32 v134, 0, v134
    v_exp_f32 v39, v135 clamp
    v_max_f32 v135, 0, v135
    v_pk_fma_f32 v[128:129], v[128:129], s[56:57], v[32:33] op_sel:[0,1,0] op_sel_hi:[1,1,1]
    v_pk_fma_f32 v[130:131], v[130:131], s[56:57], v[34:35] op_sel:[0,1,0] op_sel_hi:[1,1,1]
    v_pk_fma_f32 v[132:133], v[132:133], s[56:57], v[36:37] op_sel:[0,1,0] op_sel_hi:[1,1,1]
    v_pk_fma_f32 v[134:135], v[134:135], s[56:57], v[38:39] op_sel:[0,1,0] op_sel_hi:[1,1,1]
    v_pk_add_f32 v[128:129], v[128:129], v[12:13] op_sel_hi:[1,0]
    v_pk_add_f32 v[130:131], v[130:131], v[12:13] op_sel_hi:[1,0]
    v_pk_add_f32 v[132:133], v[132:133], v[12:13] op_sel_hi:[1,0]
    v_pk_add_f32 v[134:135], v[134:135], v[12:13] op_sel_hi:[1,0]
    v_cvt_pk_bf16_f32 v104, v128, v129
    v_cvt_pk_bf16_f32 v105, v130, v131
    v_cvt_pk_bf16_f32 v106, v132, v133
    v_cvt_pk_bf16_f32 v107, v134, v135
    s_cmp_ge_u32 s45, 14
    s_cbranch_scc1 Lnw_7
    s_add_u32 m0, s87, 2048
    s_sub_u32 s86, 917504, s59
    buffer_load_dwordx4 v112, s[12:15], s86 offen lds
Lnw_7:
    v_pk_mul_f32 v[136:137], v[136:137], v[6:7] op_sel_hi:[1,0]
    v_pk_mul_f32 v[138:139], v[138:139], v[6:7] op_sel_hi:[1,0]
    v_pk_mul_f32 v[140:141], v[140:141], v[6:7] op_sel_hi:[1,0]
    v_pk_mul_f32 v[142:143], v[142:143], v[6:7] op_sel_hi:[1,0]
    v_exp_f32 v32, v136 clamp
    v_max_f32 v136, 0, v136
    v_exp_f32 v33, v137 clamp
    v_max_f32 v137, 0, v137
    v_exp_f32 v34, v138 clamp
    v_max_f32 v138, 0, v138
    v_exp_f32 v35, v139 clamp
    v_max_f32 v139, 0, v139
    v_exp_f32 v36, v140 clamp
    v_max_f32 v140, 0, v140
    v_exp_f32 v37, v141 clamp
    v_max_f32 v141, 0, v141
    v_exp_f32 v38, v142 clamp
    v_max_f32 v142, 0, v142
    v_exp_f32 v39, v143 clamp
    v_max_f32 v143, 0, v143
    v_pk_fma_f32 v[136:137], v[136:137], s[56:57], v[32:33] op_sel:[0,1,0] op_sel_hi:[1,1,1]
    s_cmp_ge_u32 s45, 14
    s_cbranch_scc1 Lnw_8
    s_add_u32 m0, s87, 3072
    s_sub_u32 s86, 974848, s59
    buffer_load_dwordx4 v112, s[12:15], s86 offen lds
Lnw_8:
    v_pk_fma_f32 v[138:139], v[138:139], s[56:57], v[34:35] op_sel:[0,1,0] op_sel_hi:[1,1,1]
    v_pk_fma_f32 v[140:141], v[140:141], s[56:57], v[36:37] op_sel:[0,1,0] op_sel_hi:[1,1,1]
    v_pk_fma_f32 v[142:143], v[142:143], s[56:57], v[38:39] op_sel:[0,1,0] op_sel_hi:[1,1,1]
    v_pk_add_f32 v[136:137], v[136:137], v[12:13] op_sel_hi:[1,0]
    v_pk_add_f32 v[138:139], v[138:139], v[12:13] op_sel_hi:[1,0]
    v_pk_add_f32 v[140:141], v[140:141], v[12:13] op_sel_hi:[1,0]
    v_pk_add_f32 v[142:143], v[142:143], v[12:13] op_sel_hi:[1,0]
    v_cvt_pk_bf16_f32 v108, v136, v137
    v_cvt_pk_bf16_f32 v109, v138, v139
    v_cvt_pk_bf16_f32 v110, v140, v141
    v_cvt_pk_bf16_f32 v111, v142, v143
    v_cndmask_b32 v110, v110, 0, s[62:63]
    v_cndmask_b32 v111, v111, 0, s[62:63]
    v_lshrrev_b32 v114, 5, v0
    v_mul_u32_u24 v114, 4, v114
    v_bfe_u32 v11, v0, 2, 2
    v_add_u32 v114, v114, v11
    v_mul_u32_u24 v114, 64, v114
    v_bfe_u32 v11, v0, 4, 1
    v_lshl_add_u32 v114, v11, 5, v114
    v_and_b32 v11, 3, v0
    v_lshl_add_u32 v114, v11, 3, v114
    v_add_u32 v113, s54, v114
    v_add_u32 v114, s87, v114
    v_mov_b32 v124, 0x3f803f80
    v_mov_b32 v125, 0x3f803f80
    v_mov_b32 v126, 0x3f803f80
    v_mov_b32 v127, 0x3f803f80
    s_add_u32 s86, s78, 0
    buffer_load_dwordx4 v[48:51], v1, s[40:43], s86 offen offset:0 sc1
    buffer_load_dwordx4 v[52:55], v1, s[40:43], s86 offen offset:1024 sc1
    buffer_load_dwordx4 v[56:59], v1, s[40:43], s86 offen offset:2048 sc1
    buffer_load_dwordx4 v[60:63], v1, s[40:43], s86 offen offset:3072 sc1
    s_add_u32 s86, s78, 4096
    buffer_load_dwordx4 v[64:67], v1, s[40:43], s86 offen offset:0 sc1
    buffer_load_dwordx4 v[68:71], v1, s[40:43], s86 offen offset:1024 sc1
    buffer_load_dwordx4 v[72:75], v1, s[40:43], s86 offen offset:2048 sc1
    buffer_load_dwordx4 v[76:79], v1, s[40:43], s86 offen offset:3072 sc1
    s_cmp_ge_u32 s45, 14
    s_cbranch_scc1 Lnostage_3
    v_and_b32 v11, 31, v0
    v_lshlrev_b32 v11, 1, v11
    buffer_load_ushort v116, v11, s[28:31], s56 offen
    v_lshrrev_b32 v11, 5, v0
    v_lshlrev_b32 v11, 3, v11
    s_lshl_b32 s53, s73, 5
    buffer_load_dwordx2 v[168:169], v11, s[32:35], s53 offen
    buffer_load_dwordx2 v[170:171], v11, s[32:35], s53 offen offset:16
    s_add_u32 m0, s87, 4096
    s_sub_u32 s86, 1032192, s59
    buffer_load_dwordx4 v112, s[12:15], s86 offen lds
    s_waitcnt vmcnt(17)
    ds_read_b64_tr_b16 a[224:225], v113 offset:0
    ds_read_b64_tr_b16 a[226:227], v113 offset:512
    s_add_u32 m0, s87, 5120
    s_sub_u32 s86, 1089536, s59
    buffer_load_dwordx4 v112, s[12:15], s86 offen lds
    ds_read_b64_tr_b16 a[228:229], v113 offset:1024
    ds_read_b64_tr_b16 a[230:231], v113 offset:1536
    s_add_u32 m0, s87, 6144
    s_sub_u32 s86, 1146880, s59
    buffer_load_dwordx4 v112, s[12:15], s86 offen lds
    ds_read_b64_tr_b16 a[232:233], v113 offset:2048
    ds_read_b64_tr_b16 a[234:235], v113 offset:2560
    s_waitcnt lgkmcnt(4)
    v_mfma_f32_32x32x16_bf16 v[128:143], v[124:127], a[224:227], 0
    s_add_u32 m0, s87, 7168
    s_sub_u32 s86, 1204224, s59
    buffer_load_dwordx4 v112, s[12:15], s86 offen lds
    ds_read_b64_tr_b16 a[236:237], v113 offset:3072
    ds_read_b64_tr_b16 a[238:239], v113 offset:3584
    s_waitcnt lgkmcnt(4)
    v_mfma_f32_32x32x16_bf16 v[128:143], v[124:127], a[228:231], v[128:143]
    s_add_u32 m0, s87, 8192
    s_sub_u32 s86, 1261568, s59
    buffer_load_dwordx4 v112, s[12:15], s86 offen lds
    ds_read_b64_tr_b16 a[240:241], v113 offset:4096
    ds_read_b64_tr_b16 a[242:243], v113 offset:4608
    s_waitcnt lgkmcnt(4)
    v_mfma_f32_32x32x16_bf16 v[128:143], v[124:127], a[232:235], v[128:143]
    s_add_u32 m0, s87, 9216
    s_sub_u32 s86, 1318912, s59
    buffer_load_dwordx4 v112, s[12:15], s86 offen lds
    ds_read_b64_tr_b16 a[244:245], v113 offset:5120
    ds_read_b64_tr_b16 a[246:247], v113 offset:5632
    s_waitcnt lgkmcnt(4)
    v_mfma_f32_32x32x16_bf16 v[128:143], v[124:127], a[236:239], v[128:143]
    s_add_u32 m0, s87, 10240
    s_sub_u32 s86, 1376256, s59
    buffer_load_dwordx4 v112, s[12:15], s86 offen lds
    ds_read_b64_tr_b16 a[248:249], v113 offset:6144
    ds_read_b64_tr_b16 a[250:251], v113 offset:6656
    s_waitcnt lgkmcnt(4)
    v_mfma_f32_32x32x16_bf16 v[128:143], v[124:127], a[240:243], v[128:143]
    s_add_u32 m0, s87, 11264
    s_sub_u32 s86, 1433600, s59
    buffer_load_dwordx4 v112, s[12:15], s86 offen lds
    ds_read_b64_tr_b16 a[252:253], v113 offset:7168
    ds_read_b64_tr_b16 a[254:255], v113 offset:7680
    s_waitcnt lgkmcnt(4)
    v_mfma_f32_32x32x16_bf16 v[128:143], v[124:127], a[244:247], v[128:143]
    s_add_u32 m0, s87, 12288
    s_sub_u32 s86, 1490944, s59
    buffer_load_dwordx4 v112, s[12:15], s86 offen lds
    ds_read_b64_tr_b16 v[176:177], v113 offset:8192
    ds_read_b64_tr_b16 v[178:179], v113 offset:8704
    s_waitcnt lgkmcnt(4)
    v_mfma_f32_32x32x16_bf16 v[128:143], v[124:127], a[248:251], v[128:143]
    s_add_u32 m0, s87, 13312
    s_sub_u32 s86, 1548288, s59
    buffer_load_dwordx4 v112, s[12:15], s86 offen lds
    ds_read_b64_tr_b16 v[180:181], v113 offset:9216
    ds_read_b64_tr_b16 v[182:183], v113 offset:9728
    s_waitcnt lgkmcnt(4)
    v_mfma_f32_32x32x16_bf16 v[128:143], v[124:127], a[252:255], v[128:143]
    ds_read_b64_tr_b16 v[184:185], v113 offset:10240
    ds_read_b64_tr_b16 v[186:187], v113 offset:10752
    s_waitcnt lgkmcnt(4)
    v_mfma_f32_32x32x16_bf16 v[128:143], v[124:127], v[176:179], v[128:143]
    ds_read_b64_tr_b16 v[188:189], v113 offset:11264
    ds_read_b64_tr_b16 v[190:191], v113 offset:11776
    s_waitcnt lgkmcnt(4)
    v_mfma_f32_32x32x16_bf16 v[128:143], v[124:127], v[180:183], v[128:143]
    ds_read_b64_tr_b16 v[192:193], v113 offset:12288
    ds_read_b64_tr_b16 v[194:195], v113 offset:12800
    s_waitcnt lgkmcnt(4)
    v_mfma_f32_32x32x16_bf16 v[128:143], v[124:127], v[184:187], v[128:143]
    ds_read_b64_tr_b16 v[196:197], v113 offset:13312
    ds_read_b64_tr_b16 v[198:199], v113 offset:13824
    s_waitcnt lgkmcnt(4)
    v_mfma_f32_32x32x16_bf16 v[128:143], v[124:127], v[188:191], v[128:143]
    s_waitcnt lgkmcnt(2)
    v_mfma_f32_32x32x16_bf16 v[128:143], v[124:127], v[192:195], v[128:143]
    s_waitcnt lgkmcnt(0)
    v_mfma_f32_32x32x16_bf16 v[128:143], v[124:127], v[196:199], v[128:143]
Lstaged_4:
    s_nop 1
    s_waitcnt vmcnt(25)
    v_subrev_u32 v9, s47, v9
    v_cmp_lt_u32 vcc, 15, v9
    s_cbranch_vccnz Lxcc_10
Lxok_11:
    v_cmp_ne_u32 vcc, s58, v9
    s_cmp_lg_u64 vcc, 0
    s_cselect_b32 s48, 1, 0
    s_mov_b32 s66, 131072
    s_cselect_b32 s66, 720896, s66
    v_and_b32 v10, 15, v0
    v_lshlrev_b32 v10, 11, v10
    v_add_u32 v10, 2044, v10
    v_lshrrev_b32 v3, 5, v0
    v_mul_u32_u24 v3, 7, v3
    v_bfe_u32 v11, v0, 2, 2
    v_add_u32 v3, v3, v11
    v_mul_u32_u24 v3, 64, v3
    v_bfe_u32 v11, v0, 4, 1
    v_lshl_add_u32 v3, v11, 5, v3
    v_and_b32 v11, 3, v0
    v_lshl_add_u32 v3, v11, 3, v3
    v_add_u32 v3, 114688, v3
    v_lshrrev_b32 v172, 5, v0
    v_lshlrev_b32 v172, 2, v172
    v_and_b32 v173, 31, v0
    v_sub_u32 v120, v173, v172
    v_mov_b32 v121, 0x3f80
    v_mov_b32 v122, 0x3f800000
    v_cmp_eq_u32 vcc, 0, v120
    v_cmp_eq_u32 s[88:89], 1, v120
    s_nop 0
    v_cndmask_b32 v172, 0, v121, vcc
    v_cndmask_b32 v172, v172, v122, s[88:89]
    v_cmp_eq_u32 vcc, 2, v120
    v_cmp_eq_u32 s[88:89], 3, v120
    s_nop 0
    v_cndmask_b32 v173, 0, v121, vcc
    v_cndmask_b32 v173, v173, v122, s[88:89]
    v_cmp_eq_u32 vcc, 8, v120
    v_cmp_eq_u32 s[88:89], 9, v120
    s_nop 0
    v_cndmask_b32 v174, 0, v121, vcc
    v_cndmask_b32 v174, v174, v122, s[88:89]
    v_cmp_eq_u32 vcc, 10, v120
    v_cmp_eq_u32 s[88:89], 11, v120
    s_nop 0
    v_cndmask_b32 v175, 0, v121, vcc
    v_cndmask_b32 v175, v175, v122, s[88:89]
    s_lshl_b32 s51, s68, 15
    s_lshl_b32 s53, s73, 10
    s_add_u32 s51, s51, s53
    s_add_u32 s34, s51, 131072
    s_add_u32 s28, s51, s66
    s_lshl_b32 s51, s68, 13
    s_lshr_b32 s53, s73, 2
    s_lshl_b32 s53, s53, 10
    s_add_u32 s51, s51, s53
    s_and_b32 s53, s73, 3
    s_lshl_b32 s53, s53, 2
    s_add_u32 s51, s51, s53
    s_add_u32 s30, s51, 851968
    s_lshl_b32 s53, s68, 5
    s_add_u32 s53, s53, s73
    s_lshl_b32 s53, s53, 2
    s_add_u32 s32, s53, 885760
    s_lshl_b32 s51, s69, 15
    s_lshl_b32 s53, s73, 10
    s_add_u32 s51, s51, s53
    s_add_u32 s35, s51, 131072
    s_add_u32 s29, s51, s66
    s_lshl_b32 s51, s69, 13
    s_lshr_b32 s53, s73, 2
    s_lshl_b32 s53, s53, 10
    s_add_u32 s51, s51, s53
    s_and_b32 s53, s73, 3
    s_lshl_b32 s53, s53, 2
    s_add_u32 s51, s51, s53
    s_add_u32 s31, s51, 851968
    s_lshl_b32 s53, s69, 5
    s_add_u32 s53, s53, s73
    s_lshl_b32 s53, s53, 2
    s_add_u32 s33, s53, 885760
    s_add_u32 s55, s75, 131072
    s_lshr_b32 s56, s45, 2
    s_lshl_b32 s56, s56, 10
    s_and_b32 s52, s45, 3
    s_lshl_b32 s52, s52, 2
    s_add_u32 s56, s56, s52
    s_add_u32 s56, s56, s74
    s_add_u32 s56, s56, 159744
    v_and_b32 v31, 0xffff0000, v167
    v_lshlrev_b32 v30, 16, v167
    v_and_b32 v29, 0xffff0000, v166
    v_lshlrev_b32 v28, 16, v166
    v_and_b32 v27, 0xffff0000, v165
    v_lshlrev_b32 v26, 16, v165
    v_and_b32 v25, 0xffff0000, v164
    v_lshlrev_b32 v24, 16, v164
    v_and_b32 v23, 0xffff0000, v163
    v_lshlrev_b32 v22, 16, v163
    v_and_b32 v21, 0xffff0000, v162
    v_lshlrev_b32 v20, 16, v162
    v_and_b32 v19, 0xffff0000, v161
    v_lshlrev_b32 v18, 16, v161
    v_and_b32 v17, 0xffff0000, v160
    v_lshlrev_b32 v16, 16, v160
    s_mov_b32 s88, 0x88888888
    s_mov_b32 s89, 0x88888888
Lsweep_12:
    v_mov_b32 v11, 0
    s_waitcnt vmcnt(20)
    v_dot2_f32_bf16 v80, v48, v98, 0
    v_dot2_f32_bf16 v81, v48, v99, 0
    v_dot2_f32_bf16 v82, v49, v98, 0
    v_dot2_f32_bf16 v83, v49, v99, 0
    v_dot2_f32_bf16 v84, v50, v98, 0
    v_dot2_f32_bf16 v85, v50, v99, 0
    v_dot2_f32_bf16 v86, v51, v98, 0
    v_dot2_f32_bf16 v87, v51, v99, 0
    v_bitop3_b32 v11, v50, s47, v11 bitop3:0xbe
    v_bitop3_b32 v11, v51, s47, v11 bitop3:0xbe
    s_waitcnt vmcnt(19)
    v_dot2_f32_bf16 v80, v52, v98, v80
    v_dot2_f32_bf16 v81, v52, v99, v81
    v_dot2_f32_bf16 v82, v53, v98, v82
    v_dot2_f32_bf16 v83, v53, v99, v83
    v_dot2_f32_bf16 v84, v54, v98, v84
    v_dot2_f32_bf16 v85, v54, v99, v85
    v_dot2_f32_bf16 v86, v55, v98, v86
    v_dot2_f32_bf16 v87, v55, v99, v87
    v_bitop3_b32 v11, v54, s47, v11 bitop3:0xbe
    v_bitop3_b32 v11, v55, s47, v11 bitop3:0xbe
    s_waitcnt vmcnt(18)
    v_dot2_f32_bf16 v80, v56, v98, v80
    v_dot2_f32_bf16 v81, v56, v99, v81
    v_dot2_f32_bf16 v82, v57, v98, v82
    v_dot2_f32_bf16 v83, v57, v99, v83
    v_dot2_f32_bf16 v84, v58, v98, v84
    v_dot2_f32_bf16 v85, v58, v99, v85
    v_dot2_f32_bf16 v86, v59, v98, v86
    v_dot2_f32_bf16 v87, v59, v99, v87
    v_bitop3_b32 v11, v58, s47, v11 bitop3:0xbe
    v_bitop3_b32 v11, v59, s47, v11 bitop3:0xbe
    s_waitcnt vmcnt(17)
    v_dot2_f32_bf16 v80, v60, v98, v80
    v_dot2_f32_bf16 v81, v60, v99, v81
    v_dot2_f32_bf16 v82, v61, v98, v82
    v_dot2_f32_bf16 v83, v61, v99, v83
    v_dot2_f32_bf16 v84, v62, v98, v84
    v_dot2_f32_bf16 v85, v62, v99, v85
    v_dot2_f32_bf16 v86, v63, v98, v86
    v_dot2_f32_bf16 v87, v63, v99, v87
    v_bitop3_b32 v11, v62, s47, v11 bitop3:0xbe
    v_bitop3_b32 v11, v63, s47, v11 bitop3:0xbe
    s_waitcnt vmcnt(16)
    v_dot2_f32_bf16 v80, v64, v98, v80
    v_dot2_f32_bf16 v81, v64, v99, v81
    v_dot2_f32_bf16 v82, v65, v98, v82
    v_dot2_f32_bf16 v83, v65, v99, v83
    v_dot2_f32_bf16 v84, v66, v98, v84
    v_dot2_f32_bf16 v85, v66, v99, v85
    v_dot2_f32_bf16 v86, v67, v98, v86
    v_dot2_f32_bf16 v87, v67, v99, v87
    v_bitop3_b32 v11, v66, s47, v11 bitop3:0xbe
    v_bitop3_b32 v11, v67, s47, v11 bitop3:0xbe
    s_waitcnt vmcnt(15)
    v_dot2_f32_bf16 v80, v68, v98, v80
    v_dot2_f32_bf16 v81, v68, v99, v81
    v_dot2_f32_bf16 v82, v69, v98, v82
    v_dot2_f32_bf16 v83, v69, v99, v83
    v_dot2_f32_bf16 v84, v70, v98, v84
    v_dot2_f32_bf16 v85, v70, v99, v85
    v_dot2_f32_bf16 v86, v71, v98, v86
    v_dot2_f32_bf16 v87, v71, v99, v87
    v_bitop3_b32 v11, v70, s47, v11 bitop3:0xbe
    v_bitop3_b32 v11, v71, s47, v11 bitop3:0xbe
    s_waitcnt vmcnt(14)
    v_dot2_f32_bf16 v80, v72, v98, v80
    v_dot2_f32_bf16 v81, v72, v99, v81
    v_dot2_f32_bf16 v82, v73, v98, v82
    v_dot2_f32_bf16 v83, v73, v99, v83
    v_dot2_f32_bf16 v84, v74, v98, v84
    v_dot2_f32_bf16 v85, v74, v99, v85
    v_dot2_f32_bf16 v86, v75, v98, v86
    v_dot2_f32_bf16 v87, v75, v99, v87
    v_bitop3_b32 v11, v74, s47, v11 bitop3:0xbe
    v_bitop3_b32 v11, v75, s47, v11 bitop3:0xbe
    s_waitcnt vmcnt(13)
    v_dot2_f32_bf16 v80, v76, v98, v80
    v_dot2_f32_bf16 v81, v76, v99, v81
    v_dot2_f32_bf16 v82, v77, v98, v82
    v_dot2_f32_bf16 v83, v77, v99, v83
    v_dot2_f32_bf16 v84, v78, v98, v84
    v_dot2_f32_bf16 v85, v78, v99, v85
    v_dot2_f32_bf16 v86, v79, v98, v86
    v_dot2_f32_bf16 v87, v79, v99, v87
    v_bitop3_b32 v11, v78, s47, v11 bitop3:0xbe
    v_bitop3_b32 v11, v79, s47, v11 bitop3:0xbe
    v_cmp_ne_u32 vcc, 0, v11
    s_and_b64 vcc, vcc, s[88:89]
    s_cbranch_vccnz Lresweep_13
    v_permlane32_swap_b32 v80, v84
    v_permlane32_swap_b32 v81, v85
    v_permlane32_swap_b32 v82, v86
    v_permlane32_swap_b32 v83, v87
    v_pk_add_f32 v[80:81], v[80:81], v[84:85]
    v_pk_add_f32 v[82:83], v[82:83], v[86:87]
    v_cvt_pk_bf16_f32 v80, v80, v81
    v_cvt_pk_bf16_f32 v81, v82, v83
    ds_write_b64 v100, v[80:81]
    s_waitcnt lgkmcnt(0)
    s_barrier
    ds_read_b128 v[72:75], v101
    ds_read_b128 v[76:79], v101 offset:16
    s_cmp_ge_u32 s45, 14
    s_cbranch_scc1 Lnowo_9
    v_lshrrev_b32 v117, 2, v0
    v_mul_u32_u24 v117, 896, v117
    v_and_b32 v11, 3, v0
    v_lshl_add_u32 v117, v11, 4, v117
    s_lshl_b32 s86, s45, 6
    v_add_u32 v117, s86, v117
    s_mul_i32 s87, s46, 14336
    s_lshl_b32 s54, s46, 10
    s_add_u32 s54, s54, 114688
    s_add_u32 m0, s54, 0
    s_add_u32 s86, s87, 0
    buffer_load_dwordx4 v117, s[8:11], s86 offen lds
    s_add_u32 m0, s54, 4096
    s_add_u32 s86, s87, 57344
    buffer_load_dwordx4 v117, s[8:11], s86 offen lds
    s_add_u32 m0, s54, 8192
    s_add_u32 s86, s87, 114688
    buffer_load_dwordx4 v117, s[8:11], s86 offen lds
    s_add_u32 m0, s54, 12288
    s_add_u32 s86, s87, 172032
    buffer_load_dwordx4 v117, s[8:11], s86 offen lds
    s_add_u32 m0, s54, 16384
    s_add_u32 s86, s87, 229376
    buffer_load_dwordx4 v117, s[8:11], s86 offen lds
    s_add_u32 m0, s54, 20480
    s_add_u32 s86, s87, 286720
    buffer_load_dwordx4 v117, s[8:11], s86 offen lds
    s_add_u32 m0, s54, 24576
    s_add_u32 s86, s87, 344064
    buffer_load_dwordx4 v117, s[8:11], s86 offen lds
    s_mov_b32 s86, 401408
    s_mov_b32 m0, 143360
    s_mov_b64 exec, 0xffff
    buffer_load_dwordx4 v117, s[8:11], s86 offen lds
    s_mov_b64 exec, -1
Lnowo_9:
    s_waitcnt lgkmcnt(1)
    v_mfma_f32_32x32x16_bf16 v[80:95], v[72:75], v[104:107], 0
    s_waitcnt lgkmcnt(0)
    v_cndmask_b32 v78, v78, 0, s[62:63]
    v_cndmask_b32 v79, v79, 0, s[62:63]
    s_nop 1
    v_mfma_f32_32x32x16_bf16 v[80:95], v[76:79], v[108:111], v[80:95]
    s_nop 11
    v_add_f32 v120, 0x358637bd, v87
    v_rcp_f32 v120, v120
    s_nop 0
    v_mul_f32 v120, s57, v120
    v_pk_mul_f32 v[80:81], v[80:81], v[120:121] op_sel_hi:[1,0]
    v_pk_mul_f32 v[82:83], v[82:83], v[120:121] op_sel_hi:[1,0]
    v_pk_mul_f32 v[84:85], v[84:85], v[120:121] op_sel_hi:[1,0]
    v_pk_mul_f32 v[86:87], v[86:87], v[120:121] op_sel_hi:[1,0]
    v_pk_mul_f32 v[88:89], v[88:89], v[120:121] op_sel_hi:[1,0]
    v_pk_mul_f32 v[90:91], v[90:91], v[120:121] op_sel_hi:[1,0]
    v_pk_mul_f32 v[92:93], v[92:93], v[120:121] op_sel_hi:[1,0]
    v_pk_mul_f32 v[94:95], v[94:95], v[120:121] op_sel_hi:[1,0]
    v_mov_b32 v87, s23
    v_mov_b32 v95, s23
    v_cvt_pk_bf16_f32 v80, v80, v81
    v_cvt_pk_bf16_f32 v81, v82, v83
    v_cvt_pk_bf16_f32 v82, v84, v85
    v_cvt_pk_bf16_f32 v83, v86, v87
    v_cvt_pk_bf16_f32 v84, v88, v89
    v_cvt_pk_bf16_f32 v85, v90, v91
    v_cvt_pk_bf16_f32 v86, v92, v93
    v_cvt_pk_bf16_f32 v87, v94, v95
    s_cmp_lg_u32 s48, 0
    s_cbranch_scc1 Lslow_14
    buffer_store_dwordx4 v[80:83], v1, s[36:39], s75 offen offset:0
    buffer_store_dwordx4 v[84:87], v1, s[36:39], s75 offen offset:1024
Lback_15:
    s_cmp_ge_u32 s45, 14
    s_cbranch_scc1 Lskipmlp_16
L_mlp0:
    s_lshl_b32 s86, s46, 1
    s_mul_i32 s52, s67, 14
    s_add_u32 s52, s52, s86
    s_mov_b32 s53, 131072
    s_lshl_b32 s4, s52, 10
    s_add_u32 s4, s4, s53
    s_add_u32 s86, s86, 8
    s_cmp_ge_u32 s86, 28
    s_cselect_b32 s54, 28, 0
    s_cselect_b32 s5, 0x8000, 0
    s_sub_u32 s86, s86, s54
    s_add_u32 s53, s53, s5
    s_add_u32 s52, s52, 8
    s_cmp_ge_u32 s52, 28
    s_cselect_b32 s54, 28, 0
    s_sub_u32 s52, s52, s54
    s_lshl_b32 s5, s52, 10
    s_add_u32 s5, s5, s53
    s_add_u32 s86, s86, 8
    s_cmp_ge_u32 s86, 28
    s_cselect_b32 s54, 28, 0
    s_cselect_b32 s6, 0x8000, 0
    s_sub_u32 s86, s86, s54
    s_add_u32 s53, s53, s6
    s_add_u32 s52, s52, 8
    s_cmp_ge_u32 s52, 28
    s_cselect_b32 s54, 28, 0
    s_sub_u32 s52, s52, s54
    s_lshl_b32 s6, s52, 10
    s_add_u32 s6, s6, s53
    s_add_u32 s86, s86, 8
    s_cmp_ge_u32 s86, 28
    s_cselect_b32 s54, 28, 0
    s_cselect_b32 s7, 0x8000, 0
    s_sub_u32 s86, s86, s54
    s_add_u32 s53, s53, s7
    s_add_u32 s52, s52, 8
    s_cmp_ge_u32 s52, 28
    s_cselect_b32 s54, 28, 0
    s_sub_u32 s52, s52, s54
    s_lshl_b32 s7, s52, 10
    s_add_u32 s7, s7, s53
    s_add_u32 s86, s86, 8
    s_cmp_ge_u32 s86, 28
    s_cselect_b32 s54, 28, 0
    s_cselect_b32 s8, 0x8000, 0
    s_sub_u32 s86, s86, s54
    s_add_u32 s53, s53, s8
    s_add_u32 s52, s52, 8
    s_cmp_ge_u32 s52, 28
    s_cselect_b32 s54, 28, 0
    s_sub_u32 s52, s52, s54
    s_lshl_b32 s8, s52, 10
    s_add_u32 s8, s8, s53
    s_add_u32 s86, s86, 8
    s_cmp_ge_u32 s86, 28
    s_cselect_b32 s54, 28, 0
    s_cselect_b32 s9, 0x8000, 0
    s_sub_u32 s86, s86, s54
    s_add_u32 s53, s53, s9
    s_add_u32 s52, s52, 8
    s_cmp_ge_u32 s52, 28
    s_cselect_b32 s54, 28, 0
    s_sub_u32 s52, s52, s54
    s_lshl_b32 s9, s52, 10
    s_add_u32 s9, s9, s53
    s_add_u32 s86, s86, 8
    s_cmp_ge_u32 s86, 28
    s_cselect_b32 s54, 28, 0
    s_cselect_b32 s10, 0x8000, 0
    s_sub_u32 s86, s86, s54
    s_add_u32 s53, s53, s10
    s_add_u32 s52, s52, 8
    s_cmp_ge_u32 s52, 28
    s_cselect_b32 s54, 28, 0
    s_sub_u32 s52, s52, s54
    s_lshl_b32 s10, s52, 10
    s_add_u32 s10, s10, s53
    s_add_u32 s86, s86, 8
    s_cmp_ge_u32 s86, 28
    s_cselect_b32 s54, 28, 0
    s_cselect_b32 s11, 0x8000, 0
    s_sub_u32 s86, s86, s54
    s_add_u32 s53, s53, s11
    s_add_u32 s52, s52, 8
    s_cmp_ge_u32 s52, 28
    s_cselect_b32 s54, 28, 0
    s_sub_u32 s52, s52, s54
    s_lshl_b32 s11, s52, 10
    s_add_u32 s11, s11, s53
    s_add_u32 s86, s86, 8
    s_cmp_ge_u32 s86, 28
    s_cselect_b32 s54, 28, 0
    s_cselect_b32 s12, 0x8000, 0
    s_sub_u32 s86, s86, s54
    s_add_u32 s53, s53, s12
    s_add_u32 s52, s52, 8
    s_cmp_ge_u32 s52, 28
    s_cselect_b32 s54, 28, 0
    s_sub_u32 s52, s52, s54
    s_lshl_b32 s12, s52, 10
    s_add_u32 s12, s12, s53
    s_add_u32 s86, s86, 8
    s_cmp_ge_u32 s86, 28
    s_cselect_b32 s54, 28, 0
    s_cselect_b32 s13, 0x8000, 0
    s_sub_u32 s86, s86, s54
    s_add_u32 s53, s53, s13
    s_add_u32 s52, s52, 8
    s_cmp_ge_u32 s52, 28
    s_cselect_b32 s54, 28, 0
    s_sub_u32 s52, s52, s54
    s_lshl_b32 s13, s52, 10
    s_add_u32 s13, s13, s53
    s_add_u32 s86, s86, 8
    s_cmp_ge_u32 s86, 28
    s_cselect_b32 s54, 28, 0
    s_cselect_b32 s14, 0x8000, 0
    s_sub_u32 s86, s86, s54
    s_add_u32 s53, s53, s14
    s_add_u32 s52, s52, 8
    s_cmp_ge_u32 s52, 28
    s_cselect_b32 s54, 28, 0
    s_sub_u32 s52, s52, s54
    s_lshl_b32 s14, s52, 10
    s_add_u32 s14, s14, s53
    s_add_u32 s86, s86, 8
    s_cmp_ge_u32 s86, 28
    s_cselect_b32 s54, 28, 0
    s_cselect_b32 s15, 0x8000, 0
    s_sub_u32 s86, s86, s54
    s_add_u32 s53, s53, s15
    s_add_u32 s52, s52, 8
    s_cmp_ge_u32 s52, 28
    s_cselect_b32 s54, 28, 0
    s_sub_u32 s52, s52, s54
    s_lshl_b32 s15, s52, 10
    s_add_u32 s15, s15, s53
    s_add_u32 s86, s86, 8
    s_cmp_ge_u32 s86, 28
    s_cselect_b32 s54, 28, 0
    s_cselect_b32 s20, 0x8000, 0
    s_sub_u32 s86, s86, s54
    s_add_u32 s53, s53, s20
    s_add_u32 s52, s52, 8
    s_cmp_ge_u32 s52, 28
    s_cselect_b32 s54, 28, 0
    s_sub_u32 s52, s52, s54
    s_lshl_b32 s20, s52, 10
    s_add_u32 s20, s20, s53
    s_add_u32 s86, s86, 8
    s_cmp_ge_u32 s86, 28
    s_cselect_b32 s54, 28, 0
    s_cselect_b32 s21, 0x8000, 0
    s_sub_u32 s86, s86, s54
    s_add_u32 s53, s53, s21
    s_add_u32 s52, s52, 8
    s_cmp_ge_u32 s52, 28
    s_cselect_b32 s54, 28, 0
    s_sub_u32 s52, s52, s54
    s_lshl_b32 s21, s52, 10
    s_add_u32 s21, s21, s53
    s_waitcnt vmcnt(2)
    s_waitcnt lgkmcnt(0)
    s_barrier
    ds_read_b64_tr_b16 v[144:145], v3 offset:0
    ds_read_b64_tr_b16 v[146:147], v3 offset:256
    ds_read_b64_tr_b16 v[148:149], v3 offset:896
    ds_read_b64_tr_b16 v[150:151], v3 offset:1152
    ds_read_b64_tr_b16 v[152:153], v3 offset:1792
    ds_read_b64_tr_b16 v[154:155], v3 offset:2048
    ds_read_b64_tr_b16 v[156:157], v3 offset:2688
    ds_read_b64_tr_b16 v[158:159], v3 offset:2944
Ls2_19:
    buffer_load_dword v9, v10, s[36:39], s74 offen sc1
    v_mov_b32 v11, 0
    s_waitcnt vmcnt(0)
    v_lshrrev_b32 v9, 16, v9
    v_cmp_ne_u32 vcc, s22, v9
    s_cbranch_vccnz Lspin_21
Lgot_22:
    s_add_u32 s51, s74, 0
    buffer_load_dwordx4 v[32:35], v1, s[36:39], s51 offen offset:0 sc1
    buffer_load_dwordx4 v[36:39], v1, s[36:39], s51 offen offset:1024 sc1
    buffer_load_dwordx4 v[40:43], v1, s[36:39], s51 offen offset:2048 sc1
    buffer_load_dwordx4 v[44:47], v1, s[36:39], s51 offen offset:3072 sc1
    s_add_u32 s51, s74, 4096
    buffer_load_dwordx4 v[48:51], v1, s[36:39], s51 offen offset:0 sc1
    buffer_load_dwordx4 v[52:55], v1, s[36:39], s51 offen offset:1024 sc1
    buffer_load_dwordx4 v[56:59], v1, s[36:39], s51 offen offset:2048 sc1
    buffer_load_dwordx4 v[60:63], v1, s[36:39], s51 offen offset:3072 sc1
    s_add_u32 s51, s74, 8192
    buffer_load_dwordx4 v[64:67], v1, s[36:39], s51 offen offset:0 sc1
    buffer_load_dwordx4 v[68:71], v1, s[36:39], s51 offen offset:1024 sc1
    s_waitcnt vmcnt(9)
    v_bitop3_b32 v11, v35, s23, v11 bitop3:0xbe
    v_and_b32 v35, 0xffff, v35
    buffer_load_dwordx4 v[72:75], v1, s[36:39], s51 offen offset:2048 sc1
    s_waitcnt lgkmcnt(6)
    v_mfma_f32_32x32x16_bf16 v[16:31], v[144:147], v[32:35], v[16:31]
    ds_read_b64_tr_b16 v[144:145], v3 offset:3584
    ds_read_b64_tr_b16 v[146:147], v3 offset:3840
    ds_read_b64_tr_b16 v[200:201], v114 offset:0
    ds_read_b64_tr_b16 v[202:203], v114 offset:512
    s_waitcnt vmcnt(9)
    v_bitop3_b32 v11, v39, s23, v11 bitop3:0xbe
    v_and_b32 v39, 0xffff, v39
    buffer_load_dwordx4 v[76:79], v1, s[36:39], s51 offen offset:3072 sc1
    s_waitcnt lgkmcnt(8)
    v_mfma_f32_32x32x16_bf16 v[16:31], v[148:151], v[36:39], v[16:31]
    ds_read_b64_tr_b16 v[148:149], v3 offset:4480
    ds_read_b64_tr_b16 v[150:151], v3 offset:4736
    s_waitcnt vmcnt(9)
    v_bitop3_b32 v11, v43, s23, v11 bitop3:0xbe
    v_and_b32 v43, 0xffff, v43
    s_add_u32 s51, s74, 12288
    buffer_load_dwordx4 v[80:83], v1, s[36:39], s51 offen offset:0 sc1
    s_waitcnt lgkmcnt(8)
    v_mfma_f32_32x32x16_bf16 v[16:31], v[152:155], v[40:43], v[16:31]
    ds_read_b64_tr_b16 v[152:153], v3 offset:5376
    ds_read_b64_tr_b16 v[154:155], v3 offset:5632
    ds_read_b64_tr_b16 v[204:205], v114 offset:1024
    ds_read_b64_tr_b16 v[206:207], v114 offset:1536
    s_waitcnt vmcnt(9)
    v_bitop3_b32 v11, v47, s23, v11 bitop3:0xbe
    v_and_b32 v47, 0xffff, v47
    buffer_load_dwordx4 v[84:87], v1, s[36:39], s51 offen offset:1024 sc1
    s_waitcnt lgkmcnt(10)
    v_mfma_f32_32x32x16_bf16 v[16:31], v[156:159], v[44:47], v[16:31]
    ds_read_b64_tr_b16 v[156:157], v3 offset:6272
    ds_read_b64_tr_b16 v[158:159], v3 offset:6528
    s_waitcnt lgkmcnt(8)
    v_mfma_f32_32x32x16_bf16 v[88:103], v[124:127], v[200:203], 0
    s_waitcnt vmcnt(9)
    v_bitop3_b32 v11, v51, s23, v11 bitop3:0xbe
    v_and_b32 v51, 0xffff, v51
    buffer_load_dwordx4 v[32:35], v1, s[36:39], s51 offen offset:2048 sc1
    s_nop 0
    v_mfma_f32_32x32x16_bf16 v[16:31], v[144:147], v[48:51], v[16:31]
    ds_read_b64_tr_b16 v[144:145], v3 offset:7168
    ds_read_b64_tr_b16 v[146:147], v3 offset:7424
    ds_read_b64_tr_b16 v[208:209], v114 offset:2048
    ds_read_b64_tr_b16 v[210:211], v114 offset:2560
    s_waitcnt vmcnt(9)
    v_bitop3_b32 v11, v55, s23, v11 bitop3:0xbe
    v_and_b32 v55, 0xffff, v55
    buffer_load_dwordx4 v[36:39], v1, s[36:39], s51 offen offset:3072 sc1
    s_waitcnt lgkmcnt(10)
    v_mfma_f32_32x32x16_bf16 v[16:31], v[148:151], v[52:55], v[16:31]
    ds_read_b64_tr_b16 v[148:149], v3 offset:8064
    ds_read_b64_tr_b16 v[150:151], v3 offset:8320
    s_waitcnt lgkmcnt(8)
    v_mfma_f32_32x32x16_bf16 v[88:103], v[124:127], v[204:207], v[88:103]
    s_waitcnt vmcnt(9)
    v_bitop3_b32 v11, v59, s23, v11 bitop3:0xbe
    v_and_b32 v59, 0xffff, v59
    s_add_u32 s51, s74, 16384
    buffer_load_dwordx4 v[40:43], v1, s[36:39], s51 offen offset:0 sc1
    v_mfma_f32_32x32x16_bf16 v[16:31], v[152:155], v[56:59], v[16:31]
    ds_read_b64_tr_b16 v[152:153], v3 offset:8960
    ds_read_b64_tr_b16 v[154:155], v3 offset:9216
    ds_read_b64_tr_b16 v[212:213], v114 offset:3072
    ds_read_b64_tr_b16 v[214:215], v114 offset:3584
    s_waitcnt vmcnt(9)
    v_bitop3_b32 v11, v63, s23, v11 bitop3:0xbe
    v_and_b32 v63, 0xffff, v63
    buffer_load_dwordx4 v[44:47], v1, s[36:39], s51 offen offset:1024 sc1
    s_waitcnt lgkmcnt(10)
    v_mfma_f32_32x32x16_bf16 v[16:31], v[156:159], v[60:63], v[16:31]
    ds_read_b64_tr_b16 v[156:157], v3 offset:9856
    ds_read_b64_tr_b16 v[158:159], v3 offset:10112
    s_waitcnt lgkmcnt(8)
    v_mfma_f32_32x32x16_bf16 v[88:103], v[124:127], v[208:211], v[88:103]
    s_waitcnt vmcnt(9)
    v_bitop3_b32 v11, v67, s23, v11 bitop3:0xbe
    v_and_b32 v67, 0xffff, v67
    buffer_load_dwordx4 v[48:51], v1, s[36:39], s51 offen offset:2048 sc1
    s_nop 0
    v_mfma_f32_32x32x16_bf16 v[16:31], v[144:147], v[64:67], v[16:31]
    ds_read_b64_tr_b16 v[144:145], v3 offset:10752
    ds_read_b64_tr_b16 v[146:147], v3 offset:11008
    ds_read_b64_tr_b16 v[216:217], v114 offset:4096
    ds_read_b64_tr_b16 v[218:219], v114 offset:4608
    s_waitcnt vmcnt(9)
    v_bitop3_b32 v11, v71, s23, v11 bitop3:0xbe
    v_and_b32 v71, 0xffff, v71
    buffer_load_dwordx4 v[52:55], v1, s[36:39], s51 offen offset:3072 sc1
    s_waitcnt lgkmcnt(10)
    v_mfma_f32_32x32x16_bf16 v[16:31], v[148:151], v[68:71], v[16:31]
    ds_read_b64_tr_b16 v[148:149], v3 offset:11648
    ds_read_b64_tr_b16 v[150:151], v3 offset:11904
    s_waitcnt lgkmcnt(8)
    v_mfma_f32_32x32x16_bf16 v[88:103], v[124:127], v[212:215], v[88:103]
    s_waitcnt vmcnt(9)
    v_bitop3_b32 v11, v75, s23, v11 bitop3:0xbe
    v_and_b32 v75, 0xffff, v75
    s_add_u32 s51, s74, 20480
    buffer_load_dwordx4 v[56:59], v1, s[36:39], s51 offen offset:0 sc1
    v_mfma_f32_32x32x16_bf16 v[16:31], v[152:155], v[72:75], v[16:31]
    ds_read_b64_tr_b16 v[152:153], v3 offset:12544
    ds_read_b64_tr_b16 v[154:155], v3 offset:12800
    ds_read_b64_tr_b16 v[220:221], v114 offset:5120
    ds_read_b64_tr_b16 v[222:223], v114 offset:5632
    s_waitcnt vmcnt(9)
    v_bitop3_b32 v11, v79, s23, v11 bitop3:0xbe
    v_and_b32 v79, 0xffff, v79
    buffer_load_dwordx4 v[60:63], v1, s[36:39], s51 offen offset:1024 sc1
    s_waitcnt lgkmcnt(10)
    v_mfma_f32_32x32x16_bf16 v[16:31], v[156:159], v[76:79], v[16:31]
    ds_read_b64_tr_b16 v[156:157], v3 offset:13440
    ds_read_b64_tr_b16 v[158:159], v3 offset:13696
    s_waitcnt lgkmcnt(8)
    v_mfma_f32_32x32x16_bf16 v[88:103], v[124:127], v[216:219], v[88:103]
    s_waitcnt vmcnt(9)
    v_bitop3_b32 v11, v83, s23, v11 bitop3:0xbe
    v_and_b32 v83, 0xffff, v83
    buffer_load_dwordx4 v[64:67], v1, s[36:39], s51 offen offset:2048 sc1
    s_nop 0
    v_mfma_f32_32x32x16_bf16 v[16:31], v[144:147], v[80:83], v[16:31]
    ds_read_b64_tr_b16 v[144:145], v3 offset:14336
    ds_read_b64_tr_b16 v[146:147], v3 offset:14592
    ds_read_b64_tr_b16 v[224:225], v114 offset:6144
    ds_read_b64_tr_b16 v[226:227], v114 offset:6656
    s_waitcnt vmcnt(9)
    v_bitop3_b32 v11, v87, s23, v11 bitop3:0xbe
    v_and_b32 v87, 0xffff, v87
    buffer_load_dwordx4 v[68:71], v1, s[36:39], s51 offen offset:3072 sc1
    s_waitcnt lgkmcnt(10)
    v_mfma_f32_32x32x16_bf16 v[16:31], v[148:151], v[84:87], v[16:31]
    ds_read_b64_tr_b16 v[148:149], v3 offset:15232
    ds_read_b64_tr_b16 v[150:151], v3 offset:15488
    s_waitcnt lgkmcnt(8)
    v_mfma_f32_32x32x16_bf16 v[88:103], v[124:127], v[220:223], v[88:103]
    s_waitcnt vmcnt(9)
    v_bitop3_b32 v11, v35, s23, v11 bitop3:0xbe
    v_and_b32 v35, 0xffff, v35
    s_add_u32 s51, s74, 24576
    buffer_load_dwordx4 v[72:75], v1, s[36:39], s51 offen offset:0 sc1
    v_mfma_f32_32x32x16_bf16 v[16:31], v[152:155], v[32:35], v[16:31]
    ds_read_b64_tr_b16 v[152:153], v3 offset:16128
    ds_read_b64_tr_b16 v[154:155], v3 offset:16384
    ds_read_b64_tr_b16 v[228:229], v114 offset:7168
    ds_read_b64_tr_b16 v[230:231], v114 offset:7680
    s_waitcnt vmcnt(9)
    v_bitop3_b32 v11, v39, s23, v11 bitop3:0xbe
    v_and_b32 v39, 0xffff, v39
    buffer_load_dwordx4 v[76:79], v1, s[36:39], s51 offen offset:1024 sc1
    s_waitcnt lgkmcnt(10)
    v_mfma_f32_32x32x16_bf16 v[16:31], v[156:159], v[36:39], v[16:31]
    ds_read_b64_tr_b16 v[156:157], v3 offset:17024
    ds_read_b64_tr_b16 v[158:159], v3 offset:17280
    s_waitcnt lgkmcnt(8)
    v_mfma_f32_32x32x16_bf16 v[88:103], v[124:127], v[224:227], v[88:103]
    s_waitcnt vmcnt(9)
    v_bitop3_b32 v11, v43, s23, v11 bitop3:0xbe
    v_and_b32 v43, 0xffff, v43
    buffer_load_dwordx4 v[80:83], v1, s[36:39], s51 offen offset:2048 sc1
    s_nop 0
    v_mfma_f32_32x32x16_bf16 v[16:31], v[144:147], v[40:43], v[16:31]
    ds_read_b64_tr_b16 v[144:145], v3 offset:17920
    ds_read_b64_tr_b16 v[146:147], v3 offset:18176
    ds_read_b64_tr_b16 v[232:233], v114 offset:8192
    ds_read_b64_tr_b16 v[234:235], v114 offset:8704
    s_waitcnt vmcnt(9)
    v_bitop3_b32 v11, v47, s23, v11 bitop3:0xbe
    v_and_b32 v47, 0xffff, v47
    buffer_load_dwordx4 v[84:87], v1, s[36:39], s51 offen offset:3072 sc1
    s_waitcnt lgkmcnt(10)
    v_mfma_f32_32x32x16_bf16 v[16:31], v[148:151], v[44:47], v[16:31]
    ds_read_b64_tr_b16 v[148:149], v3 offset:18816
    ds_read_b64_tr_b16 v[150:151], v3 offset:19072
    s_waitcnt lgkmcnt(8)
    v_mfma_f32_32x32x16_bf16 v[88:103], v[124:127], v[228:231], v[88:103]
    s_waitcnt vmcnt(9)
    v_bitop3_b32 v11, v51, s23, v11 bitop3:0xbe
    v_and_b32 v51, 0xffff, v51
    s_add_u32 s51, s74, 28672
    buffer_load_dwordx4 v[32:35], v1, s[36:39], s51 offen offset:0 sc1
    v_mfma_f32_32x32x16_bf16 v[16:31], v[152:155], v[48:51], v[16:31]
    ds_read_b64_tr_b16 v[152:153], v3 offset:19712
    ds_read_b64_tr_b16 v[154:155], v3 offset:19968
    ds_read_b64_tr_b16 v[236:237], v114 offset:9216
    ds_read_b64_tr_b16 v[238:239], v114 offset:9728
    s_waitcnt vmcnt(9)
    v_bitop3_b32 v11, v55, s23, v11 bitop3:0xbe
    v_and_b32 v55, 0xffff, v55
    buffer_load_dwordx4 v[36:39], v1, s[36:39], s51 offen offset:1024 sc1
    s_waitcnt lgkmcnt(10)
    v_mfma_f32_32x32x16_bf16 v[16:31], v[156:159], v[52:55], v[16:31]
    ds_read_b64_tr_b16 v[156:157], v3 offset:20608
    ds_read_b64_tr_b16 v[158:159], v3 offset:20864
    s_waitcnt lgkmcnt(8)
    v_mfma_f32_32x32x16_bf16 v[88:103], v[124:127], v[232:235], v[88:103]
    s_waitcnt vmcnt(9)
    v_bitop3_b32 v11, v59, s23, v11 bitop3:0xbe
    v_and_b32 v59, 0xffff, v59
    buffer_load_dwordx4 v[40:43], v1, s[36:39], s51 offen offset:2048 sc1
    s_nop 0
    v_mfma_f32_32x32x16_bf16 v[16:31], v[144:147], v[56:59], v[16:31]
    ds_read_b64_tr_b16 v[144:145], v3 offset:21504
    ds_read_b64_tr_b16 v[146:147], v3 offset:21760
    ds_read_b64_tr_b16 v[240:241], v114 offset:10240
    ds_read_b64_tr_b16 v[242:243], v114 offset:10752
    s_waitcnt vmcnt(9)
    v_bitop3_b32 v11, v63, s23, v11 bitop3:0xbe
    v_and_b32 v63, 0xffff, v63
    buffer_load_dwordx4 v[44:47], v1, s[36:39], s51 offen offset:3072 sc1
    s_waitcnt lgkmcnt(10)
    v_mfma_f32_32x32x16_bf16 v[16:31], v[148:151], v[60:63], v[16:31]
    ds_read_b64_tr_b16 v[148:149], v3 offset:22400
    ds_read_b64_tr_b16 v[150:151], v3 offset:22656
    s_waitcnt lgkmcnt(8)
    v_mfma_f32_32x32x16_bf16 v[88:103], v[124:127], v[236:239], v[88:103]
    s_waitcnt vmcnt(9)
    v_bitop3_b32 v11, v67, s23, v11 bitop3:0xbe
    v_and_b32 v67, 0xffff, v67
    s_nop 1
    v_mfma_f32_32x32x16_bf16 v[16:31], v[152:155], v[64:67], v[16:31]
    ds_read_b64_tr_b16 v[152:153], v3 offset:23296
    ds_read_b64_tr_b16 v[154:155], v3 offset:23552
    ds_read_b64_tr_b16 v[244:245], v114 offset:11264
    ds_read_b64_tr_b16 v[246:247], v114 offset:11776
    s_waitcnt vmcnt(8)
    v_bitop3_b32 v11, v71, s23, v11 bitop3:0xbe
    v_and_b32 v71, 0xffff, v71
    s_waitcnt lgkmcnt(10)
    s_nop 0
    v_mfma_f32_32x32x16_bf16 v[16:31], v[156:159], v[68:71], v[16:31]
    ds_read_b64_tr_b16 v[156:157], v3 offset:24192
    ds_read_b64_tr_b16 v[158:159], v3 offset:24448
    s_waitcnt lgkmcnt(8)
    v_mfma_f32_32x32x16_bf16 v[88:103], v[124:127], v[240:243], v[88:103]
    s_waitcnt vmcnt(7)
    v_bitop3_b32 v11, v75, s23, v11 bitop3:0xbe
    v_and_b32 v75, 0xffff, v75
    s_nop 1
    v_mfma_f32_32x32x16_bf16 v[16:31], v[144:147], v[72:75], v[16:31]
    ds_read_b64_tr_b16 v[144:145], v3 offset:25088
    ds_read_b64_tr_b16 v[146:147], v3 offset:25344
    ds_read_b64_tr_b16 v[248:249], v114 offset:12288
    ds_read_b64_tr_b16 v[250:251], v114 offset:12800
    s_waitcnt vmcnt(6)
    v_bitop3_b32 v11, v79, s23, v11 bitop3:0xbe
    v_and_b32 v79, 0xffff, v79
    s_waitcnt lgkmcnt(10)
    s_nop 0
    v_mfma_f32_32x32x16_bf16 v[16:31], v[148:151], v[76:79], v[16:31]
    ds_read_b64_tr_b16 v[148:149], v3 offset:25984
    ds_read_b64_tr_b16 v[150:151], v3 offset:26240
    s_waitcnt lgkmcnt(8)
    v_mfma_f32_32x32x16_bf16 v[88:103], v[124:127], v[244:247], v[88:103]
    s_waitcnt vmcnt(5)
    v_bitop3_b32 v11, v83, s23, v11 bitop3:0xbe
    v_and_b32 v83, 0xffff, v83
    s_nop 1
    v_mfma_f32_32x32x16_bf16 v[16:31], v[152:155], v[80:83], v[16:31]
    ds_read_b64_tr_b16 v[152:153], v3 offset:26880
    ds_read_b64_tr_b16 v[154:155], v3 offset:27136
    ds_read_b64_tr_b16 v[252:253], v114 offset:13312
    ds_read_b64_tr_b16 v[254:255], v114 offset:13824
    s_waitcnt vmcnt(4)
    v_bitop3_b32 v11, v87, s23, v11 bitop3:0xbe
    v_and_b32 v87, 0xffff, v87
    s_waitcnt lgkmcnt(10)
    s_nop 0
    v_mfma_f32_32x32x16_bf16 v[16:31], v[156:159], v[84:87], v[16:31]
    ds_read_b64_tr_b16 v[156:157], v3 offset:27776
    ds_read_b64_tr_b16 v[158:159], v3 offset:28032
    s_waitcnt lgkmcnt(8)
    v_mfma_f32_32x32x16_bf16 v[88:103], v[124:127], v[248:251], v[88:103]
    s_waitcnt vmcnt(3)
    v_bitop3_b32 v11, v35, s23, v11 bitop3:0xbe
    v_and_b32 v35, 0xffff, v35
    s_nop 1
    v_mfma_f32_32x32x16_bf16 v[16:31], v[144:147], v[32:35], v[16:31]
    s_waitcnt vmcnt(2)
    v_bitop3_b32 v11, v39, s23, v11 bitop3:0xbe
    v_and_b32 v39, 0xffff, v39
    v_and_b32 v13, 15, v0
    v_min_u32 v13, 13, v13
    v_lshlrev_b32 v13, 2, v13
    v_lshrrev_b32 v14, 4, v0
    v_lshl_add_u32 v13, v14, 7, v13
    s_waitcnt lgkmcnt(6)
    v_mfma_f32_32x32x16_bf16 v[16:31], v[148:151], v[36:39], v[16:31]
    s_waitcnt lgkmcnt(2)
    v_mfma_f32_32x32x16_bf16 v[88:103], v[124:127], v[252:255], v[88:103]
    s_waitcnt vmcnt(1)
    v_bitop3_b32 v11, v43, s23, v11 bitop3:0xbe
    v_and_b32 v43, 0xffff, v43
    s_nop 1
    v_mfma_f32_32x32x16_bf16 v[16:31], v[152:155], v[40:43], v[16:31]
    s_waitcnt vmcnt(0)
    v_bitop3_b32 v11, v47, s23, v11 bitop3:0xbe
    v_and_b32 v47, 0xffff, v47
    s_waitcnt lgkmcnt(0)
    s_nop 0
    v_mfma_f32_32x32x16_bf16 v[16:31], v[156:159], v[44:47], v[16:31]
    v_cmp_lt_u32 vcc, 0xffff, v11
    s_cbranch_vccnz Ls2again_20
    v_mov_b32 v10, v13
    s_nop 8
    v_cvt_pk_bf16_f32 v32, v16, v17
    v_cvt_pk_bf16_f32 v33, v18, v19
    v_cvt_pk_bf16_f32 v34, v20, v21
    v_cvt_pk_bf16_f32 v35, v22, v23
    v_cvt_pk_bf16_f32 v36, v24, v25
    v_cvt_pk_bf16_f32 v37, v26, v27
    v_cvt_pk_bf16_f32 v38, v28, v29
    v_cvt_pk_bf16_f32 v39, v30, v31
    s_cmp_lg_u32 s48, 0
    s_cbranch_scc1 Lslow_23
    buffer_store_dwordx4 v[32:35], v1, s[36:39], s55 offen offset:0
    buffer_store_dwordx4 v[36:39], v1, s[36:39], s55 offen offset:1024
Lback_24:
    v_mov_b32 v13, 0x3f803f80
    v_dot2_f32_bf16 v11, v32, v13, 0
    v_dot2_f32_bf16 v12, v32, v32, 0
    v_dot2_f32_bf16 v11, v33, v13, v11
    v_dot2_f32_bf16 v12, v33, v33, v12
    v_dot2_f32_bf16 v11, v34, v13, v11
    v_dot2_f32_bf16 v12, v34, v34, v12
    v_dot2_f32_bf16 v11, v35, v13, v11
    v_dot2_f32_bf16 v12, v35, v35, v12
    v_dot2_f32_bf16 v11, v36, v13, v11
    v_dot2_f32_bf16 v12, v36, v36, v12
    v_dot2_f32_bf16 v11, v37, v13, v11
    v_dot2_f32_bf16 v12, v37, v37, v12
    v_dot2_f32_bf16 v11, v38, v13, v11
    v_dot2_f32_bf16 v12, v38, v38, v12
    v_dot2_f32_bf16 v11, v39, v13, v11
    v_dot2_f32_bf16 v12, v39, v39, v12
    s_nop 2
    v_permlane32_swap_b32 v11, v12
    v_add_f32 v11, v11, v12
    s_cmp_lg_u32 s48, 0
    s_cbranch_scc1 Lslow_25
    buffer_store_dword v11, v1, s[36:39], s56 offen
Lback_26:
    s_waitcnt vmcnt(0)
    s_mov_b64 exec, 1
    s_cmp_lg_u32 s48, 0
    s_cbranch_scc1 Lslow_27
    buffer_store_dword v4, off, s[36:39], s77 offset:512
Lback_28:
    s_mov_b64 exec, -1
    v_add_f32 v128, v128, v88
    v_and_b32 v151, 0xffff0000, v171
    v_lshlrev_b32 v150, 16, v171
    v_and_b32 v149, 0xffff0000, v170
    v_lshlrev_b32 v148, 16, v170
    v_and_b32 v147, 0xffff0000, v169
    v_lshlrev_b32 v146, 16, v169
    v_and_b32 v145, 0xffff0000, v168
    v_lshlrev_b32 v144, 16, v168
    v_mov_b32 v152, 0
    v_mov_b32 v153, 0
    v_mov_b32 v154, 0
    v_mov_b32 v155, 0
    s_lshl_b32 s51, s46, 7
    s_add_u32 s51, s51, 162816
    v_lshrrev_b32 v11, 5, v0
    v_lshl_add_u32 v11, v11, 6, s51
    ds_write_b128 v11, v[144:147] offset:0
    ds_write_b128 v11, v[148:151] offset:16
    ds_write_b128 v11, v[152:155] offset:32
    ds_write_b128 v11, v[152:155] offset:48
    v_cvt_pk_bf16_f32 v7, v128, v128
    v_and_b32 v12, 0xffff0000, v7
    v_sub_f32 v12, v128, v12
    v_cvt_pk_bf16_f32 v8, v12, 0
    v_lshl_or_b32 v116, v116, 16, v116
    v_cndmask_b32 v7, v7, v116, s[62:63]
    v_cndmask_b32 v8, v8, 0, s[62:63]
    s_waitcnt lgkmcnt(0)
    s_mov_b32 s55, 885248
    s_lshl_b32 s56, s46, 11
    v_mov_b32 v76, v7
    v_mov_b32 v77, v8
    v_mov_b32 v78, 0
    v_mov_b32 v79, 0
    v_mov_b32 v74, 0
    v_mov_b32 v75, 0
    v_lshlrev_b32 v3, 3, v0
    v_add_u32 v3, 143616, v3
    v_and_b32 v14, 31, v0
    v_lshlrev_b32 v14, 4, v14
    v_add_u32 v14, 144128, v14
    v_add_u32 v105, 57344, v1
    s_lshl_b32 s54, s46, 7
    s_add_u32 s54, s54, 162816
    v_lshrrev_b32 v104, 5, v0
    v_lshl_add_u32 v104, v104, 6, s54
    s_add_u32 s52, s74, 159744
    s_cmp_lg_u32 s46, 0
    s_cbranch_scc1 Lnp_29
    buffer_load_dword v9, v10, s[36:39], s55 offen sc1
    s_waitcnt vmcnt(0)
    v_cmp_ne_u32 vcc, s47, v9
    s_cbranch_vccnz Lspin_30
Lgot_31:
Lnp_29:
    s_barrier
    s_add_u32 m0, s56, 0
    s_nop 0
    buffer_load_dwordx4 v1, s[36:39], s4 offen sc1 lds
    buffer_load_dwordx4 v1, s[36:39], s4 offen offset:1024 sc1 lds
    s_add_u32 m0, s56, 8192
    s_nop 0
    buffer_load_dwordx4 v1, s[36:39], s5 offen sc1 lds
    buffer_load_dwordx4 v1, s[36:39], s5 offen offset:1024 sc1 lds
    buffer_load_dwordx4 v[108:111], v1, s[36:39], s52 offen offset:0 sc1
    buffer_load_dwordx4 v[112:115], v1, s[36:39], s52 offen offset:1024 sc1
    buffer_load_dwordx4 v[116:119], v1, s[36:39], s52 offen offset:2048 sc1
    buffer_load_dwordx4 v[120:123], v1, s[36:39], s52 offen offset:3072 sc1
    s_waitcnt vmcnt(6)
    s_barrier
    ds_read_b128 v[48:51], v1 offset:0
    ds_read_b128 v[52:55], v1 offset:1024
    ds_read_b128 v[56:59], v1 offset:2048
    ds_read_b128 v[60:63], v1 offset:3072
    ds_read_b128 v[64:67], v1 offset:4096
    ds_read_b128 v[68:71], v1 offset:5120
    s_waitcnt lgkmcnt(4)
    v_mfma_f32_32x32x16_bf16 v[16:31], a[224:227], v[48:51], 0
    s_add_u32 m0, s56, 16384
    s_nop 0
    buffer_load_dwordx4 v1, s[36:39], s6 offen sc1 lds
    buffer_load_dwordx4 v1, s[36:39], s6 offen offset:1024 sc1 lds
    v_lshrrev_b32 v15, 3, v0
    v_mul_u32_u24 v15, 896, v15
    v_lshrrev_b32 v11, 2, v0
    v_and_b32 v11, 4, v11
    v_mfma_f32_32x32x16_bf16 v[16:31], a[228:231], v[52:55], v[16:31]
    ds_read_b128 v[48:51], v1 offset:6144
    ds_read_b128 v[52:55], v1 offset:7168
    v_xor_b32 v11, v11, v0
    v_and_b32 v11, 7, v11
    v_lshl_add_u32 v15, v11, 4, v15
    s_waitcnt lgkmcnt(4)
    v_mfma_f32_32x32x16_bf16 v[16:31], a[232:235], v[56:59], v[16:31]
    s_lshr_b32 s51, s45, 1
    s_lshl_b32 s51, s51, 7
    s_mul_i32 s53, s46, 28672
    s_add_u32 s51, s51, s53
    v_mfma_f32_32x32x16_bf16 v[16:31], a[236:239], v[60:63], v[16:31]
    s_waitcnt vmcnt(6)
    s_barrier
    ds_read_b128 v[56:59], v1 offset:8192
    ds_read_b128 v[60:63], v1 offset:9216
    v_add_u32 v15, s51, v15
    s_mul_i32 s85, s46, 7168
    s_add_u32 s85, s85, 86016
    s_waitcnt lgkmcnt(4)
    v_mfma_f32_32x32x16_bf16 v[16:31], a[240:243], v[64:67], v[16:31]
    s_lshl_b32 s87, s46, 12
    s_add_u32 s87, s87, 143616
    s_lshr_b32 s51, s46, 1
    v_lshrrev_b32 v106, 5, v0
    v_mfma_f32_32x32x16_bf16 v[16:31], a[244:247], v[68:71], v[16:31]
    ds_read_b128 v[64:67], v1 offset:10240
    ds_read_b128 v[68:71], v1 offset:11264
    v_mul_u32_u24 v106, 4, v106
    v_bfe_u32 v11, v0, 2, 2
    v_add_u32 v106, v106, v11
    s_waitcnt lgkmcnt(4)
    v_mfma_f32_32x32x16_bf16 v[16:31], a[248:251], v[48:51], v[16:31]
    s_add_u32 m0, s56, 24576
    s_nop 0
    buffer_load_dwordx4 v1, s[36:39], s7 offen sc1 lds
    buffer_load_dwordx4 v1, s[36:39], s7 offen offset:1024 sc1 lds
    v_mul_u32_u24 v106, 128, v106
    v_bfe_u32 v11, v0, 4, 1
    v_xor_b32 v11, s51, v11
    v_lshl_add_u32 v106, v11, 5, v106
    v_mfma_f32_32x32x16_bf16 v[16:31], a[252:255], v[52:55], v[16:31]
    ds_read_b128 v[48:51], v1 offset:12288
    ds_read_b128 v[52:55], v1 offset:13312
    v_and_b32 v11, 3, v0
    v_lshl_add_u32 v106, v11, 3, v106
    s_and_b32 s51, s46, 1
    s_waitcnt lgkmcnt(4)
    v_mfma_f32_32x32x16_bf16 v[16:31], v[176:179], v[56:59], v[16:31]
    v_bfe_u32 v11, v0, 3, 1
    v_xor_b32 v11, s51, v11
    v_lshl_add_u32 v106, v11, 6, v106
    v_xor_b32 v107, 64, v106
    v_mfma_f32_32x32x16_bf16 v[16:31], v[180:183], v[60:63], v[16:31]
    ds_read_b128 v[56:59], v1 offset:14336
    ds_read_b128 v[60:63], v1 offset:15360
    s_mul_i32 s59, s46, 10240
    v_add_u32 v140, s59, v106
    v_add_u32 v141, s59, v107
    s_waitcnt lgkmcnt(4)
    v_mfma_f32_32x32x16_bf16 v[16:31], v[184:187], v[64:67], v[16:31]
    s_add_u32 m0, s56, 32768
    s_nop 0
    buffer_load_dwordx4 v1, s[36:39], s8 offen sc1 lds
    buffer_load_dwordx4 v1, s[36:39], s8 offen offset:1024 sc1 lds
    s_waitcnt vmcnt(9)
    v_add_f32 v108, v108, v109
    v_add_f32 v110, v110, v111
    s_waitcnt vmcnt(8)
    v_add_f32 v112, v112, v113
    v_add_f32 v114, v114, v115
    v_mfma_f32_32x32x16_bf16 v[16:31], v[188:191], v[68:71], v[16:31]
    s_waitcnt vmcnt(4)
    s_barrier
    ds_read_b128 v[64:67], v1 offset:16384
    ds_read_b128 v[68:71], v1 offset:17408
    v_add_f32 v116, v116, v117
    v_add_f32 v118, v118, v119
    v_add_f32 v120, v120, v121
    v_add_f32 v108, v108, v110
    s_waitcnt lgkmcnt(4)
    v_mfma_f32_32x32x16_bf16 v[16:31], v[192:195], v[48:51], v[16:31]
    v_add_f32 v112, v112, v114
    v_add_f32 v116, v116, v118
    v_add_f32 v108, v108, v112
    v_add_f32 v116, v116, v120
    v_mfma_f32_32x32x16_bf16 v[16:31], v[196:199], v[52:55], v[16:31]
    ds_read_b128 v[48:51], v1 offset:18432
    ds_read_b128 v[52:55], v1 offset:19456
    v_add_f32 v80, v108, v116
    v_mov_b32 v12, v80
    v_mov_b32 v5, v80
    s_nop 1
    v_permlane32_swap_b32 v5, v12
    s_waitcnt lgkmcnt(4)
    v_mfma_f32_32x32x16_bf16 v[16:31], v[200:203], v[56:59], v[16:31]
    s_add_u32 m0, s56, 40960
    s_nop 0
    buffer_load_dwordx4 v1, s[36:39], s9 offen sc1 lds
    buffer_load_dwordx4 v1, s[36:39], s9 offen offset:1024 sc1 lds
    v_mul_f32 v5, 0x3b124925, v5
    v_mul_f32 v12, 0x3b124925, v12
    v_fma_f32 v12, -v5, v5, v12
    v_max_f32 v12, 0, v12
    v_mfma_f32_32x32x16_bf16 v[16:31], v[204:207], v[60:63], v[16:31]
    ds_read_b128 v[56:59], v1 offset:20480
    ds_read_b128 v[60:63], v1 offset:21504
    v_add_f32 v13, 0x3727c5ac, v12
    v_rsq_f32 v6, v13
    s_nop 0
    v_mul_f32 v13, v6, v6
    s_waitcnt lgkmcnt(4)
    v_mfma_f32_32x32x16_bf16 v[16:31], v[208:211], v[64:67], v[16:31]
    v_fmaak_f32 v12, v12, v13, 0x3727c5ac
    v_rsq_f32 v12, v12
    v_mfma_f32_32x32x16_bf16 v[16:31], v[212:215], v[68:71], v[16:31]
    ds_read_b128 v[64:67], v1 offset:22528
    ds_read_b128 v[68:71], v1 offset:23552
    v_mul_f32 v6, v6, v12
    v_rcp_f32 v102, v6
    v_mul_f32 v100, s70, v6
    s_waitcnt lgkmcnt(4)
    v_mfma_f32_32x32x16_bf16 v[16:31], v[216:219], v[48:51], v[16:31]
    s_add_u32 m0, s56, 49152
    s_nop 0
    buffer_load_dwordx4 v1, s[36:39], s10 offen sc1 lds
    buffer_load_dwordx4 v1, s[36:39], s10 offen offset:1024 sc1 lds
    v_mul_f32 v80, v6, v6
    v_mul_f32 v101, s71, v6
    v_mul_f32 v101, v101, v80
    v_sub_f32 v5, 0, v5
    v_mfma_f32_32x32x16_bf16 v[16:31], v[220:223], v[52:55], v[16:31]
    s_waitcnt vmcnt(6)
    s_barrier
    ds_read_b128 v[48:51], v1 offset:24576
    ds_read_b128 v[52:55], v1 offset:25600
    v_cndmask_b32 v5, v5, v102, s[62:63]
    v_cvt_pk_bf16_f32 v83, v5, v5
    v_and_b32 v80, 0xffff0000, v83
    v_sub_f32 v80, v5, v80
    s_waitcnt lgkmcnt(4)
    v_mfma_f32_32x32x16_bf16 v[16:31], v[224:227], v[56:59], v[16:31]
    v_cvt_pk_bf16_f32 v82, v5, v80
    v_and_b32 v83, 0xffff, v83
    v_cndmask_b32 v83, v83, 0, s[62:63]
    s_lshl_b32 s55, s46, 10
    v_mfma_f32_32x32x16_bf16 v[16:31], v[228:231], v[60:63], v[16:31]
    ds_read_b128 v[56:59], v1 offset:26624
    ds_read_b128 v[60:63], v1 offset:27648
    v_add_u32 v11, s55, v3
    v_add_u32 v12, s55, v14
    ds_write_b64 v11, v[82:83]
    s_waitcnt lgkmcnt(5)
    v_mfma_f32_32x32x16_bf16 v[16:31], v[232:235], v[64:67], v[16:31]
    s_add_u32 m0, s56, 57344
    s_nop 0
    buffer_load_dwordx4 v1, s[36:39], s11 offen sc1 lds
    buffer_load_dwordx4 v1, s[36:39], s11 offen offset:1024 sc1 lds
    ds_write_b128 v12, v[100:103]
    v_mfma_f32_32x32x16_bf16 v[16:31], v[236:239], v[68:71], v[16:31]
    ds_read_b128 v[64:67], v1 offset:28672
    ds_read_b128 v[68:71], v1 offset:29696
    s_waitcnt lgkmcnt(6)
    v_mfma_f32_32x32x16_bf16 v[16:31], v[240:243], v[48:51], v[16:31]
    v_mfma_f32_32x32x16_bf16 v[16:31], v[244:247], v[52:55], v[16:31]
    ds_read_b128 v[48:51], v1 offset:30720
    ds_read_b128 v[52:55], v1 offset:31744
    s_waitcnt lgkmcnt(6)
    v_mfma_f32_32x32x16_bf16 v[16:31], v[248:251], v[56:59], v[16:31]
    s_add_u32 m0, s56, 65536
    s_nop 0
    buffer_load_dwordx4 v1, s[36:39], s12 offen sc1 lds
    buffer_load_dwordx4 v1, s[36:39], s12 offen offset:1024 sc1 lds
    v_add_u32 v5, s87, v106
    v_add_u32 v6, s87, v107
    v_add_u32 v106, s85, v106
    v_add_u32 v107, s85, v107
    s_mul_i32 s51, s46, 21504
    v_add_u32 v13, s51, v1
    v_add_u32 v12, 6144, v15
    v_mfma_f32_32x32x16_bf16 v[16:31], v[252:255], v[60:63], v[16:31]
    s_waitcnt vmcnt(6) lgkmcnt(4)
    s_barrier
    ds_read_b128 v[56:59], v1 offset:32768
    ds_read_b128 v[60:63], v1 offset:33792
    ds_read_b64 v[72:73], v3 offset:0
    ds_read_b128 v[96:99], v14 offset:0
    s_waitcnt lgkmcnt(6)
    v_mfma_f32_32x32x16_bf16 v[32:47], a[224:227], v[64:67], 0
    v_mfma_f32_32x32x16_bf16 v[32:47], a[228:231], v[68:71], v[32:47]
    ds_read_b128 v[64:67], v1 offset:34816
    ds_read_b128 v[68:71], v1 offset:35840
    s_waitcnt lgkmcnt(6)
    v_mfma_f32_32x32x16_bf16 v[32:47], a[232:235], v[48:51], v[32:47]
    s_waitcnt lgkmcnt(3)
    v_mfma_f32_32x32x16_bf16 v[16:31], v[76:79], v[72:75], v[16:31]
    s_add_u32 m0, s56, 73728
    s_nop 0
    buffer_load_dwordx4 v1, s[36:39], s13 offen sc1 lds
    buffer_load_dwordx4 v1, s[36:39], s13 offen offset:1024 sc1 lds
    v_mfma_f32_32x32x16_bf16 v[32:47], a[236:239], v[52:55], v[32:47]
    ds_read_b128 v[48:51], v1 offset:36864
    ds_read_b128 v[52:55], v1 offset:37888
    v_mfma_f32_32x32x16_bf16 v[32:47], a[240:243], v[56:59], v[32:47]
    v_mfma_f32_32x32x16_bf16 v[32:47], a[244:247], v[60:63], v[32:47]
    ds_read_b128 v[56:59], v1 offset:38912
    ds_read_b128 v[60:63], v1 offset:39936
    s_nop 0
    v_pk_mul_f32 v[80:81], v[16:17], v[16:17]
    v_pk_mul_f32 v[82:83], v[18:19], v[18:19]
    v_pk_mul_f32 v[84:85], v[20:21], v[20:21]
    v_pk_mul_f32 v[86:87], v[22:23], v[22:23]
    v_pk_mul_f32 v[88:89], v[24:25], v[24:25]
    v_pk_mul_f32 v[90:91], v[26:27], v[26:27]
    v_pk_mul_f32 v[92:93], v[28:29], v[28:29]
    v_pk_mul_f32 v[94:95], v[30:31], v[30:31]
    s_waitcnt lgkmcnt(6)
    v_pk_fma_f32 v[80:81], v[80:81], v[96:97], v[96:97] op_sel:[0,1,0] op_sel_hi:[1,1,0]
    v_pk_fma_f32 v[82:83], v[82:83], v[96:97], v[96:97] op_sel:[0,1,0] op_sel_hi:[1,1,0]
    v_pk_fma_f32 v[84:85], v[84:85], v[96:97], v[96:97] op_sel:[0,1,0] op_sel_hi:[1,1,0]
    v_pk_fma_f32 v[86:87], v[86:87], v[96:97], v[96:97] op_sel:[0,1,0] op_sel_hi:[1,1,0]
    v_pk_fma_f32 v[88:89], v[88:89], v[96:97], v[96:97] op_sel:[0,1,0] op_sel_hi:[1,1,0]
    v_pk_fma_f32 v[90:91], v[90:91], v[96:97], v[96:97] op_sel:[0,1,0] op_sel_hi:[1,1,0]
    v_pk_fma_f32 v[92:93], v[92:93], v[96:97], v[96:97] op_sel:[0,1,0] op_sel_hi:[1,1,0]
    v_pk_fma_f32 v[94:95], v[94:95], v[96:97], v[96:97] op_sel:[0,1,0] op_sel_hi:[1,1,0]
    v_pk_mul_f32 v[80:81], v[80:81], v[16:17]
    v_pk_mul_f32 v[82:83], v[82:83], v[18:19]
    v_pk_mul_f32 v[84:85], v[84:85], v[20:21]
    v_pk_mul_f32 v[86:87], v[86:87], v[22:23]
    v_pk_mul_f32 v[88:89], v[88:89], v[24:25]
    v_pk_mul_f32 v[90:91], v[90:91], v[26:27]
    v_pk_mul_f32 v[92:93], v[92:93], v[28:29]
    v_pk_mul_f32 v[94:95], v[94:95], v[30:31]
    s_waitcnt lgkmcnt(4)
    v_mfma_f32_32x32x16_bf16 v[32:47], a[248:251], v[64:67], v[32:47]
    s_add_u32 m0, s56, 81920
    s_nop 0
    buffer_load_dwordx4 v1, s[36:39], s14 offen sc1 lds
    buffer_load_dwordx4 v1, s[36:39], s14 offen offset:1024 sc1 lds
    v_exp_f32 v80, v80
    v_exp_f32 v81, v81
    v_exp_f32 v82, v82
    v_mfma_f32_32x32x16_bf16 v[32:47], a[252:255], v[68:71], v[32:47]
    ds_read_b128 v[64:67], v1 offset:40960
    ds_read_b128 v[68:71], v1 offset:41984
    v_exp_f32 v83, v83
    v_exp_f32 v84, v84
    s_waitcnt lgkmcnt(4)
    v_mfma_f32_32x32x16_bf16 v[32:47], v[176:179], v[48:51], v[32:47]
    v_exp_f32 v85, v85
    v_exp_f32 v86, v86
    v_exp_f32 v87, v87
    v_mfma_f32_32x32x16_bf16 v[32:47], v[180:183], v[52:55], v[32:47]
    ds_read_b128 v[48:51], v1 offset:43008
    ds_read_b128 v[52:55], v1 offset:44032
    v_fma_f32 v80, v80, v98, v98
    v_fma_f32 v81, v81, v98, v98
    v_fma_f32 v82, v82, v98, v98
    v_fma_f32 v83, v83, v98, v98
    s_waitcnt lgkmcnt(4)
    v_mfma_f32_32x32x16_bf16 v[32:47], v[184:187], v[56:59], v[32:47]
    s_add_u32 m0, s56, 90112
    s_nop 0
    buffer_load_dwordx4 v1, s[36:39], s15 offen sc1 lds
    buffer_load_dwordx4 v1, s[36:39], s15 offen offset:1024 sc1 lds
    v_rcp_f32 v80, v80
    v_rcp_f32 v81, v81
    v_rcp_f32 v82, v82
    v_mfma_f32_32x32x16_bf16 v[32:47], v[188:191], v[60:63], v[32:47]
    ds_read_b128 v[56:59], v1 offset:45056
    ds_read_b128 v[60:63], v1 offset:46080
    v_rcp_f32 v83, v83
    v_exp_f32 v88, v88
    v_exp_f32 v89, v89
    s_waitcnt lgkmcnt(4)
    v_mfma_f32_32x32x16_bf16 v[32:47], v[192:195], v[64:67], v[32:47]
    v_exp_f32 v90, v90
    v_exp_f32 v91, v91
    v_mfma_f32_32x32x16_bf16 v[32:47], v[196:199], v[68:71], v[32:47]
    ds_read_b128 v[64:67], v1 offset:47104
    ds_read_b128 v[68:71], v1 offset:48128
    v_fma_f32 v84, v84, v98, v98
    v_fma_f32 v85, v85, v98, v98
    v_fma_f32 v86, v86, v98, v98
    v_fma_f32 v87, v87, v98, v98
    v_mul_f32 v16, v16, v80
    v_mul_f32 v17, v17, v81
    s_waitcnt lgkmcnt(4)
    v_mfma_f32_32x32x16_bf16 v[32:47], v[200:203], v[48:51], v[32:47]
    s_add_u32 m0, s56, 98304
    s_nop 0
    buffer_load_dwordx4 v1, s[36:39], s20 offen sc1 lds
    buffer_load_dwordx4 v1, s[36:39], s20 offen offset:1024 sc1 lds
    v_mul_f32 v18, v18, v82
    v_mul_f32 v19, v19, v83
    v_cvt_pk_bf16_f32 v16, v16, v17
    v_cvt_pk_bf16_f32 v17, v18, v19
    v_mfma_f32_32x32x16_bf16 v[32:47], v[204:207], v[52:55], v[32:47]
    s_waitcnt vmcnt(6)
    s_barrier
    ds_read_b128 v[48:51], v1 offset:49152
    ds_read_b128 v[52:55], v1 offset:50176
    v_rcp_f32 v84, v84
    v_rcp_f32 v85, v85
    v_rcp_f32 v86, v86
    s_waitcnt lgkmcnt(4)
    v_mfma_f32_32x32x16_bf16 v[32:47], v[208:211], v[56:59], v[32:47]
    v_rcp_f32 v87, v87
    v_exp_f32 v92, v92
    v_exp_f32 v93, v93
    v_mfma_f32_32x32x16_bf16 v[32:47], v[212:215], v[60:63], v[32:47]
    ds_read_b128 v[56:59], v1 offset:51200
    ds_read_b128 v[60:63], v1 offset:52224
    v_exp_f32 v94, v94
    v_exp_f32 v95, v95
    s_waitcnt lgkmcnt(4)
    v_mfma_f32_32x32x16_bf16 v[32:47], v[216:219], v[64:67], v[32:47]
    s_add_u32 m0, s56, 106496
    s_nop 0
    buffer_load_dwordx4 v1, s[36:39], s21 offen sc1 lds
    buffer_load_dwordx4 v1, s[36:39], s21 offen offset:1024 sc1 lds
    v_fma_f32 v88, v88, v98, v98
    v_fma_f32 v89, v89, v98, v98
    v_fma_f32 v90, v90, v98, v98
    v_fma_f32 v91, v91, v98, v98
    v_mul_f32 v20, v20, v84
    v_mfma_f32_32x32x16_bf16 v[32:47], v[220:223], v[68:71], v[32:47]
    ds_read_b128 v[64:67], v1 offset:53248
    ds_read_b128 v[68:71], v1 offset:54272
    v_mul_f32 v21, v21, v85
    v_mul_f32 v22, v22, v86
    v_mul_f32 v23, v23, v87
    v_cvt_pk_bf16_f32 v18, v20, v21
    v_cvt_pk_bf16_f32 v19, v22, v23
    s_waitcnt lgkmcnt(4)
    v_mfma_f32_32x32x16_bf16 v[32:47], v[224:227], v[48:51], v[32:47]
    s_add_u32 m0, s59, 0
    s_mov_b32 s86, 0
    buffer_load_dwordx4 v15, s[16:19], s86 offen lds
    buffer_load_dwordx4 v12, s[16:19], s86 offen offset:1024 lds
    v_rcp_f32 v88, v88
    v_rcp_f32 v89, v89
    v_rcp_f32 v90, v90
    v_mfma_f32_32x32x16_bf16 v[32:47], v[228:231], v[52:55], v[32:47]
    ds_read_b128 v[48:51], v1 offset:55296
    ds_read_b128 v[52:55], v1 offset:56320
    v_rcp_f32 v91, v91
    v_fma_f32 v92, v92, v98, v98
    v_fma_f32 v93, v93, v98, v98
    v_fma_f32 v94, v94, v98, v98
    s_waitcnt lgkmcnt(4)
    v_mfma_f32_32x32x16_bf16 v[32:47], v[232:235], v[56:59], v[32:47]
    s_add_u32 m0, s59, 2048
    s_mov_b32 s86, 14336
    buffer_load_dwordx4 v15, s[16:19], s86 offen lds
    buffer_load_dwordx4 v12, s[16:19], s86 offen offset:1024 lds
    v_fma_f32 v95, v95, v98, v98
    v_mul_f32 v24, v24, v88
    v_mul_f32 v25, v25, v89
    v_mul_f32 v26, v26, v90
    v_mul_f32 v27, v27, v91
    v_mfma_f32_32x32x16_bf16 v[32:47], v[236:239], v[60:63], v[32:47]
    ds_read_b128 v[56:59], v105 offset:0
    ds_read_b128 v[60:63], v105 offset:1024
    v_cvt_pk_bf16_f32 v20, v24, v25
    v_cvt_pk_bf16_f32 v21, v26, v27
    v_rcp_f32 v92, v92
    v_rcp_f32 v93, v93
    s_waitcnt lgkmcnt(4)
    v_mfma_f32_32x32x16_bf16 v[32:47], v[240:243], v[64:67], v[32:47]
    s_add_u32 m0, s59, 4096
    s_mov_b32 s86, 114688
    buffer_load_dwordx4 v15, s[16:19], s86 offen lds
    buffer_load_dwordx4 v12, s[16:19], s86 offen offset:1024 lds
    v_rcp_f32 v94, v94
    v_rcp_f32 v95, v95
    v_mul_f32 v28, v28, v92
    v_mfma_f32_32x32x16_bf16 v[32:47], v[244:247], v[68:71], v[32:47]
    ds_read_b128 v[64:67], v105 offset:2048
    ds_read_b128 v[68:71], v105 offset:3072
    ds_read_b64 v[72:73], v3 offset:1024
    ds_read_b128 v[100:103], v14 offset:1024
    v_mul_f32 v29, v29, v93
    v_mul_f32 v30, v30, v94
    v_mul_f32 v31, v31, v95
    v_cvt_pk_bf16_f32 v22, v28, v29
    v_cvt_pk_bf16_f32 v23, v30, v31
    s_waitcnt lgkmcnt(6)
    v_mfma_f32_32x32x16_bf16 v[32:47], v[248:251], v[48:51], v[32:47]
    s_add_u32 m0, s59, 6144
    s_mov_b32 s86, 129024
    buffer_load_dwordx4 v15, s[16:19], s86 offen lds
    buffer_load_dwordx4 v12, s[16:19], s86 offen offset:1024 lds
    s_add_u32 s55, s84, 0
    s_cmp_lg_u32 s48, 0
    s_cbranch_scc1 Lslow_32
    buffer_store_dwordx4 v[16:19], v1, s[36:39], s55 offen offset:0
    buffer_store_dwordx4 v[20:23], v1, s[36:39], s55 offen offset:1024
Lback_33:
    v_mfma_f32_32x32x16_bf16 v[32:47], v[252:255], v[52:55], v[32:47]
    ds_read_b128 v[48:51], v105 offset:4096
    ds_read_b128 v[52:55], v105 offset:5120
    s_waitcnt lgkmcnt(3)
    v_mfma_f32_32x32x16_bf16 v[32:47], v[76:79], v[72:75], v[32:47]
    v_mfma_f32_32x32x16_bf16 v[16:31], a[224:227], v[56:59], 0
    v_mfma_f32_32x32x16_bf16 v[16:31], a[228:231], v[60:63], v[16:31]
    ds_read_b128 v[56:59], v105 offset:6144
    ds_read_b128 v[60:63], v105 offset:7168
    v_mfma_f32_32x32x16_bf16 v[16:31], a[232:235], v[64:67], v[16:31]
    s_nop 6
    v_pk_mul_f32 v[80:81], v[32:33], v[32:33]
    v_pk_mul_f32 v[82:83], v[34:35], v[34:35]
    v_pk_mul_f32 v[84:85], v[36:37], v[36:37]
    v_pk_mul_f32 v[86:87], v[38:39], v[38:39]
    v_pk_mul_f32 v[88:89], v[40:41], v[40:41]
    v_pk_mul_f32 v[90:91], v[42:43], v[42:43]
    v_pk_mul_f32 v[92:93], v[44:45], v[44:45]
    v_pk_mul_f32 v[94:95], v[46:47], v[46:47]
    s_waitcnt lgkmcnt(4)
    v_pk_fma_f32 v[80:81], v[80:81], v[100:101], v[100:101] op_sel:[0,1,0] op_sel_hi:[1,1,0]
    v_pk_fma_f32 v[82:83], v[82:83], v[100:101], v[100:101] op_sel:[0,1,0] op_sel_hi:[1,1,0]
    v_pk_fma_f32 v[84:85], v[84:85], v[100:101], v[100:101] op_sel:[0,1,0] op_sel_hi:[1,1,0]
    v_pk_fma_f32 v[86:87], v[86:87], v[100:101], v[100:101] op_sel:[0,1,0] op_sel_hi:[1,1,0]
    v_pk_fma_f32 v[88:89], v[88:89], v[100:101], v[100:101] op_sel:[0,1,0] op_sel_hi:[1,1,0]
    v_pk_fma_f32 v[90:91], v[90:91], v[100:101], v[100:101] op_sel:[0,1,0] op_sel_hi:[1,1,0]
    v_pk_fma_f32 v[92:93], v[92:93], v[100:101], v[100:101] op_sel:[0,1,0] op_sel_hi:[1,1,0]
    v_pk_fma_f32 v[94:95], v[94:95], v[100:101], v[100:101] op_sel:[0,1,0] op_sel_hi:[1,1,0]
    v_pk_mul_f32 v[80:81], v[80:81], v[32:33]
    v_pk_mul_f32 v[82:83], v[82:83], v[34:35]
    v_pk_mul_f32 v[84:85], v[84:85], v[36:37]
    v_pk_mul_f32 v[86:87], v[86:87], v[38:39]
    v_pk_mul_f32 v[88:89], v[88:89], v[40:41]
    v_pk_mul_f32 v[90:91], v[90:91], v[42:43]
    v_pk_mul_f32 v[92:93], v[92:93], v[44:45]
    v_pk_mul_f32 v[94:95], v[94:95], v[46:47]
    v_mfma_f32_32x32x16_bf16 v[16:31], a[236:239], v[68:71], v[16:31]
    ds_read_b128 v[64:67], v105 offset:8192
    ds_read_b128 v[68:71], v105 offset:9216
    v_exp_f32 v80, v80
    v_exp_f32 v81, v81
    s_waitcnt lgkmcnt(4)
    v_mfma_f32_32x32x16_bf16 v[16:31], a[240:243], v[48:51], v[16:31]
    v_exp_f32 v82, v82
    v_exp_f32 v83, v83
    v_exp_f32 v84, v84
    v_mfma_f32_32x32x16_bf16 v[16:31], a[244:247], v[52:55], v[16:31]
    ds_read_b128 v[48:51], v105 offset:10240
    ds_read_b128 v[52:55], v105 offset:11264
    v_exp_f32 v85, v85
    v_exp_f32 v86, v86
    s_waitcnt lgkmcnt(4)
    v_mfma_f32_32x32x16_bf16 v[16:31], a[248:251], v[56:59], v[16:31]
    s_add_u32 m0, s59, 8192
    s_mov_b32 s86, 229376
    buffer_load_dwordx4 v15, s[16:19], s86 offen lds
    buffer_load_dwordx4 v12, s[16:19], s86 offen offset:1024 lds
    v_exp_f32 v87, v87
    v_fma_f32 v80, v80, v102, v102
    v_fma_f32 v81, v81, v102, v102
    v_mfma_f32_32x32x16_bf16 v[16:31], a[252:255], v[60:63], v[16:31]
    ds_read_b128 v[56:59], v105 offset:12288
    ds_read_b128 v[60:63], v105 offset:13312
    s_waitcnt vmcnt(10)
    ds_read_b64_tr_b16 a[0:1], v140 offset:0
    ds_read_b64_tr_b16 a[2:3], v140 offset:1024
    ds_read_b64_tr_b16 a[4:5], v141 offset:0
    ds_read_b64_tr_b16 a[6:7], v141 offset:1024
    v_fma_f32 v82, v82, v102, v102
    v_fma_f32 v83, v83, v102, v102
    v_rcp_f32 v80, v80
    s_waitcnt lgkmcnt(8)
    v_mfma_f32_32x32x16_bf16 v[16:31], v[176:179], v[64:67], v[16:31]
    s_waitcnt lgkmcnt(0)
    s_add_u32 m0, s59, 0
    s_mov_b32 s86, 243712
    buffer_load_dwordx4 v15, s[16:19], s86 offen lds
    buffer_load_dwordx4 v12, s[16:19], s86 offen offset:1024 lds
    v_rcp_f32 v81, v81
    v_rcp_f32 v82, v82
    v_rcp_f32 v83, v83
    v_mfma_f32_32x32x16_bf16 v[16:31], v[180:183], v[68:71], v[16:31]
    ds_read_b128 v[64:67], v105 offset:14336
    ds_read_b128 v[68:71], v105 offset:15360
    s_waitcnt vmcnt(10)
    ds_read_b64_tr_b16 a[8:9], v140 offset:2048
    ds_read_b64_tr_b16 a[10:11], v140 offset:3072
    ds_read_b64_tr_b16 a[12:13], v141 offset:2048
    ds_read_b64_tr_b16 a[14:15], v141 offset:3072
    v_exp_f32 v88, v88
    v_exp_f32 v89, v89
    v_mfma_f32_32x32x16_bf16 v[16:31], v[184:187], v[48:51], v[16:31]
    v_exp_f32 v90, v90
    v_exp_f32 v91, v91
    v_mfma_f32_32x32x16_bf16 v[16:31], v[188:191], v[52:55], v[16:31]
    ds_read_b128 v[48:51], v105 offset:16384
    ds_read_b128 v[52:55], v105 offset:17408
    s_waitcnt lgkmcnt(2)
    s_add_u32 m0, s59, 2048
    s_mov_b32 s86, 344064
    buffer_load_dwordx4 v15, s[16:19], s86 offen lds
    buffer_load_dwordx4 v12, s[16:19], s86 offen offset:1024 lds
    v_fma_f32 v84, v84, v102, v102
    v_fma_f32 v85, v85, v102, v102
    v_fma_f32 v86, v86, v102, v102
    v_fma_f32 v87, v87, v102, v102
    v_mul_f32 v32, v32, v80
    v_mfma_f32_32x32x16_bf16 v[16:31], v[192:195], v[56:59], v[16:31]
    s_waitcnt vmcnt(10)
    ds_read_b64_tr_b16 a[16:17], v140 offset:4096
    ds_read_b64_tr_b16 a[18:19], v140 offset:5120
    ds_read_b64_tr_b16 a[20:21], v141 offset:4096
    ds_read_b64_tr_b16 a[22:23], v141 offset:5120
    v_mul_f32 v33, v33, v81
    v_mul_f32 v34, v34, v82
    v_mul_f32 v35, v35, v83
    v_cvt_pk_bf16_f32 v32, v32, v33
    v_mfma_f32_32x32x16_bf16 v[16:31], v[196:199], v[60:63], v[16:31]
    ds_read_b128 v[56:59], v105 offset:18432
    ds_read_b128 v[60:63], v105 offset:19456
    v_cvt_pk_bf16_f32 v33, v34, v35
    v_rcp_f32 v84, v84
    v_rcp_f32 v85, v85
    v_mfma_f32_32x32x16_bf16 v[16:31], v[200:203], v[64:67], v[16:31]
    s_waitcnt lgkmcnt(2)
    s_add_u32 m0, s59, 4096
    s_mov_b32 s86, 358400
    buffer_load_dwordx4 v15, s[16:19], s86 offen lds
    buffer_load_dwordx4 v12, s[16:19], s86 offen offset:1024 lds
    v_rcp_f32 v86, v86
    v_rcp_f32 v87, v87
    v_mfma_f32_32x32x16_bf16 v[16:31], v[204:207], v[68:71], v[16:31]
    ds_read_b128 v[64:67], v105 offset:20480
    ds_read_b128 v[68:71], v105 offset:21504
    s_waitcnt vmcnt(10)
    ds_read_b64_tr_b16 a[24:25], v140 offset:6144
    ds_read_b64_tr_b16 a[26:27], v140 offset:7168
    ds_read_b64_tr_b16 a[28:29], v141 offset:6144
    ds_read_b64_tr_b16 a[30:31], v141 offset:7168
    v_exp_f32 v92, v92
    v_exp_f32 v93, v93
    v_exp_f32 v94, v94
    v_mfma_f32_32x32x16_bf16 v[16:31], v[208:211], v[48:51], v[16:31]
    v_exp_f32 v95, v95
    v_fma_f32 v88, v88, v102, v102
    v_fma_f32 v89, v89, v102, v102
    v_mfma_f32_32x32x16_bf16 v[16:31], v[212:215], v[52:55], v[16:31]
    ds_read_b128 v[48:51], v105 offset:22528
    ds_read_b128 v[52:55], v105 offset:23552
    s_waitcnt lgkmcnt(2)
    s_add_u32 m0, s59, 6144
    s_mov_b32 s86, 458752
    buffer_load_dwordx4 v15, s[16:19], s86 offen lds
    buffer_load_dwordx4 v12, s[16:19], s86 offen offset:1024 lds
    v_fma_f32 v90, v90, v102, v102
    v_fma_f32 v91, v91, v102, v102
    v_mul_f32 v36, v36, v84
    v_mul_f32 v37, v37, v85
    v_mfma_f32_32x32x16_bf16 v[16:31], v[216:219], v[56:59], v[16:31]
    s_waitcnt vmcnt(8)
    ds_read_b64_tr_b16 a[32:33], v140 offset:8192
    ds_read_b64_tr_b16 a[34:35], v140 offset:9216
    ds_read_b64_tr_b16 a[36:37], v141 offset:8192
    ds_read_b64_tr_b16 a[38:39], v141 offset:9216
    v_mul_f32 v38, v38, v86
    v_mul_f32 v39, v39, v87
    v_cvt_pk_bf16_f32 v34, v36, v37
    v_cvt_pk_bf16_f32 v35, v38, v39
    v_mfma_f32_32x32x16_bf16 v[16:31], v[220:223], v[60:63], v[16:31]
    s_barrier
    ds_read_b128 v[56:59], v105 offset:24576
    ds_read_b128 v[60:63], v105 offset:25600
    v_rcp_f32 v88, v88
    v_rcp_f32 v89, v89
    v_rcp_f32 v90, v90
    v_mfma_f32_32x32x16_bf16 v[16:31], v[224:227], v[64:67], v[16:31]
    s_waitcnt lgkmcnt(2)
    s_add_u32 m0, s59, 8192
    s_mov_b32 s86, 473088
    buffer_load_dwordx4 v15, s[16:19], s86 offen lds
    buffer_load_dwordx4 v12, s[16:19], s86 offen offset:1024 lds
    v_rcp_f32 v91, v91
    v_fma_f32 v92, v92, v102, v102
    v_fma_f32 v93, v93, v102, v102
    v_mfma_f32_32x32x16_bf16 v[16:31], v[228:231], v[68:71], v[16:31]
    ds_read_b128 v[64:67], v105 offset:26624
    ds_read_b128 v[68:71], v105 offset:27648
    s_waitcnt vmcnt(8)
    ds_read_b64_tr_b16 a[40:41], v140 offset:0
    ds_read_b64_tr_b16 a[42:43], v140 offset:1024
    ds_read_b64_tr_b16 a[44:45], v141 offset:0
    ds_read_b64_tr_b16 a[46:47], v141 offset:1024
    v_fma_f32 v94, v94, v102, v102
    v_fma_f32 v95, v95, v102, v102
    v_mul_f32 v40, v40, v88
    v_mul_f32 v41, v41, v89
    v_mfma_f32_32x32x16_bf16 v[16:31], v[232:235], v[48:51], v[16:31]
    s_waitcnt lgkmcnt(0)
    s_add_u32 m0, s59, 0
    s_mov_b32 s86, 573440
    buffer_load_dwordx4 v15, s[16:19], s86 offen lds
    buffer_load_dwordx4 v12, s[16:19], s86 offen offset:1024 lds
    v_mul_f32 v42, v42, v90
    v_mul_f32 v43, v43, v91
    v_cvt_pk_bf16_f32 v36, v40, v41
    v_cvt_pk_bf16_f32 v37, v42, v43
    v_mfma_f32_32x32x16_bf16 v[16:31], v[236:239], v[52:55], v[16:31]
    ds_read_b128 v[48:51], v105 offset:28672
    ds_read_b128 v[52:55], v105 offset:29696
    s_waitcnt vmcnt(8)
    ds_read_b64_tr_b16 a[48:49], v140 offset:2048
    ds_read_b64_tr_b16 a[50:51], v140 offset:3072
    ds_read_b64_tr_b16 a[52:53], v141 offset:2048
    ds_read_b64_tr_b16 a[54:55], v141 offset:3072
    v_rcp_f32 v92, v92
    v_rcp_f32 v93, v93
    v_rcp_f32 v94, v94
    v_mfma_f32_32x32x16_bf16 v[16:31], v[240:243], v[56:59], v[16:31]
    v_rcp_f32 v95, v95
    v_mul_f32 v44, v44, v92
    v_mul_f32 v45, v45, v93
    v_mfma_f32_32x32x16_bf16 v[16:31], v[244:247], v[60:63], v[16:31]
    ds_read_b128 v[56:59], v105 offset:30720
    ds_read_b128 v[60:63], v105 offset:31744
    ds_read_b64 v[72:73], v3 offset:2048
    ds_read_b128 v[96:99], v14 offset:2048
    s_waitcnt lgkmcnt(4)
    s_add_u32 m0, s59, 2048
    s_mov_b32 s86, 587776
    buffer_load_dwordx4 v15, s[16:19], s86 offen lds
    buffer_load_dwordx4 v12, s[16:19], s86 offen offset:1024 lds
    v_mul_f32 v46, v46, v94
    v_mul_f32 v47, v47, v95
    v_cvt_pk_bf16_f32 v38, v44, v45
    v_cvt_pk_bf16_f32 v39, v46, v47
    v_mfma_f32_32x32x16_bf16 v[16:31], v[248:251], v[64:67], v[16:31]
    s_waitcnt vmcnt(8)
    ds_read_b64_tr_b16 a[56:57], v140 offset:4096
    ds_read_b64_tr_b16 a[58:59], v140 offset:5120
    ds_read_b64_tr_b16 a[60:61], v141 offset:4096
    ds_read_b64_tr_b16 a[62:63], v141 offset:5120
    s_add_u32 s55, s84, 114688
    s_cmp_lg_u32 s48, 0
    s_cbranch_scc1 Lslow_34
    buffer_store_dwordx4 v[32:35], v1, s[36:39], s55 offen offset:0
    buffer_store_dwordx4 v[36:39], v1, s[36:39], s55 offen offset:1024
Lback_35:
    v_mfma_f32_32x32x16_bf16 v[16:31], v[252:255], v[68:71], v[16:31]
    ds_read_b128 v[64:67], v105 offset:32768
    ds_read_b128 v[68:71], v105 offset:33792
    s_waitcnt lgkmcnt(7)
    v_mfma_f32_32x32x16_bf16 v[16:31], v[76:79], v[72:75], v[16:31]
    v_mfma_f32_32x32x16_bf16 v[32:47], a[224:227], v[48:51], 0
    s_waitcnt lgkmcnt(2)
    s_add_u32 m0, s59, 4096
    s_mov_b32 s86, 688128
    buffer_load_dwordx4 v15, s[16:19], s86 offen lds
    buffer_load_dwordx4 v12, s[16:19], s86 offen offset:1024 lds
    v_mfma_f32_32x32x16_bf16 v[32:47], a[228:231], v[52:55], v[32:47]
    ds_read_b128 v[48:51], v105 offset:34816
    ds_read_b128 v[52:55], v105 offset:35840
    s_waitcnt vmcnt(10)
    ds_read_b64_tr_b16 a[64:65], v140 offset:6144
    ds_read_b64_tr_b16 a[66:67], v140 offset:7168
    ds_read_b64_tr_b16 a[68:69], v141 offset:6144
    ds_read_b64_tr_b16 a[70:71], v141 offset:7168
    v_mfma_f32_32x32x16_bf16 v[32:47], a[232:235], v[56:59], v[32:47]
    v_pk_mul_f32 v[80:81], v[16:17], v[16:17]
    v_pk_mul_f32 v[82:83], v[18:19], v[18:19]
    v_pk_mul_f32 v[84:85], v[20:21], v[20:21]
    v_pk_mul_f32 v[86:87], v[22:23], v[22:23]
    v_pk_mul_f32 v[88:89], v[24:25], v[24:25]
    v_pk_mul_f32 v[90:91], v[26:27], v[26:27]
    v_pk_mul_f32 v[92:93], v[28:29], v[28:29]
    v_pk_mul_f32 v[94:95], v[30:31], v[30:31]
    v_pk_fma_f32 v[80:81], v[80:81], v[96:97], v[96:97] op_sel:[0,1,0] op_sel_hi:[1,1,0]
    v_pk_fma_f32 v[82:83], v[82:83], v[96:97], v[96:97] op_sel:[0,1,0] op_sel_hi:[1,1,0]
    v_pk_fma_f32 v[84:85], v[84:85], v[96:97], v[96:97] op_sel:[0,1,0] op_sel_hi:[1,1,0]
    v_pk_fma_f32 v[86:87], v[86:87], v[96:97], v[96:97] op_sel:[0,1,0] op_sel_hi:[1,1,0]
    v_pk_fma_f32 v[88:89], v[88:89], v[96:97], v[96:97] op_sel:[0,1,0] op_sel_hi:[1,1,0]
    v_pk_fma_f32 v[90:91], v[90:91], v[96:97], v[96:97] op_sel:[0,1,0] op_sel_hi:[1,1,0]
    v_pk_fma_f32 v[92:93], v[92:93], v[96:97], v[96:97] op_sel:[0,1,0] op_sel_hi:[1,1,0]
    v_pk_fma_f32 v[94:95], v[94:95], v[96:97], v[96:97] op_sel:[0,1,0] op_sel_hi:[1,1,0]
    v_pk_mul_f32 v[80:81], v[80:81], v[16:17]
    v_pk_mul_f32 v[82:83], v[82:83], v[18:19]
    v_pk_mul_f32 v[84:85], v[84:85], v[20:21]
    v_pk_mul_f32 v[86:87], v[86:87], v[22:23]
    v_pk_mul_f32 v[88:89], v[88:89], v[24:25]
    v_pk_mul_f32 v[90:91], v[90:91], v[26:27]
    v_pk_mul_f32 v[92:93], v[92:93], v[28:29]
    v_pk_mul_f32 v[94:95], v[94:95], v[30:31]
    v_mfma_f32_32x32x16_bf16 v[32:47], a[236:239], v[60:63], v[32:47]
    ds_read_b128 v[56:59], v105 offset:36864
    ds_read_b128 v[60:63], v105 offset:37888
    s_waitcnt lgkmcnt(2)
    s_add_u32 m0, s59, 6144
    s_mov_b32 s86, 702464
    buffer_load_dwordx4 v15, s[16:19], s86 offen lds
    buffer_load_dwordx4 v12, s[16:19], s86 offen offset:1024 lds
    v_exp_f32 v80, v80
    v_exp_f32 v81, v81
    v_mfma_f32_32x32x16_bf16 v[32:47], a[240:243], v[64:67], v[32:47]
    s_waitcnt vmcnt(10)
    ds_read_b64_tr_b16 a[72:73], v140 offset:8192
    ds_read_b64_tr_b16 a[74:75], v140 offset:9216
    ds_read_b64_tr_b16 a[76:77], v141 offset:8192
    ds_read_b64_tr_b16 a[78:79], v141 offset:9216
    v_exp_f32 v82, v82
    v_exp_f32 v83, v83
    v_exp_f32 v84, v84
    v_mfma_f32_32x32x16_bf16 v[32:47], a[244:247], v[68:71], v[32:47]
    ds_read_b128 v[64:67], v105 offset:38912
    ds_read_b128 v[68:71], v105 offset:39936
    v_exp_f32 v85, v85
    v_exp_f32 v86, v86
    v_mfma_f32_32x32x16_bf16 v[32:47], a[248:251], v[48:51], v[32:47]
    s_waitcnt lgkmcnt(2)
    s_add_u32 m0, s59, 8192
    s_mov_b32 s86, 802816
    buffer_load_dwordx4 v15, s[16:19], s86 offen lds
    buffer_load_dwordx4 v12, s[16:19], s86 offen offset:1024 lds
    v_exp_f32 v87, v87
    v_fma_f32 v80, v80, v98, v98
    v_fma_f32 v81, v81, v98, v98
    v_mfma_f32_32x32x16_bf16 v[32:47], a[252:255], v[52:55], v[32:47]
    ds_read_b128 v[48:51], v105 offset:40960
    ds_read_b128 v[52:55], v105 offset:41984
    s_waitcnt vmcnt(10)
    ds_read_b64_tr_b16 a[80:81], v140 offset:0
    ds_read_b64_tr_b16 a[82:83], v140 offset:1024
    ds_read_b64_tr_b16 a[84:85], v141 offset:0
    ds_read_b64_tr_b16 a[86:87], v141 offset:1024
    v_fma_f32 v82, v82, v98, v98
    v_fma_f32 v83, v83, v98, v98
    v_rcp_f32 v80, v80
    v_mfma_f32_32x32x16_bf16 v[32:47], v[176:179], v[56:59], v[32:47]
    v_rcp_f32 v81, v81
    v_rcp_f32 v82, v82
    v_rcp_f32 v83, v83
    v_mfma_f32_32x32x16_bf16 v[32:47], v[180:183], v[60:63], v[32:47]
    ds_read_b128 v[56:59], v105 offset:43008
    ds_read_b128 v[60:63], v105 offset:44032
    s_waitcnt lgkmcnt(2)
    s_add_u32 m0, s59, 0
    s_mov_b32 s86, 817152
    buffer_load_dwordx4 v15, s[16:19], s86 offen lds
    buffer_load_dwordx4 v12, s[16:19], s86 offen offset:1024 lds
    v_exp_f32 v88, v88
    v_exp_f32 v89, v89
    v_mfma_f32_32x32x16_bf16 v[32:47], v[184:187], v[64:67], v[32:47]
    s_waitcnt vmcnt(10)
    ds_read_b64_tr_b16 a[88:89], v140 offset:2048
    ds_read_b64_tr_b16 a[90:91], v140 offset:3072
    ds_read_b64_tr_b16 a[92:93], v141 offset:2048
    ds_read_b64_tr_b16 a[94:95], v141 offset:3072
    v_exp_f32 v90, v90
    v_exp_f32 v91, v91
    v_mfma_f32_32x32x16_bf16 v[32:47], v[188:191], v[68:71], v[32:47]
    ds_read_b128 v[64:67], v105 offset:45056
    ds_read_b128 v[68:71], v105 offset:46080
    s_waitcnt lgkmcnt(2)
    s_add_u32 m0, s59, 2048
    s_mov_b32 s86, 917504
    buffer_load_dwordx4 v15, s[16:19], s86 offen lds
    buffer_load_dwordx4 v12, s[16:19], s86 offen offset:1024 lds
    v_fma_f32 v84, v84, v98, v98
    v_fma_f32 v85, v85, v98, v98
    v_fma_f32 v86, v86, v98, v98
    v_fma_f32 v87, v87, v98, v98
    v_mul_f32 v16, v16, v80
    v_mfma_f32_32x32x16_bf16 v[32:47], v[192:195], v[48:51], v[32:47]
    s_waitcnt vmcnt(8)
    ds_read_b64_tr_b16 a[96:97], v140 offset:4096
    ds_read_b64_tr_b16 a[98:99], v140 offset:5120
    ds_read_b64_tr_b16 a[100:101], v141 offset:4096
    ds_read_b64_tr_b16 a[102:103], v141 offset:5120
    v_mul_f32 v17, v17, v81
    v_mul_f32 v18, v18, v82
    v_mul_f32 v19, v19, v83
    v_cvt_pk_bf16_f32 v16, v16, v17
    v_mfma_f32_32x32x16_bf16 v[32:47], v[196:199], v[52:55], v[32:47]
    ds_read_b128 v[48:51], v105 offset:47104
    ds_read_b128 v[52:55], v105 offset:48128
    v_cvt_pk_bf16_f32 v17, v18, v19
    v_rcp_f32 v84, v84
    v_rcp_f32 v85, v85
    v_mfma_f32_32x32x16_bf16 v[32:47], v[200:203], v[56:59], v[32:47]
    v_rcp_f32 v86, v86
    v_rcp_f32 v87, v87
    v_mfma_f32_32x32x16_bf16 v[32:47], v[204:207], v[60:63], v[32:47]
    ds_read_b128 v[56:59], v105 offset:49152
    ds_read_b128 v[60:63], v105 offset:50176
    s_waitcnt vmcnt(6)
    ds_read_b64_tr_b16 a[104:105], v140 offset:6144
    ds_read_b64_tr_b16 a[106:107], v140 offset:7168
    ds_read_b64_tr_b16 a[108:109], v141 offset:6144
    ds_read_b64_tr_b16 a[110:111], v141 offset:7168
    v_exp_f32 v92, v92
    v_exp_f32 v93, v93
    v_exp_f32 v94, v94
    s_waitcnt lgkmcnt(12)
    v_mfma_f32_32x32x16_bf16 v[32:47], v[208:211], v[64:67], v[32:47]
    v_exp_f32 v95, v95
    v_fma_f32 v88, v88, v98, v98
    v_fma_f32 v89, v89, v98, v98
    v_mfma_f32_32x32x16_bf16 v[32:47], v[212:215], v[68:71], v[32:47]
    ds_read_b128 v[64:67], v105 offset:51200
    ds_read_b128 v[68:71], v105 offset:52224
    v_fma_f32 v90, v90, v98, v98
    v_fma_f32 v91, v91, v98, v98
    v_mul_f32 v20, v20, v84
    v_mul_f32 v21, v21, v85
    s_waitcnt lgkmcnt(8)
    v_mfma_f32_32x32x16_bf16 v[32:47], v[216:219], v[48:51], v[32:47]
    s_waitcnt vmcnt(4)
    ds_read_b64_tr_b16 a[112:113], v140 offset:8192
    ds_read_b64_tr_b16 a[114:115], v140 offset:9216
    ds_read_b64_tr_b16 a[116:117], v141 offset:8192
    ds_read_b64_tr_b16 a[118:119], v141 offset:9216
    v_mul_f32 v22, v22, v86
    v_mul_f32 v23, v23, v87
    v_cvt_pk_bf16_f32 v18, v20, v21
    v_cvt_pk_bf16_f32 v19, v22, v23
    v_mfma_f32_32x32x16_bf16 v[32:47], v[220:223], v[52:55], v[32:47]
    ds_read_b128 v[48:51], v105 offset:53248
    ds_read_b128 v[52:55], v105 offset:54272
    v_rcp_f32 v88, v88
    v_rcp_f32 v89, v89
    v_rcp_f32 v90, v90
    s_waitcnt lgkmcnt(12)
    v_mfma_f32_32x32x16_bf16 v[32:47], v[224:227], v[56:59], v[32:47]
    v_rcp_f32 v91, v91
    v_fma_f32 v92, v92, v98, v98
    v_fma_f32 v93, v93, v98, v98
    v_mfma_f32_32x32x16_bf16 v[32:47], v[228:231], v[60:63], v[32:47]
    ds_read_b128 v[56:59], v105 offset:55296
    ds_read_b128 v[60:63], v105 offset:56320
    s_waitcnt vmcnt(2)
    ds_read_b64_tr_b16 a[120:121], v140 offset:0
    ds_read_b64_tr_b16 a[122:123], v140 offset:1024
    ds_read_b64_tr_b16 a[124:125], v141 offset:0
    ds_read_b64_tr_b16 a[126:127], v141 offset:1024
    v_fma_f32 v94, v94, v98, v98
    v_fma_f32 v95, v95, v98, v98
    v_mul_f32 v24, v24, v88
    v_mul_f32 v25, v25, v89
    s_waitcnt lgkmcnt(12)
    v_mfma_f32_32x32x16_bf16 v[32:47], v[232:235], v[64:67], v[32:47]
    v_mul_f32 v26, v26, v90
    v_mul_f32 v27, v27, v91
    v_cvt_pk_bf16_f32 v20, v24, v25
    v_cvt_pk_bf16_f32 v21, v26, v27
    v_mfma_f32_32x32x16_bf16 v[32:47], v[236:239], v[68:71], v[32:47]
    v_rcp_f32 v92, v92
    v_rcp_f32 v93, v93
    v_rcp_f32 v94, v94
    s_waitcnt lgkmcnt(6)
    v_mfma_f32_32x32x16_bf16 v[32:47], v[240:243], v[48:51], v[32:47]
    s_waitcnt vmcnt(0)
    ds_read_b64_tr_b16 a[128:129], v140 offset:2048
    ds_read_b64_tr_b16 a[130:131], v140 offset:3072
    ds_read_b64_tr_b16 a[132:133], v141 offset:2048
    ds_read_b64_tr_b16 a[134:135], v141 offset:3072
    v_rcp_f32 v95, v95
    v_mul_f32 v28, v28, v92
    v_mul_f32 v29, v29, v93
    v_mfma_f32_32x32x16_bf16 v[32:47], v[244:247], v[52:55], v[32:47]
    ds_read_b64 v[72:73], v3 offset:3072
    ds_read_b128 v[100:103], v14 offset:3072
    v_mul_f32 v30, v30, v94
    v_mul_f32 v31, v31, v95
    v_cvt_pk_bf16_f32 v22, v28, v29
    v_cvt_pk_bf16_f32 v23, v30, v31
    s_waitcnt lgkmcnt(10)
    v_mfma_f32_32x32x16_bf16 v[32:47], v[248:251], v[56:59], v[32:47]
    s_add_u32 s55, s84, 229376
    s_cmp_lg_u32 s48, 0
    s_cbranch_scc1 Lslow_36
    buffer_store_dwordx4 v[16:19], v1, s[36:39], s55 offen offset:0
    buffer_store_dwordx4 v[20:23], v1, s[36:39], s55 offen offset:1024
Lback_37:
    v_mfma_f32_32x32x16_bf16 v[32:47], v[252:255], v[60:63], v[32:47]
    s_waitcnt lgkmcnt(1)
    v_mfma_f32_32x32x16_bf16 v[32:47], v[76:79], v[72:75], v[32:47]
    s_waitcnt lgkmcnt(0)
    s_barrier
    s_add_u32 m0, s85, 0
    s_mov_b32 s86, 931840
    buffer_load_dwordx4 v15, s[16:19], s86 offen lds
    buffer_load_dwordx4 v12, s[16:19], s86 offen offset:1024 lds
    s_add_u32 m0, s85, 2048
    s_mov_b32 s86, 1032192
    buffer_load_dwordx4 v15, s[16:19], s86 offen lds
    buffer_load_dwordx4 v12, s[16:19], s86 offen offset:1024 lds
    s_add_u32 m0, s85, 4096
    s_mov_b32 s86, 1046528
    buffer_load_dwordx4 v15, s[16:19], s86 offen lds
    buffer_load_dwordx4 v12, s[16:19], s86 offen offset:1024 lds
    s_add_u32 m0, s87, 0
    s_mov_b32 s86, 1146880
    buffer_load_dwordx4 v15, s[16:19], s86 offen lds
    buffer_load_dwordx4 v12, s[16:19], s86 offen offset:1024 lds
    s_add_u32 m0, s87, 2048
    s_mov_b32 s86, 1161216
    buffer_load_dwordx4 v15, s[16:19], s86 offen lds
    buffer_load_dwordx4 v12, s[16:19], s86 offen offset:1024 lds
    ds_write_b128 v13, a[140:143] offset:0
    s_waitcnt vmcnt(8)
    ds_read_b64_tr_b16 a[136:137], v106 offset:0
    ds_read_b64_tr_b16 a[138:139], v106 offset:1024
    ds_read_b64_tr_b16 a[140:141], v107 offset:0
    ds_read_b64_tr_b16 a[142:143], v107 offset:1024
    v_pk_mul_f32 v[80:81], v[32:33], v[32:33]
    v_pk_mul_f32 v[82:83], v[34:35], v[34:35]
    v_pk_mul_f32 v[84:85], v[36:37], v[36:37]
    v_pk_mul_f32 v[86:87], v[38:39], v[38:39]
    v_pk_mul_f32 v[88:89], v[40:41], v[40:41]
    v_pk_mul_f32 v[90:91], v[42:43], v[42:43]
    v_pk_mul_f32 v[92:93], v[44:45], v[44:45]
    v_pk_mul_f32 v[94:95], v[46:47], v[46:47]
    v_pk_fma_f32 v[80:81], v[80:81], v[100:101], v[100:101] op_sel:[0,1,0] op_sel_hi:[1,1,0]
    v_pk_fma_f32 v[82:83], v[82:83], v[100:101], v[100:101] op_sel:[0,1,0] op_sel_hi:[1,1,0]
    v_pk_fma_f32 v[84:85], v[84:85], v[100:101], v[100:101] op_sel:[0,1,0] op_sel_hi:[1,1,0]
    v_pk_fma_f32 v[86:87], v[86:87], v[100:101], v[100:101] op_sel:[0,1,0] op_sel_hi:[1,1,0]
    v_pk_fma_f32 v[88:89], v[88:89], v[100:101], v[100:101] op_sel:[0,1,0] op_sel_hi:[1,1,0]
    v_pk_fma_f32 v[90:91], v[90:91], v[100:101], v[100:101] op_sel:[0,1,0] op_sel_hi:[1,1,0]
    v_pk_fma_f32 v[92:93], v[92:93], v[100:101], v[100:101] op_sel:[0,1,0] op_sel_hi:[1,1,0]
    v_pk_fma_f32 v[94:95], v[94:95], v[100:101], v[100:101] op_sel:[0,1,0] op_sel_hi:[1,1,0]
    v_pk_mul_f32 v[80:81], v[80:81], v[32:33]
    v_pk_mul_f32 v[82:83], v[82:83], v[34:35]
    v_pk_mul_f32 v[84:85], v[84:85], v[36:37]
    v_pk_mul_f32 v[86:87], v[86:87], v[38:39]
    v_pk_mul_f32 v[88:89], v[88:89], v[40:41]
    v_pk_mul_f32 v[90:91], v[90:91], v[42:43]
    v_pk_mul_f32 v[92:93], v[92:93], v[44:45]
    v_pk_mul_f32 v[94:95], v[94:95], v[46:47]
    s_mov_b64 exec, 1
    s_cmp_lg_u32 s48, 0
    s_cbranch_scc1 Lslow_40
    buffer_store_dword v4, off, s[36:39], s77 offset:1536
Lback_41:
    s_mov_b64 exec, -1
    s_mov_b64 exec, 1
    s_cmp_lg_u32 s48, 0
    s_cbranch_scc1 Lslow_42
    buffer_store_dword v4, off, s[36:39], s77 offset:2048
Lback_43:
    s_mov_b64 exec, -1
    s_waitcnt lgkmcnt(0)
    s_add_u32 m0, s85, 0
    s_mov_b32 s86, 1261568
    buffer_load_dwordx4 v15, s[16:19], s86 offen lds
    buffer_load_dwordx4 v12, s[16:19], s86 offen offset:1024 lds
    ds_write_b128 v13, a[144:147] offset:1024
    ds_write_b128 v13, a[148:151] offset:2048
    s_waitcnt vmcnt(10)
    ds_read_b64_tr_b16 a[144:145], v106 offset:2048
    ds_read_b64_tr_b16 a[146:147], v106 offset:3072
    ds_read_b64_tr_b16 a[148:149], v107 offset:2048
    ds_read_b64_tr_b16 a[150:151], v107 offset:3072
    s_mov_b64 exec, 1
    s_cmp_lg_u32 s48, 0
    s_cbranch_scc1 Lslow_44
    buffer_store_dword v4, off, s[36:39], s77 offset:2560
Lback_45:
    s_mov_b64 exec, -1
    v_exp_f32 v80, v80
    v_exp_f32 v81, v81
    v_exp_f32 v82, v82
    v_exp_f32 v83, v83
    v_exp_f32 v84, v84
    v_exp_f32 v85, v85
    v_exp_f32 v86, v86
    v_exp_f32 v87, v87
    v_exp_f32 v88, v88
    v_exp_f32 v89, v89
    v_exp_f32 v90, v90
    v_exp_f32 v91, v91
    v_exp_f32 v92, v92
    v_exp_f32 v93, v93
    s_waitcnt lgkmcnt(0)
    s_add_u32 m0, s85, 2048
    s_mov_b32 s86, 1275904
    buffer_load_dwordx4 v15, s[16:19], s86 offen lds
    buffer_load_dwordx4 v12, s[16:19], s86 offen offset:1024 lds
    ds_write_b128 v13, a[152:155] offset:3072
    ds_write_b128 v13, a[156:159] offset:4096
    s_waitcnt vmcnt(11)
    ds_read_b64_tr_b16 a[152:153], v106 offset:4096
    ds_read_b64_tr_b16 a[154:155], v106 offset:5120
    ds_read_b64_tr_b16 a[156:157], v107 offset:4096
    ds_read_b64_tr_b16 a[158:159], v107 offset:5120
    v_exp_f32 v94, v94
    v_exp_f32 v95, v95
    v_pk_fma_f32 v[80:81], v[80:81], v[102:103], v[102:103] op_sel_hi:[1,0,0]
    v_pk_fma_f32 v[82:83], v[82:83], v[102:103], v[102:103] op_sel_hi:[1,0,0]
    v_pk_fma_f32 v[84:85], v[84:85], v[102:103], v[102:103] op_sel_hi:[1,0,0]
    v_pk_fma_f32 v[86:87], v[86:87], v[102:103], v[102:103] op_sel_hi:[1,0,0]
    v_pk_fma_f32 v[88:89], v[88:89], v[102:103], v[102:103] op_sel_hi:[1,0,0]
    v_pk_fma_f32 v[90:91], v[90:91], v[102:103], v[102:103] op_sel_hi:[1,0,0]
    v_pk_fma_f32 v[92:93], v[92:93], v[102:103], v[102:103] op_sel_hi:[1,0,0]
    v_pk_fma_f32 v[94:95], v[94:95], v[102:103], v[102:103] op_sel_hi:[1,0,0]
    v_rcp_f32 v80, v80
    v_rcp_f32 v81, v81
    v_rcp_f32 v82, v82
    v_rcp_f32 v83, v83
    v_rcp_f32 v84, v84
    v_rcp_f32 v85, v85
    v_rcp_f32 v86, v86
    v_rcp_f32 v87, v87
    v_rcp_f32 v88, v88
    v_rcp_f32 v89, v89
    s_waitcnt lgkmcnt(0)
    s_add_u32 m0, s85, 4096
    s_mov_b32 s86, 1376256
    buffer_load_dwordx4 v15, s[16:19], s86 offen lds
    buffer_load_dwordx4 v12, s[16:19], s86 offen offset:1024 lds
    ds_write_b128 v13, a[160:163] offset:5120
    ds_write_b128 v13, a[164:167] offset:6144
    s_waitcnt vmcnt(11)
    ds_read_b64_tr_b16 a[160:161], v5 offset:0
    ds_read_b64_tr_b16 a[162:163], v5 offset:1024
    ds_read_b64_tr_b16 a[164:165], v6 offset:0
    ds_read_b64_tr_b16 a[166:167], v6 offset:1024
    v_and_b32 v10, 15, v0
    v_min_u32 v10, 13, v10
    v_lshlrev_b32 v10, 2, v10
    buffer_load_dword v9, v10, s[36:39], s82 offen sc1
    v_rcp_f32 v90, v90
    v_rcp_f32 v91, v91
    v_rcp_f32 v92, v92
    v_rcp_f32 v93, v93
    v_rcp_f32 v94, v94
    v_rcp_f32 v95, v95
    v_pk_mul_f32 v[32:33], v[32:33], v[80:81]
    v_pk_mul_f32 v[34:35], v[34:35], v[82:83]
    v_pk_mul_f32 v[36:37], v[36:37], v[84:85]
    v_pk_mul_f32 v[38:39], v[38:39], v[86:87]
    v_pk_mul_f32 v[40:41], v[40:41], v[88:89]
    v_pk_mul_f32 v[42:43], v[42:43], v[90:91]
    v_pk_mul_f32 v[44:45], v[44:45], v[92:93]
    v_pk_mul_f32 v[46:47], v[46:47], v[94:95]
    v_cvt_pk_bf16_f32 v32, v32, v33
    v_cvt_pk_bf16_f32 v33, v34, v35
    v_cvt_pk_bf16_f32 v34, v36, v37
    v_cvt_pk_bf16_f32 v35, v38, v39
    v_cvt_pk_bf16_f32 v36, v40, v41
    v_cvt_pk_bf16_f32 v37, v42, v43
    v_cvt_pk_bf16_f32 v38, v44, v45
    v_cvt_pk_bf16_f32 v39, v46, v47
    s_add_u32 s55, s84, 344064
    s_cmp_lg_u32 s48, 0
    s_cbranch_scc1 Lslow_38
    buffer_store_dwordx4 v[32:35], v1, s[36:39], s55 offen offset:0
    buffer_store_dwordx4 v[36:39], v1, s[36:39], s55 offen offset:1024
Lback_39:
    s_waitcnt lgkmcnt(0)
    s_add_u32 m0, s87, 0
    s_mov_b32 s86, 1390592
    buffer_load_dwordx4 v15, s[16:19], s86 offen lds
    buffer_load_dwordx4 v12, s[16:19], s86 offen offset:1024 lds
    ds_write_b128 v13, a[168:171] offset:7168
    ds_write_b128 v13, a[172:175] offset:8192
    s_waitcnt vmcnt(14)
    ds_read_b64_tr_b16 a[168:169], v5 offset:2048
    ds_read_b64_tr_b16 a[170:171], v5 offset:3072
    ds_read_b64_tr_b16 a[172:173], v6 offset:2048
    ds_read_b64_tr_b16 a[174:175], v6 offset:3072
    ds_read_b128 v[48:51], v104 offset:0
    ds_read_b128 v[52:55], v104 offset:16
    ds_read_b128 v[56:59], v104 offset:32
    ds_read_b128 v[60:63], v104 offset:48
    s_waitcnt vmcnt(4)
    v_cmp_ne_u32 vcc, s47, v9
    s_cbranch_vccnz Lspin_46
Lgot_47:
    buffer_load_dwordx4 v[96:99], v1, s[36:39], s34 offen sc1
    s_add_u32 s72, s80, 0
    buffer_load_dwordx4 v[108:111], v1, s[36:39], s72 offen offset:0 sc1
    buffer_load_dwordx4 v[112:115], v1, s[36:39], s72 offen offset:1024 sc1
    s_add_u32 s72, s80, 8192
    buffer_load_dwordx4 v[116:119], v1, s[36:39], s72 offen offset:0 sc1
    buffer_load_dwordx4 v[120:123], v1, s[36:39], s72 offen offset:1024 sc1
    s_add_u32 s72, s80, 16384
    buffer_load_dwordx4 v[124:127], v1, s[36:39], s72 offen offset:0 sc1
    buffer_load_dwordx4 v[128:131], v1, s[36:39], s72 offen offset:1024 sc1
    s_add_u32 s72, s80, 24576
    buffer_load_dwordx4 v[132:135], v1, s[36:39], s72 offen offset:0 sc1
    buffer_load_dwordx4 v[136:139], v1, s[36:39], s72 offen offset:1024 sc1
    s_add_u32 s72, s80, 32768
    buffer_load_dwordx4 v[140:143], v1, s[36:39], s72 offen offset:0 sc1
    s_waitcnt vmcnt(9) lgkmcnt(0)
    v_mfma_f32_32x32x16_bf16 v[48:63], v[172:175], v[96:99], v[48:63]
    s_waitcnt vmcnt(8)
    v_mfma_f32_32x32x16_bf16 v[48:63], a[0:3], v[108:111], v[48:63]
    buffer_load_dwordx4 v[144:147], v1, s[36:39], s72 offen offset:1024 sc1
    v_mfma_f32_32x32x16_bf16 v[64:79], a[4:7], v[108:111], 0
    s_add_u32 m0, s87, 2048
    s_mov_b32 s86, 1490944
    buffer_load_dwordx4 v15, s[16:19], s86 offen lds
    buffer_load_dwordx4 v12, s[16:19], s86 offen offset:1024 lds
    ds_write_b128 v13, a[176:179] offset:9216
    s_waitcnt vmcnt(10)
    v_mfma_f32_32x32x16_bf16 v[48:63], a[8:11], v[112:115], v[48:63]
    s_add_u32 s72, s80, 40960
    buffer_load_dwordx4 v[148:151], v1, s[36:39], s72 offen offset:0 sc1
    ds_write_b128 v13, a[180:183] offset:10240
    v_mfma_f32_32x32x16_bf16 v[64:79], a[12:15], v[112:115], v[64:79]
    ds_read_b64_tr_b16 a[176:177], v106 offset:0
    ds_read_b64_tr_b16 a[178:179], v106 offset:1024
    ds_read_b64_tr_b16 a[180:181], v107 offset:0
    ds_read_b64_tr_b16 a[182:183], v107 offset:1024
    s_waitcnt vmcnt(10)
    v_mfma_f32_32x32x16_bf16 v[48:63], a[16:19], v[116:119], v[48:63]
    buffer_load_dwordx4 v[152:155], v1, s[36:39], s72 offen offset:1024 sc1
    s_mov_b64 exec, 1
    s_cmp_lg_u32 s48, 0
    s_cbranch_scc1 Lslow_50
    buffer_store_dword v4, off, s[36:39], s77 offset:3072
Lback_51:
    s_mov_b64 exec, -1
    v_mfma_f32_32x32x16_bf16 v[64:79], a[20:23], v[116:119], v[64:79]
    s_waitcnt vmcnt(11)
    v_mfma_f32_32x32x16_bf16 v[48:63], a[24:27], v[120:123], v[48:63]
    s_add_u32 s72, s80, 49152
    buffer_load_dwordx4 v[156:159], v1, s[36:39], s72 offen offset:0 sc1
    v_mfma_f32_32x32x16_bf16 v[64:79], a[28:31], v[120:123], v[64:79]
    s_waitcnt lgkmcnt(0)
    s_add_u32 m0, s85, 0
    s_mov_b32 s86, 1505280
    buffer_load_dwordx4 v15, s[16:19], s86 offen lds
    buffer_load_dwordx4 v12, s[16:19], s86 offen offset:1024 lds
    ds_write_b128 v13, a[184:187] offset:11264
    s_waitcnt vmcnt(13)
    v_mfma_f32_32x32x16_bf16 v[48:63], a[32:35], v[124:127], v[48:63]
    buffer_load_dwordx4 v[160:163], v1, s[36:39], s72 offen offset:1024 sc1
    ds_write_b128 v13, a[188:191] offset:12288
    v_mfma_f32_32x32x16_bf16 v[64:79], a[36:39], v[124:127], v[64:79]
    ds_read_b64_tr_b16 a[184:185], v106 offset:2048
    ds_read_b64_tr_b16 a[186:187], v106 offset:3072
    ds_read_b64_tr_b16 a[188:189], v107 offset:2048
    ds_read_b64_tr_b16 a[190:191], v107 offset:3072
    s_waitcnt vmcnt(13)
    v_mfma_f32_32x32x16_bf16 v[48:63], a[40:43], v[128:131], v[48:63]
    s_add_u32 s72, s80, 57344
    buffer_load_dwordx4 v[164:167], v1, s[36:39], s72 offen offset:0 sc1
    v_mfma_f32_32x32x16_bf16 v[64:79], a[44:47], v[128:131], v[64:79]
    s_waitcnt vmcnt(13)
    v_mfma_f32_32x32x16_bf16 v[48:63], a[48:51], v[132:135], v[48:63]
    buffer_load_dwordx4 v[168:171], v1, s[36:39], s72 offen offset:1024 sc1
    v_mfma_f32_32x32x16_bf16 v[64:79], a[52:55], v[132:135], v[64:79]
    ds_write_b128 v13, a[192:195] offset:13312
    s_waitcnt vmcnt(13)
    v_mfma_f32_32x32x16_bf16 v[48:63], a[56:59], v[136:139], v[48:63]
    s_add_u32 s72, s80, 65536
    buffer_load_dwordx4 v[108:111], v1, s[36:39], s72 offen offset:0 sc1
    ds_write_b128 v13, a[196:199] offset:14336
    v_mfma_f32_32x32x16_bf16 v[64:79], a[60:63], v[136:139], v[64:79]
    ds_read_b64_tr_b16 a[192:193], v106 offset:4096
    ds_read_b64_tr_b16 a[194:195], v106 offset:5120
    ds_read_b64_tr_b16 a[196:197], v107 offset:4096
    ds_read_b64_tr_b16 a[198:199], v107 offset:5120
    s_waitcnt vmcnt(13)
    v_mfma_f32_32x32x16_bf16 v[48:63], a[64:67], v[140:143], v[48:63]
    buffer_load_dwordx4 v[112:115], v1, s[36:39], s72 offen offset:1024 sc1
    v_mfma_f32_32x32x16_bf16 v[64:79], a[68:71], v[140:143], v[64:79]
    s_waitcnt vmcnt(13)
    v_mfma_f32_32x32x16_bf16 v[48:63], a[72:75], v[144:147], v[48:63]
    s_add_u32 s72, s80, 73728
    buffer_load_dwordx4 v[116:119], v1, s[36:39], s72 offen offset:0 sc1
    v_mfma_f32_32x32x16_bf16 v[64:79], a[76:79], v[144:147], v[64:79]
    ds_write_b128 v13, a[200:203] offset:15360
    s_waitcnt vmcnt(11)
    v_mfma_f32_32x32x16_bf16 v[48:63], a[80:83], v[148:151], v[48:63]
    buffer_load_dwordx4 v[120:123], v1, s[36:39], s72 offen offset:1024 sc1
    ds_write_b128 v13, a[204:207] offset:16384
    buffer_load_dword v9, v10, s[36:39], s83 offen sc1
    v_mfma_f32_32x32x16_bf16 v[64:79], a[84:87], v[148:151], v[64:79]
    ds_read_b64_tr_b16 a[200:201], v5 offset:0
    ds_read_b64_tr_b16 a[202:203], v5 offset:1024
    ds_read_b64_tr_b16 a[204:205], v6 offset:0
    ds_read_b64_tr_b16 a[206:207], v6 offset:1024
    s_waitcnt vmcnt(12)
    v_mfma_f32_32x32x16_bf16 v[48:63], a[88:91], v[152:155], v[48:63]
    s_add_u32 s72, s80, 81920
    buffer_load_dwordx4 v[124:127], v1, s[36:39], s72 offen offset:0 sc1
    v_mfma_f32_32x32x16_bf16 v[64:79], a[92:95], v[152:155], v[64:79]
    s_waitcnt vmcnt(11)
    v_mfma_f32_32x32x16_bf16 v[48:63], a[96:99], v[156:159], v[48:63]
    buffer_load_dwordx4 v[128:131], v1, s[36:39], s72 offen offset:1024 sc1
    v_mfma_f32_32x32x16_bf16 v[64:79], a[100:103], v[156:159], v[64:79]
    ds_write_b128 v13, a[208:211] offset:17408
    s_waitcnt vmcnt(9)
    v_mfma_f32_32x32x16_bf16 v[48:63], a[104:107], v[160:163], v[48:63]
    s_add_u32 s72, s80, 90112
    buffer_load_dwordx4 v[132:135], v1, s[36:39], s72 offen offset:0 sc1
    ds_write_b128 v13, a[212:215] offset:18432
    v_mfma_f32_32x32x16_bf16 v[64:79], a[108:111], v[160:163], v[64:79]
    ds_read_b64_tr_b16 a[208:209], v5 offset:2048
    ds_read_b64_tr_b16 a[210:211], v5 offset:3072
    ds_read_b64_tr_b16 a[212:213], v6 offset:2048
    ds_read_b64_tr_b16 a[214:215], v6 offset:3072
    s_waitcnt vmcnt(9)
    v_mfma_f32_32x32x16_bf16 v[48:63], a[112:115], v[164:167], v[48:63]
    buffer_load_dwordx4 v[136:139], v1, s[36:39], s72 offen offset:1024 sc1
    v_mfma_f32_32x32x16_bf16 v[64:79], a[116:119], v[164:167], v[64:79]
    s_waitcnt vmcnt(9)
    v_mfma_f32_32x32x16_bf16 v[48:63], a[120:123], v[168:171], v[48:63]
    s_add_u32 s72, s80, 98304
    buffer_load_dwordx4 v[140:143], v1, s[36:39], s72 offen offset:0 sc1
    s_xor_b32 s54, s46, 2
    s_mul_i32 s54, s54, 6144
    s_add_u32 s54, s54, 88064
    v_add_u32 v3, s54, v1
    v_mfma_f32_32x32x16_bf16 v[64:79], a[124:127], v[168:171], v[64:79]
    ds_write_b128 v13, a[216:219] offset:19456
    s_waitcnt vmcnt(9)
    v_mfma_f32_32x32x16_bf16 v[48:63], a[128:131], v[108:111], v[48:63]
    buffer_load_dwordx4 v[144:147], v1, s[36:39], s72 offen offset:1024 sc1
    ds_write_b128 v13, a[220:223] offset:20480
    s_xor_b32 s54, s46, 1
    s_mul_i32 s54, s54, 6144
    s_add_u32 s54, s54, 86016
    v_add_u32 v11, s54, v1
    v_mfma_f32_32x32x16_bf16 v[64:79], a[132:135], v[108:111], v[64:79]
    ds_read_b64_tr_b16 a[216:217], v106 offset:0
    ds_read_b64_tr_b16 a[218:219], v106 offset:1024
    ds_read_b64_tr_b16 a[220:221], v107 offset:0
    ds_read_b64_tr_b16 a[222:223], v107 offset:1024
    s_waitcnt vmcnt(9)
    v_mfma_f32_32x32x16_bf16 v[48:63], a[136:139], v[112:115], v[48:63]
    s_add_u32 s72, s80, 106496
    buffer_load_dwordx4 v[148:151], v1, s[36:39], s72 offen offset:0 sc1
    s_xor_b32 s54, s46, 3
    s_mul_i32 s54, s54, 6144
    s_add_u32 s54, s54, 90112
    v_add_u32 v12, s54, v1
    v_mfma_f32_32x32x16_bf16 v[64:79], a[140:143], v[112:115], v[64:79]
    s_waitcnt vmcnt(9)
    v_mfma_f32_32x32x16_bf16 v[48:63], a[144:147], v[116:119], v[48:63]
    buffer_load_dwordx4 v[152:155], v1, s[36:39], s72 offen offset:1024 sc1
    s_mul_i32 s54, s46, 6144
    s_add_u32 s54, s54, 86016
    v_add_u32 v14, s54, v1
    v_mfma_f32_32x32x16_bf16 v[64:79], a[148:151], v[116:119], v[64:79]
    s_waitcnt vmcnt(9)
    v_mfma_f32_32x32x16_bf16 v[48:63], a[152:155], v[120:123], v[48:63]
    s_waitcnt vmcnt(8)
    v_cmp_ne_u32 vcc, s47, v9
    s_cbranch_vccnz Lspin_48
Lgot_49:
    s_add_u32 s72, s81, 0
    buffer_load_dwordx4 v[156:159], v1, s[36:39], s72 offen offset:0 sc1
    v_mfma_f32_32x32x16_bf16 v[64:79], a[156:159], v[120:123], v[64:79]
    s_waitcnt vmcnt(8)
    v_mfma_f32_32x32x16_bf16 v[48:63], a[160:163], v[124:127], v[48:63]
    buffer_load_dwordx4 v[160:163], v1, s[36:39], s72 offen offset:1024 sc1
    buffer_load_dwordx4 v[96:99], v1, s[36:39], s35 offen sc1
    v_mfma_f32_32x32x16_bf16 v[64:79], a[164:167], v[124:127], v[64:79]
    s_waitcnt vmcnt(9)
    v_mfma_f32_32x32x16_bf16 v[48:63], a[168:171], v[128:131], v[48:63]
    s_add_u32 s72, s81, 8192
    buffer_load_dwordx4 v[164:167], v1, s[36:39], s72 offen offset:0 sc1
    v_mfma_f32_32x32x16_bf16 v[64:79], a[172:175], v[128:131], v[64:79]
    s_waitcnt vmcnt(9)
    v_mfma_f32_32x32x16_bf16 v[48:63], a[176:179], v[132:135], v[48:63]
    buffer_load_dwordx4 v[168:171], v1, s[36:39], s72 offen offset:1024 sc1
    v_mfma_f32_32x32x16_bf16 v[64:79], a[180:183], v[132:135], v[64:79]
    s_waitcnt vmcnt(9) lgkmcnt(15)
    v_mfma_f32_32x32x16_bf16 v[48:63], a[184:187], v[136:139], v[48:63]
    s_add_u32 s72, s81, 16384
    buffer_load_dwordx4 v[108:111], v1, s[36:39], s72 offen offset:0 sc1
    ds_read_b128 v[16:19], v104 offset:0
    ds_read_b128 v[20:23], v104 offset:16
    ds_read_b128 v[24:27], v104 offset:32
    ds_read_b128 v[28:31], v104 offset:48
    v_mfma_f32_32x32x16_bf16 v[64:79], a[188:191], v[136:139], v[64:79]
    s_waitcnt vmcnt(9)
    v_mfma_f32_32x32x16_bf16 v[48:63], a[192:195], v[140:143], v[48:63]
    buffer_load_dwordx4 v[112:115], v1, s[36:39], s72 offen offset:1024 sc1
    v_mfma_f32_32x32x16_bf16 v[64:79], a[196:199], v[140:143], v[64:79]
    s_waitcnt vmcnt(9) lgkmcnt(15)
    v_mfma_f32_32x32x16_bf16 v[48:63], a[200:203], v[144:147], v[48:63]
    s_add_u32 s72, s81, 24576
    buffer_load_dwordx4 v[116:119], v1, s[36:39], s72 offen offset:0 sc1
    v_mfma_f32_32x32x16_bf16 v[64:79], a[204:207], v[144:147], v[64:79]
    s_waitcnt vmcnt(9) lgkmcnt(12)
    v_mfma_f32_32x32x16_bf16 v[48:63], a[208:211], v[148:151], v[48:63]
    buffer_load_dwordx4 v[120:123], v1, s[36:39], s72 offen offset:1024 sc1
    s_waitcnt lgkmcnt(0)
    s_barrier
    v_mfma_f32_32x32x16_bf16 v[64:79], a[212:215], v[148:151], v[64:79]
    s_waitcnt vmcnt(9)
    v_mfma_f32_32x32x16_bf16 v[48:63], a[216:219], v[152:155], v[48:63]
    s_add_u32 s72, s81, 32768
    buffer_load_dwordx4 v[124:127], v1, s[36:39], s72 offen offset:0 sc1
    v_mfma_f32_32x32x16_bf16 v[64:79], a[220:223], v[152:155], v[64:79]
    s_waitcnt vmcnt(7)
    v_mfma_f32_32x32x16_bf16 v[16:31], v[172:175], v[96:99], v[16:31]
    v_mfma_f32_32x32x16_bf16 v[16:31], a[0:3], v[156:159], v[16:31]
    buffer_load_dwordx4 v[128:131], v1, s[36:39], s72 offen offset:1024 sc1
    v_mfma_f32_32x32x16_bf16 v[32:47], a[4:7], v[156:159], 0
    v_mfma_f32_32x32x16_bf16 v[16:31], a[8:11], v[160:163], v[16:31]
    s_add_u32 s72, s81, 40960
    buffer_load_dwordx4 v[132:135], v1, s[36:39], s72 offen offset:0 sc1
    s_nop 0
    ds_write_b128 v3, v[56:59]
    v_mfma_f32_32x32x16_bf16 v[32:47], a[12:15], v[160:163], v[32:47]
    ds_write_b128 v3, v[60:63] offset:1024
    s_waitcnt vmcnt(8)
    v_mfma_f32_32x32x16_bf16 v[16:31], a[16:19], v[164:167], v[16:31]
    buffer_load_dwordx4 v[136:139], v1, s[36:39], s72 offen offset:1024 sc1
    ds_write_b128 v11, v[64:67]
    v_mfma_f32_32x32x16_bf16 v[32:47], a[20:23], v[164:167], v[32:47]
    s_waitcnt vmcnt(8)
    v_mfma_f32_32x32x16_bf16 v[16:31], a[24:27], v[168:171], v[16:31]
    s_add_u32 s72, s81, 49152
    buffer_load_dwordx4 v[140:143], v1, s[36:39], s72 offen offset:0 sc1
    ds_write_b128 v11, v[68:71] offset:1024
    v_mfma_f32_32x32x16_bf16 v[32:47], a[28:31], v[168:171], v[32:47]
    ds_write_b128 v12, v[72:75]
    s_waitcnt vmcnt(8)
    v_mfma_f32_32x32x16_bf16 v[16:31], a[32:35], v[108:111], v[16:31]
    buffer_load_dwordx4 v[144:147], v1, s[36:39], s72 offen offset:1024 sc1
    ds_write_b128 v12, v[76:79] offset:1024
    v_mfma_f32_32x32x16_bf16 v[32:47], a[36:39], v[108:111], v[32:47]
    s_waitcnt vmcnt(8)
    v_mfma_f32_32x32x16_bf16 v[16:31], a[40:43], v[112:115], v[16:31]
    s_add_u32 s72, s81, 57344
    buffer_load_dwordx4 v[148:151], v1, s[36:39], s72 offen offset:0 sc1
    v_mfma_f32_32x32x16_bf16 v[32:47], a[44:47], v[112:115], v[32:47]
    s_waitcnt vmcnt(8)
    v_mfma_f32_32x32x16_bf16 v[16:31], a[48:51], v[116:119], v[16:31]
    buffer_load_dwordx4 v[152:155], v1, s[36:39], s72 offen offset:1024 sc1
    v_mfma_f32_32x32x16_bf16 v[32:47], a[52:55], v[116:119], v[32:47]
    s_waitcnt lgkmcnt(0)
    s_barrier
    ds_read_b128 v[80:83], v14 offset:0
    ds_read_b128 v[84:87], v14 offset:1024
    ds_read_b128 v[88:91], v14 offset:2048
    ds_read_b128 v[92:95], v14 offset:3072
    ds_read_b128 v[96:99], v14 offset:4096
    ds_read_b128 v[100:103], v14 offset:5120
    s_waitcnt vmcnt(8)
    v_mfma_f32_32x32x16_bf16 v[16:31], a[56:59], v[120:123], v[16:31]
    s_add_u32 s72, s81, 65536
    buffer_load_dwordx4 v[156:159], v1, s[36:39], s72 offen offset:0 sc1
    v_mfma_f32_32x32x16_bf16 v[32:47], a[60:63], v[120:123], v[32:47]
    s_waitcnt vmcnt(8)
    v_mfma_f32_32x32x16_bf16 v[16:31], a[64:67], v[124:127], v[16:31]
    buffer_load_dwordx4 v[160:163], v1, s[36:39], s72 offen offset:1024 sc1
    v_mfma_f32_32x32x16_bf16 v[32:47], a[68:71], v[124:127], v[32:47]
    s_waitcnt lgkmcnt(5)
    v_add_f32 v48, v48, v80
    v_add_f32 v49, v49, v81
    v_add_f32 v50, v50, v82
    s_waitcnt vmcnt(8)
    v_mfma_f32_32x32x16_bf16 v[16:31], a[72:75], v[128:131], v[16:31]
    s_add_u32 s72, s81, 73728
    buffer_load_dwordx4 v[164:167], v1, s[36:39], s72 offen offset:0 sc1
    v_add_f32 v51, v51, v83
    s_waitcnt lgkmcnt(4)
    v_add_f32 v52, v52, v84
    v_add_f32 v53, v53, v85
    v_add_f32 v54, v54, v86
    v_mfma_f32_32x32x16_bf16 v[32:47], a[76:79], v[128:131], v[32:47]
    v_add_f32 v55, v55, v87
    s_waitcnt lgkmcnt(1)
    v_add_f32 v88, v88, v96
    v_add_f32 v89, v89, v97
    s_waitcnt vmcnt(8)
    v_mfma_f32_32x32x16_bf16 v[16:31], a[80:83], v[132:135], v[16:31]
    buffer_load_dwordx4 v[168:171], v1, s[36:39], s72 offen offset:1024 sc1
    v_add_f32 v90, v90, v98
    v_add_f32 v91, v91, v99
    s_waitcnt lgkmcnt(0)
    v_add_f32 v92, v92, v100
    v_mfma_f32_32x32x16_bf16 v[32:47], a[84:87], v[132:135], v[32:47]
    v_add_f32 v93, v93, v101
    v_add_f32 v94, v94, v102
    v_add_f32 v95, v95, v103
    s_waitcnt vmcnt(8)
    v_mfma_f32_32x32x16_bf16 v[16:31], a[88:91], v[136:139], v[16:31]
    s_add_u32 s72, s81, 81920
    buffer_load_dwordx4 v[108:111], v1, s[36:39], s72 offen offset:0 sc1
    v_add_f32 v48, v48, v88
    v_add_f32 v49, v49, v89
    v_add_f32 v50, v50, v90
    v_add_f32 v51, v51, v91
    v_mfma_f32_32x32x16_bf16 v[32:47], a[92:95], v[136:139], v[32:47]
    v_add_f32 v52, v52, v92
    v_add_f32 v53, v53, v93
    v_add_f32 v54, v54, v94
    s_waitcnt vmcnt(8)
    v_mfma_f32_32x32x16_bf16 v[16:31], a[96:99], v[140:143], v[16:31]
    buffer_load_dwordx4 v[112:115], v1, s[36:39], s72 offen offset:1024 sc1
    v_add_f32 v55, v55, v95
    v_cvt_pk_bf16_f32 v48, v48, v49
    v_cvt_pk_bf16_f32 v49, v50, v51
    v_mfma_f32_32x32x16_bf16 v[32:47], a[100:103], v[140:143], v[32:47]
    v_cvt_pk_bf16_f32 v50, v52, v53
    v_cvt_pk_bf16_f32 v51, v54, v55
    s_waitcnt vmcnt(8)
    v_mfma_f32_32x32x16_bf16 v[16:31], a[104:107], v[144:147], v[16:31]
    s_add_u32 s72, s81, 90112
    buffer_load_dwordx4 v[116:119], v1, s[36:39], s72 offen offset:0 sc1
    s_cmp_lg_u32 s48, 0
    s_cbranch_scc1 Lslow_52
    buffer_store_dwordx4 v[48:51], v1, s[36:39], s28 offen
Lback_53:
    v_mfma_f32_32x32x16_bf16 v[32:47], a[108:111], v[144:147], v[32:47]
    s_waitcnt vmcnt(9)
    v_mfma_f32_32x32x16_bf16 v[16:31], a[112:115], v[148:151], v[16:31]
    buffer_load_dwordx4 v[120:123], v1, s[36:39], s72 offen offset:1024 sc1
    v_mov_b32 v82, 0x3f803f80
    v_dot2_f32_bf16 v80, v48, v82, 0
    v_dot2_f32_bf16 v81, v48, v48, 0
    v_dot2_f32_bf16 v80, v49, v82, v80
    v_dot2_f32_bf16 v81, v49, v49, v81
    v_dot2_f32_bf16 v80, v50, v82, v80
    v_dot2_f32_bf16 v81, v50, v50, v81
    v_dot2_f32_bf16 v80, v51, v82, v80
    v_dot2_f32_bf16 v81, v51, v51, v81
    v_mfma_f32_32x32x16_bf16 v[32:47], a[116:119], v[148:151], v[32:47]
    s_waitcnt vmcnt(9)
    v_mfma_f32_32x32x16_bf16 v[16:31], a[120:123], v[152:155], v[16:31]
    s_add_u32 s72, s81, 98304
    buffer_load_dwordx4 v[124:127], v1, s[36:39], s72 offen offset:0 sc1
    v_mfma_f32_32x32x16_bf16 v[32:47], a[124:127], v[152:155], v[32:47]
    s_nop 2
    v_permlane32_swap_b32 v80, v81
    v_add_f32 v80, v80, v81
    s_waitcnt vmcnt(9)
    v_mfma_f32_32x32x16_bf16 v[16:31], a[128:131], v[156:159], v[16:31]
    buffer_load_dwordx4 v[128:131], v1, s[36:39], s72 offen offset:1024 sc1
    s_cmp_lg_u32 s48, 0
    s_cbranch_scc1 Lslow_54
    buffer_store_dword v80, v1, s[36:39], s30 offen
Lback_55:
    v_mfma_f32_32x32x16_bf16 v[32:47], a[132:135], v[156:159], v[32:47]
    s_waitcnt vmcnt(10)
    v_mfma_f32_32x32x16_bf16 v[16:31], a[136:139], v[160:163], v[16:31]
    s_add_u32 s72, s81, 106496
    buffer_load_dwordx4 v[132:135], v1, s[36:39], s72 offen offset:0 sc1
    s_barrier
    v_mfma_f32_32x32x16_bf16 v[32:47], a[140:143], v[160:163], v[32:47]
    s_waitcnt vmcnt(10)
    v_mfma_f32_32x32x16_bf16 v[16:31], a[144:147], v[164:167], v[16:31]
    buffer_load_dwordx4 v[136:139], v1, s[36:39], s72 offen offset:1024 sc1
    v_mfma_f32_32x32x16_bf16 v[32:47], a[148:151], v[164:167], v[32:47]
    s_waitcnt vmcnt(10)
    v_mfma_f32_32x32x16_bf16 v[16:31], a[152:155], v[168:171], v[16:31]
    v_mfma_f32_32x32x16_bf16 v[32:47], a[156:159], v[168:171], v[32:47]
    s_waitcnt vmcnt(9)
    v_mfma_f32_32x32x16_bf16 v[32:47], a[164:167], v[108:111], v[32:47]
    s_waitcnt vmcnt(8)
    v_mfma_f32_32x32x16_bf16 v[32:47], a[172:175], v[112:115], v[32:47]
    s_waitcnt vmcnt(7)
    v_mfma_f32_32x32x16_bf16 v[32:47], a[180:183], v[116:119], v[32:47]
    s_waitcnt vmcnt(5)
    v_mfma_f32_32x32x16_bf16 v[32:47], a[188:191], v[120:123], v[32:47]
    s_waitcnt vmcnt(4)
    v_mfma_f32_32x32x16_bf16 v[32:47], a[196:199], v[124:127], v[32:47]
    s_waitcnt vmcnt(2)
    s_mov_b64 exec, 1
    s_cmp_lg_u32 s48, 0
    s_cbranch_scc1 Lslow_56
    buffer_store_dword v4, off, s[36:39], s32 offset:0
Lback_57:
    s_mov_b64 exec, -1
    v_mfma_f32_32x32x16_bf16 v[32:47], a[204:207], v[128:131], v[32:47]
    s_waitcnt vmcnt(2)
    v_mfma_f32_32x32x16_bf16 v[32:47], a[212:215], v[132:135], v[32:47]
    s_waitcnt vmcnt(1)
    v_mfma_f32_32x32x16_bf16 v[32:47], a[220:223], v[136:139], v[32:47]
    v_mfma_f32_32x32x16_bf16 v[16:31], a[160:163], v[108:111], v[16:31]
    v_mfma_f32_32x32x16_bf16 v[16:31], a[168:171], v[112:115], v[16:31]
    v_mfma_f32_32x32x16_bf16 v[16:31], a[176:179], v[116:119], v[16:31]
    s_nop 8
    ds_write_b128 v11, v[32:35]
    v_mfma_f32_32x32x16_bf16 v[16:31], a[184:187], v[120:123], v[16:31]
    ds_write_b128 v11, v[36:39] offset:1024
    v_mfma_f32_32x32x16_bf16 v[16:31], a[192:195], v[124:127], v[16:31]
    ds_write_b128 v12, v[40:43]
    v_mfma_f32_32x32x16_bf16 v[16:31], a[200:203], v[128:131], v[16:31]
    ds_write_b128 v12, v[44:47] offset:1024
    v_mfma_f32_32x32x16_bf16 v[16:31], a[208:211], v[132:135], v[16:31]
    v_mfma_f32_32x32x16_bf16 v[16:31], a[216:219], v[136:139], v[16:31]
    s_nop 11
    ds_write_b128 v3, v[24:27]
    ds_write_b128 v3, v[28:31] offset:1024
    s_waitcnt lgkmcnt(0)
    s_barrier
    ds_read_b128 v[80:83], v14 offset:0
    ds_read_b128 v[84:87], v14 offset:1024
    ds_read_b128 v[88:91], v14 offset:2048
    ds_read_b128 v[92:95], v14 offset:3072
    ds_read_b128 v[96:99], v14 offset:4096
    ds_read_b128 v[100:103], v14 offset:5120
    s_waitcnt lgkmcnt(5)
    v_pk_add_f32 v[16:17], v[16:17], v[80:81]
    v_pk_add_f32 v[18:19], v[18:19], v[82:83]
    s_waitcnt lgkmcnt(4)
    v_pk_add_f32 v[20:21], v[20:21], v[84:85]
    v_pk_add_f32 v[22:23], v[22:23], v[86:87]
    s_waitcnt lgkmcnt(1)
    v_pk_add_f32 v[88:89], v[88:89], v[96:97]
    v_pk_add_f32 v[90:91], v[90:91], v[98:99]
    s_waitcnt lgkmcnt(0)
    v_pk_add_f32 v[92:93], v[92:93], v[100:101]
    v_pk_add_f32 v[94:95], v[94:95], v[102:103]
    v_pk_add_f32 v[16:17], v[16:17], v[88:89]
    v_pk_add_f32 v[18:19], v[18:19], v[90:91]
    v_pk_add_f32 v[20:21], v[20:21], v[92:93]
    v_pk_add_f32 v[22:23], v[22:23], v[94:95]
    v_cvt_pk_bf16_f32 v16, v16, v17
    v_cvt_pk_bf16_f32 v17, v18, v19
    v_cvt_pk_bf16_f32 v18, v20, v21
    v_cvt_pk_bf16_f32 v19, v22, v23
    s_cmp_lg_u32 s48, 0
    s_cbranch_scc1 Lslow_58
    buffer_store_dwordx4 v[16:19], v1, s[36:39], s29 offen
Lback_59:
    v_mov_b32 v82, 0x3f803f80
    v_dot2_f32_bf16 v80, v16, v82, 0
    v_dot2_f32_bf16 v81, v16, v16, 0
    v_dot2_f32_bf16 v80, v17, v82, v80
    v_dot2_f32_bf16 v81, v17, v17, v81
    v_dot2_f32_bf16 v80, v18, v82, v80
    v_dot2_f32_bf16 v81, v18, v18, v81
    v_dot2_f32_bf16 v80, v19, v82, v80
    v_dot2_f32_bf16 v81, v19, v19, v81
    s_nop 2
    v_permlane32_swap_b32 v80, v81
    v_add_f32 v80, v80, v81
    s_cmp_lg_u32 s48, 0
    s_cbranch_scc1 Lslow_60
    buffer_store_dword v80, v1, s[36:39], s31 offen
Lback_61:
    s_waitcnt vmcnt(0)
    s_mov_b64 exec, 1
    s_cmp_lg_u32 s48, 0
    s_cbranch_scc1 Lslow_62
    buffer_store_dword v4, off, s[36:39], s33 offset:0
Lback_63:
    s_mov_b64 exec, -1
L_layer1:
    s_add_u32 s78, s78, 655360
    s_add_u32 s79, s79, 655360
    v_and_b32 v10, 31, v0
    v_min_u32 v10, 27, v10
    v_lshlrev_b32 v10, 2, v10
    s_add_u32 s55, s76, 1024
    buffer_load_dword v9, v10, s[36:39], s55 offen sc1
    s_add_u32 s56, s74, s66
    s_lshl_b32 s54, s46, 13
    v_lshrrev_b32 v3, 5, v0
    v_mul_u32_u24 v3, 4, v3
    v_bfe_u32 v11, v0, 2, 2
    v_add_u32 v3, v3, v11
    v_mul_u32_u24 v3, 128, v3
    v_bfe_u32 v11, v0, 4, 1
    v_lshl_add_u32 v3, v11, 5, v3
    v_and_b32 v11, 3, v0
    v_lshl_add_u32 v3, v11, 3, v3
    v_bfe_u32 v11, v0, 3, 1
    v_lshl_add_u32 v3, v11, 6, v3
    v_xor_b32 v14, 64, v3
    v_lshrrev_b32 v2, 5, v0
    v_mul_u32_u24 v2, 4, v2
    v_bfe_u32 v11, v0, 2, 2
    v_add_u32 v2, v2, v11
    v_mul_u32_u24 v2, 64, v2
    v_bfe_u32 v11, v0, 4, 1
    v_lshl_add_u32 v2, v11, 5, v2
    v_and_b32 v11, 3, v0
    v_lshl_add_u32 v2, v11, 3, v2
    v_add_u32 v2, 57344, v2
    ds_read_b64_tr_b16 v[144:145], v3 offset:0
    ds_read_b64_tr_b16 v[146:147], v3 offset:1024
    ds_read_b64_tr_b16 v[148:149], v14 offset:0
    ds_read_b64_tr_b16 v[150:151], v14 offset:1024
    ds_read_b64_tr_b16 v[152:153], v2 offset:0
    ds_read_b64_tr_b16 v[154:155], v2 offset:512
    ds_read_b64_tr_b16 v[156:157], v3 offset:2048
    ds_read_b64_tr_b16 v[158:159], v3 offset:3072
    s_waitcnt vmcnt(0)
    v_cmp_ne_u32 vcc, s47, v9
    s_cbranch_vccnz Lspin_64
Lgot_65:
    s_add_u32 s51, s56, 0
    buffer_load_dwordx4 v[16:19], v1, s[36:39], s51 offen offset:0 sc1
    buffer_load_dwordx4 v[20:23], v1, s[36:39], s51 offen offset:1024 sc1
    buffer_load_dwordx4 v[24:27], v1, s[36:39], s51 offen offset:2048 sc1
    buffer_load_dwordx4 v[28:31], v1, s[36:39], s51 offen offset:3072 sc1
    s_add_u32 s51, s56, 4096
    buffer_load_dwordx4 v[32:35], v1, s[36:39], s51 offen offset:0 sc1
    buffer_load_dwordx4 v[36:39], v1, s[36:39], s51 offen offset:1024 sc1
    s_add_u32 s47, s47, 1
    v_mov_b32 v4, s47
    v_and_b32 v10, 31, v0
    v_lshlrev_b32 v10, 3, v10
    v_add_u32 v10, 162048, v10
    s_waitcnt vmcnt(5) lgkmcnt(4)
    v_mfma_f32_32x32x16_bf16 v[96:111], v[16:19], v[144:147], 0
    ds_read_b64_tr_b16 v[144:145], v14 offset:2048
    ds_read_b64_tr_b16 v[146:147], v14 offset:3072
    buffer_load_dwordx4 v[40:43], v1, s[36:39], s51 offen offset:2048 sc1
    v_mfma_f32_32x32x16_bf16 v[112:127], v[16:19], v[148:151], 0
    ds_read_b64_tr_b16 v[148:149], v2 offset:1024
    ds_read_b64_tr_b16 v[150:151], v2 offset:1536
    s_waitcnt lgkmcnt(4)
    v_mfma_f32_32x32x16_bf16 v[128:143], v[152:155], v[16:19], 0
    ds_read_b64_tr_b16 v[152:153], v3 offset:4096
    ds_read_b64_tr_b16 v[154:155], v3 offset:5120
    buffer_load_dwordx4 v[44:47], v1, s[36:39], s51 offen offset:3072 sc1
    s_waitcnt vmcnt(6)
    v_mfma_f32_32x32x16_bf16 v[96:111], v[20:23], v[156:159], v[96:111]
    ds_read_b64_tr_b16 v[156:157], v14 offset:4096
    ds_read_b64_tr_b16 v[158:159], v14 offset:5120
    s_waitcnt lgkmcnt(4)
    v_mfma_f32_32x32x16_bf16 v[112:127], v[20:23], v[144:147], v[112:127]
    ds_read_b64_tr_b16 v[144:145], v2 offset:2048
    ds_read_b64_tr_b16 v[146:147], v2 offset:2560
    s_add_u32 s51, s56, 8192
    buffer_load_dwordx4 v[48:51], v1, s[36:39], s51 offen offset:0 sc1
    v_mfma_f32_32x32x16_bf16 v[128:143], v[148:151], v[20:23], v[128:143]
    ds_read_b64_tr_b16 v[148:149], v3 offset:6144
    ds_read_b64_tr_b16 v[150:151], v3 offset:7168
    s_waitcnt vmcnt(6) lgkmcnt(4)
    v_mfma_f32_32x32x16_bf16 v[96:111], v[24:27], v[152:155], v[96:111]
    ds_read_b64_tr_b16 v[152:153], v14 offset:6144
    ds_read_b64_tr_b16 v[154:155], v14 offset:7168
    buffer_load_dwordx4 v[52:55], v1, s[36:39], s51 offen offset:1024 sc1
    v_mfma_f32_32x32x16_bf16 v[112:127], v[24:27], v[156:159], v[112:127]
    ds_read_b64_tr_b16 v[156:157], v2 offset:3072
    ds_read_b64_tr_b16 v[158:159], v2 offset:3584
    s_waitcnt lgkmcnt(4)
    v_mfma_f32_32x32x16_bf16 v[128:143], v[144:147], v[24:27], v[128:143]
    ds_read_b64_tr_b16 v[144:145], v3 offset:8192
    ds_read_b64_tr_b16 v[146:147], v3 offset:9216
    buffer_load_dwordx4 v[56:59], v1, s[36:39], s51 offen offset:2048 sc1
    s_waitcnt vmcnt(7)
    v_mfma_f32_32x32x16_bf16 v[96:111], v[28:31], v[148:151], v[96:111]
    ds_read_b64_tr_b16 v[148:149], v14 offset:8192
    ds_read_b64_tr_b16 v[150:151], v14 offset:9216
    s_waitcnt lgkmcnt(4)
    v_mfma_f32_32x32x16_bf16 v[112:127], v[28:31], v[152:155], v[112:127]
    ds_read_b64_tr_b16 v[152:153], v2 offset:4096
    ds_read_b64_tr_b16 v[154:155], v2 offset:4608
    buffer_load_dwordx4 v[60:63], v1, s[36:39], s51 offen offset:3072 sc1
    v_mfma_f32_32x32x16_bf16 v[128:143], v[156:159], v[28:31], v[128:143]
    ds_read_b64_tr_b16 v[156:157], v3 offset:10240
    ds_read_b64_tr_b16 v[158:159], v3 offset:11264
    s_waitcnt vmcnt(7) lgkmcnt(4)
    v_mfma_f32_32x32x16_bf16 v[96:111], v[32:35], v[144:147], v[96:111]
    ds_read_b64_tr_b16 v[144:145], v14 offset:10240
    ds_read_b64_tr_b16 v[146:147], v14 offset:11264
    s_add_u32 s51, s56, 12288
    buffer_load_dwordx4 v[64:67], v1, s[36:39], s51 offen offset:0 sc1
    v_mfma_f32_32x32x16_bf16 v[112:127], v[32:35], v[148:151], v[112:127]
    ds_read_b64_tr_b16 v[148:149], v2 offset:5120
    ds_read_b64_tr_b16 v[150:151], v2 offset:5632
    s_add_u32 s52, s54, 851968
    buffer_load_dwordx4 v[160:163], v1, s[36:39], s52 offen offset:0 sc1
    s_waitcnt lgkmcnt(4)
    v_mfma_f32_32x32x16_bf16 v[128:143], v[152:155], v[32:35], v[128:143]
    ds_read_b64_tr_b16 v[152:153], v3 offset:12288
    ds_read_b64_tr_b16 v[154:155], v3 offset:13312
    buffer_load_dwordx4 v[68:71], v1, s[36:39], s51 offen offset:1024 sc1
    s_waitcnt vmcnt(9)
    v_mfma_f32_32x32x16_bf16 v[96:111], v[36:39], v[156:159], v[96:111]
    ds_read_b64_tr_b16 v[156:157], v14 offset:12288
    ds_read_b64_tr_b16 v[158:159], v14 offset:13312
    buffer_load_dwordx4 v[164:167], v1, s[36:39], s52 offen offset:1024 sc1
    s_waitcnt lgkmcnt(4)
    v_mfma_f32_32x32x16_bf16 v[112:127], v[36:39], v[144:147], v[112:127]
    ds_read_b64_tr_b16 v[144:145], v2 offset:6144
    ds_read_b64_tr_b16 v[146:147], v2 offset:6656
    buffer_load_dwordx4 v[72:75], v1, s[36:39], s51 offen offset:2048 sc1
    v_mfma_f32_32x32x16_bf16 v[128:143], v[148:151], v[36:39], v[128:143]
    ds_read_b64_tr_b16 v[148:149], v3 offset:14336
    ds_read_b64_tr_b16 v[150:151], v3 offset:15360
    buffer_load_dwordx4 v[168:171], v1, s[36:39], s52 offen offset:2048 sc1
    s_waitcnt vmcnt(11) lgkmcnt(4)
    v_mfma_f32_32x32x16_bf16 v[96:111], v[40:43], v[152:155], v[96:111]
    ds_read_b64_tr_b16 v[152:153], v14 offset:14336
    ds_read_b64_tr_b16 v[154:155], v14 offset:15360
    buffer_load_dwordx4 v[76:79], v1, s[36:39], s51 offen offset:3072 sc1
    v_mfma_f32_32x32x16_bf16 v[112:127], v[40:43], v[156:159], v[112:127]
    ds_read_b64_tr_b16 v[156:157], v2 offset:7168
    ds_read_b64_tr_b16 v[158:159], v2 offset:7680
    buffer_load_dwordx4 v[172:175], v1, s[36:39], s52 offen offset:3072 sc1
    s_waitcnt lgkmcnt(4)
    v_mfma_f32_32x32x16_bf16 v[128:143], v[144:147], v[40:43], v[128:143]
    ds_read_b64_tr_b16 v[144:145], v3 offset:16384
    ds_read_b64_tr_b16 v[146:147], v3 offset:17408
    s_add_u32 s51, s56, 16384
    buffer_load_dwordx4 v[80:83], v1, s[36:39], s51 offen offset:0 sc1
    s_waitcnt vmcnt(13)
    v_mfma_f32_32x32x16_bf16 v[96:111], v[44:47], v[148:151], v[96:111]
    ds_read_b64_tr_b16 v[148:149], v14 offset:16384
    ds_read_b64_tr_b16 v[150:151], v14 offset:17408
    s_waitcnt lgkmcnt(4)
    v_mfma_f32_32x32x16_bf16 v[112:127], v[44:47], v[152:155], v[112:127]
    ds_read_b64_tr_b16 v[152:153], v3 offset:18432
    ds_read_b64_tr_b16 v[154:155], v3 offset:19456
    buffer_load_dwordx4 v[84:87], v1, s[36:39], s51 offen offset:1024 sc1
    v_mfma_f32_32x32x16_bf16 v[128:143], v[156:159], v[44:47], v[128:143]
    ds_read_b64_tr_b16 v[156:157], v14 offset:18432
    ds_read_b64_tr_b16 v[158:159], v14 offset:19456
    s_waitcnt vmcnt(13) lgkmcnt(4)
    v_mfma_f32_32x32x16_bf16 v[96:111], v[48:51], v[144:147], v[96:111]
    ds_read_b64_tr_b16 v[144:145], v3 offset:20480
    ds_read_b64_tr_b16 v[146:147], v3 offset:21504
    buffer_load_dwordx4 v[88:91], v1, s[36:39], s51 offen offset:2048 sc1
    v_mfma_f32_32x32x16_bf16 v[112:127], v[48:51], v[148:151], v[112:127]
    ds_read_b64_tr_b16 v[148:149], v14 offset:20480
    ds_read_b64_tr_b16 v[150:151], v14 offset:21504
    s_waitcnt vmcnt(9)
    v_add_f32 v13, v160, v161
    v_add_f32 v13, v13, v162
    s_waitcnt lgkmcnt(4)
    v_mfma_f32_32x32x16_bf16 v[96:111], v[52:55], v[152:155], v[96:111]
    ds_read_b64_tr_b16 v[152:153], v3 offset:22528
    ds_read_b64_tr_b16 v[154:155], v3 offset:23552
    buffer_load_dwordx4 v[92:95], v1, s[36:39], s51 offen offset:3072 sc1
    v_add_f32 v13, v13, v163
    s_waitcnt vmcnt(8)
    v_add_f32 v13, v13, v164
    v_mfma_f32_32x32x16_bf16 v[112:127], v[52:55], v[156:159], v[112:127]
    ds_read_b64_tr_b16 v[156:157], v14 offset:22528
    ds_read_b64_tr_b16 v[158:159], v14 offset:23552
    v_add_f32 v13, v13, v165
    v_add_f32 v13, v13, v166
    s_waitcnt lgkmcnt(4)
    v_mfma_f32_32x32x16_bf16 v[96:111], v[56:59], v[144:147], v[96:111]
    ds_read_b64_tr_b16 v[144:145], v3 offset:24576
    ds_read_b64_tr_b16 v[146:147], v3 offset:25600
    s_add_u32 s51, s56, 20480
    buffer_load_dwordx4 v[16:19], v1, s[36:39], s51 offen offset:0 sc1
    v_add_f32 v13, v13, v167
    s_waitcnt vmcnt(7)
    v_add_f32 v13, v13, v168
    v_mfma_f32_32x32x16_bf16 v[112:127], v[56:59], v[148:151], v[112:127]
    ds_read_b64_tr_b16 v[148:149], v14 offset:24576
    ds_read_b64_tr_b16 v[150:151], v14 offset:25600
    v_add_f32 v13, v13, v169
    v_add_f32 v13, v13, v170
    s_waitcnt lgkmcnt(4)
    v_mfma_f32_32x32x16_bf16 v[96:111], v[60:63], v[152:155], v[96:111]
    ds_read_b64_tr_b16 v[152:153], v3 offset:26624
    ds_read_b64_tr_b16 v[154:155], v3 offset:27648
    buffer_load_dwordx4 v[20:23], v1, s[36:39], s51 offen offset:1024 sc1
    v_add_f32 v13, v13, v171
    s_waitcnt vmcnt(6)
    v_add_f32 v13, v13, v172
    v_mfma_f32_32x32x16_bf16 v[112:127], v[60:63], v[156:159], v[112:127]
    ds_read_b64_tr_b16 v[156:157], v14 offset:26624
    ds_read_b64_tr_b16 v[158:159], v14 offset:27648
    v_add_f32 v13, v13, v173
    v_add_f32 v13, v13, v174
    s_waitcnt lgkmcnt(4)
    v_mfma_f32_32x32x16_bf16 v[96:111], v[64:67], v[144:147], v[96:111]
    ds_read_b64_tr_b16 v[144:145], v3 offset:28672
    ds_read_b64_tr_b16 v[146:147], v3 offset:29696
    buffer_load_dwordx4 v[24:27], v1, s[36:39], s51 offen offset:2048 sc1
    v_add_f32 v13, v13, v175
    v_mfma_f32_32x32x16_bf16 v[112:127], v[64:67], v[148:151], v[112:127]
    ds_read_b64_tr_b16 v[148:149], v14 offset:28672
    ds_read_b64_tr_b16 v[150:151], v14 offset:29696
    s_add_u32 s52, s54, 856064
    buffer_load_dwordx4 v[160:163], v1, s[36:39], s52 offen offset:0 sc1
    s_waitcnt lgkmcnt(4)
    v_mfma_f32_32x32x16_bf16 v[96:111], v[68:71], v[152:155], v[96:111]
    ds_read_b64_tr_b16 v[152:153], v3 offset:30720
    ds_read_b64_tr_b16 v[154:155], v3 offset:31744
    buffer_load_dwordx4 v[28:31], v1, s[36:39], s51 offen offset:3072 sc1
    v_and_b32 v173, 31, v0
    v_lshrrev_b32 v172, 5, v0
    v_lshrrev_b32 v174, 3, v173
    v_mfma_f32_32x32x16_bf16 v[112:127], v[68:71], v[156:159], v[112:127]
    ds_read_b64_tr_b16 v[156:157], v14 offset:30720
    ds_read_b64_tr_b16 v[158:159], v14 offset:31744
    buffer_load_dwordx4 v[164:167], v1, s[36:39], s52 offen offset:1024 sc1
    v_sub_u32 v174, v173, v174
    v_lshl_add_u32 v172, v172, 5, v174
    s_lshl_b32 s53, s46, 10
    s_waitcnt lgkmcnt(4)
    v_mfma_f32_32x32x16_bf16 v[96:111], v[72:75], v[144:147], v[96:111]
    ds_read_b64_tr_b16 v[144:145], v3 offset:32768
    ds_read_b64_tr_b16 v[146:147], v3 offset:33792
    s_add_u32 s51, s56, 24576
    buffer_load_dwordx4 v[32:35], v1, s[36:39], s51 offen offset:0 sc1
    v_lshlrev_b32 v172, 4, v172
    v_add_u32 v172, s53, v172
    v_and_b32 v173, 1, v174
    v_mfma_f32_32x32x16_bf16 v[112:127], v[72:75], v[148:151], v[112:127]
    ds_read_b64_tr_b16 v[148:149], v14 offset:32768
    ds_read_b64_tr_b16 v[150:151], v14 offset:33792
    buffer_load_dwordx4 v[168:171], v1, s[36:39], s52 offen offset:2048 sc1
    v_lshlrev_b32 v173, 9, v173
    v_lshrrev_b32 v174, 1, v174
    v_cmp_gt_u32 vcc, 4, v174
    s_waitcnt lgkmcnt(4)
    v_mfma_f32_32x32x16_bf16 v[96:111], v[76:79], v[152:155], v[96:111]
    ds_read_b64_tr_b16 v[152:153], v3 offset:34816
    ds_read_b64_tr_b16 v[154:155], v3 offset:35840
    buffer_load_dwordx4 v[36:39], v1, s[36:39], s51 offen offset:1024 sc1
    v_lshl_add_u32 v173, v174, 10, v173
    v_add_u32 v173, 448, v173
    s_and_b64 vcc, vcc, s[64:65]
    v_mfma_f32_32x32x16_bf16 v[112:127], v[76:79], v[156:159], v[112:127]
    ds_read_b64_tr_b16 v[156:157], v14 offset:34816
    ds_read_b64_tr_b16 v[158:159], v14 offset:35840
    v_cndmask_b32 v172, v172, v173, vcc
    v_add_u32 v172, 143616, v172
    s_waitcnt vmcnt(12) lgkmcnt(4)
    v_mfma_f32_32x32x16_bf16 v[96:111], v[80:83], v[144:147], v[96:111]
    ds_read_b64_tr_b16 v[144:145], v3 offset:36864
    ds_read_b64_tr_b16 v[146:147], v3 offset:37888
    buffer_load_dwordx4 v[40:43], v1, s[36:39], s51 offen offset:2048 sc1
    v_mfma_f32_32x32x16_bf16 v[112:127], v[80:83], v[148:151], v[112:127]
    ds_read_b64_tr_b16 v[148:149], v14 offset:36864
    ds_read_b64_tr_b16 v[150:151], v14 offset:37888
    s_waitcnt vmcnt(12) lgkmcnt(4)
    v_mfma_f32_32x32x16_bf16 v[96:111], v[84:87], v[152:155], v[96:111]
    ds_read_b64_tr_b16 v[152:153], v3 offset:38912
    ds_read_b64_tr_b16 v[154:155], v3 offset:39936
    buffer_load_dwordx4 v[44:47], v1, s[36:39], s51 offen offset:3072 sc1
    v_mfma_f32_32x32x16_bf16 v[112:127], v[84:87], v[156:159], v[112:127]
    ds_read_b64_tr_b16 v[156:157], v14 offset:38912
    ds_read_b64_tr_b16 v[158:159], v14 offset:39936
    s_waitcnt vmcnt(12) lgkmcnt(4)
    v_mfma_f32_32x32x16_bf16 v[96:111], v[88:91], v[144:147], v[96:111]
    ds_read_b64_tr_b16 v[144:145], v3 offset:40960
    ds_read_b64_tr_b16 v[146:147], v3 offset:41984
    v_mfma_f32_32x32x16_bf16 v[112:127], v[88:91], v[148:151], v[112:127]
    ds_read_b64_tr_b16 v[148:149], v14 offset:40960
    ds_read_b64_tr_b16 v[150:151], v14 offset:41984
    s_waitcnt vmcnt(11) lgkmcnt(4)
    v_mfma_f32_32x32x16_bf16 v[96:111], v[92:95], v[152:155], v[96:111]
    ds_read_b64_tr_b16 v[152:153], v3 offset:43008
    ds_read_b64_tr_b16 v[154:155], v3 offset:44032
    v_mfma_f32_32x32x16_bf16 v[112:127], v[92:95], v[156:159], v[112:127]
    ds_read_b64_tr_b16 v[156:157], v14 offset:43008
    ds_read_b64_tr_b16 v[158:159], v14 offset:44032
    s_waitcnt vmcnt(10) lgkmcnt(4)
    v_mfma_f32_32x32x16_bf16 v[96:111], v[16:19], v[144:147], v[96:111]
    ds_read_b64_tr_b16 v[144:145], v3 offset:45056
    ds_read_b64_tr_b16 v[146:147], v3 offset:46080
    s_waitcnt vmcnt(7)
    v_add_f32 v13, v13, v160
    v_add_f32 v13, v13, v161
    v_add_f32 v13, v13, v162
    v_mfma_f32_32x32x16_bf16 v[112:127], v[16:19], v[148:151], v[112:127]
    ds_read_b64_tr_b16 v[148:149], v14 offset:45056
    ds_read_b64_tr_b16 v[150:151], v14 offset:46080
    v_add_f32 v13, v13, v163
    s_waitcnt vmcnt(5)
    v_add_f32 v13, v13, v164
    v_add_f32 v13, v13, v165
    s_waitcnt lgkmcnt(4)
    v_mfma_f32_32x32x16_bf16 v[96:111], v[20:23], v[152:155], v[96:111]
    ds_read_b64_tr_b16 v[152:153], v3 offset:47104
    ds_read_b64_tr_b16 v[154:155], v3 offset:48128
    v_add_f32 v13, v13, v166
    v_add_f32 v13, v13, v167
    s_waitcnt vmcnt(3)
    v_add_f32 v13, v13, v168
    v_mfma_f32_32x32x16_bf16 v[112:127], v[20:23], v[156:159], v[112:127]
    ds_read_b64_tr_b16 v[156:157], v14 offset:47104
    ds_read_b64_tr_b16 v[158:159], v14 offset:48128
    v_add_f32 v13, v13, v169
    v_add_f32 v13, v13, v170
    v_add_f32 v13, v13, v171
    s_waitcnt lgkmcnt(4)
    v_mfma_f32_32x32x16_bf16 v[96:111], v[24:27], v[144:147], v[96:111]
    ds_read_b64_tr_b16 v[144:145], v3 offset:49152
    ds_read_b64_tr_b16 v[146:147], v3 offset:50176
    v_mov_b32 v12, v13
    v_mov_b32 v5, v13
    s_nop 1
    v_permlane32_swap_b32 v5, v12
    v_mfma_f32_32x32x16_bf16 v[112:127], v[24:27], v[148:151], v[112:127]
    ds_read_b64_tr_b16 v[148:149], v14 offset:49152
    ds_read_b64_tr_b16 v[150:151], v14 offset:50176
    v_mul_f32 v5, 0x3b124925, v5
    v_mul_f32 v12, 0x3b124925, v12
    v_fma_f32 v12, -v5, v5, v12
    s_waitcnt lgkmcnt(4)
    v_mfma_f32_32x32x16_bf16 v[96:111], v[28:31], v[152:155], v[96:111]
    ds_read_b64_tr_b16 v[152:153], v3 offset:51200
    ds_read_b64_tr_b16 v[154:155], v3 offset:52224
    v_max_f32 v12, 0, v12
    v_add_f32 v13, 0x3727c5ac, v12
    v_rsq_f32 v6, v13
    v_mfma_f32_32x32x16_bf16 v[112:127], v[28:31], v[156:159], v[112:127]
    ds_read_b64_tr_b16 v[156:157], v14 offset:51200
    ds_read_b64_tr_b16 v[158:159], v14 offset:52224
    v_mul_f32 v6, 0x3fb8aa3b, v6
    s_lshl_b32 s55, s46, 12
    s_add_u32 s55, s55, 143616
    s_waitcnt lgkmcnt(4)
    v_mfma_f32_32x32x16_bf16 v[96:111], v[32:35], v[144:147], v[96:111]
    ds_read_b64_tr_b16 v[144:145], v3 offset:53248
    ds_read_b64_tr_b16 v[146:147], v3 offset:54272
    v_and_b32 v12, 31, v0
    v_lshl_add_u32 v12, v12, 2, s55
    ds_write_b32 v12, v6
    v_mfma_f32_32x32x16_bf16 v[112:127], v[32:35], v[148:151], v[112:127]
    ds_read_b64_tr_b16 v[148:149], v14 offset:53248
    ds_read_b64_tr_b16 v[150:151], v14 offset:54272
    v_sub_f32 v5, 0, v5
    v_cvt_pk_bf16_f32 v169, v5, v5
    v_and_b32 v11, 0xffff0000, v169
    s_waitcnt vmcnt(2) lgkmcnt(5)
    v_mfma_f32_32x32x16_bf16 v[96:111], v[36:39], v[152:155], v[96:111]
    ds_read_b64_tr_b16 v[152:153], v3 offset:55296
    ds_read_b64_tr_b16 v[154:155], v3 offset:56320
    v_sub_f32 v11, v5, v11
    v_cvt_pk_bf16_f32 v168, v5, v11
    v_and_b32 v169, 0xffff, v169
    v_mfma_f32_32x32x16_bf16 v[112:127], v[36:39], v[156:159], v[112:127]
    ds_read_b64_tr_b16 v[156:157], v14 offset:55296
    ds_read_b64_tr_b16 v[158:159], v14 offset:56320
    v_cndmask_b32 v169, v169, 0, s[62:63]
    v_cndmask_b32 v168, v168, 0, s[62:63]
    v_mov_b32 v170, 0
    s_waitcnt vmcnt(1) lgkmcnt(4)
    v_mfma_f32_32x32x16_bf16 v[96:111], v[40:43], v[144:147], v[96:111]
    ds_read_b64 v[144:145], v10 offset:256
    v_mov_b32 v146, 0
    v_mov_b32 v147, 0
    v_mov_b32 v171, 0
    v_mfma_f32_32x32x16_bf16 v[112:127], v[40:43], v[148:151], v[112:127]
    ds_read_b64 v[148:149], v10 offset:512
    v_mov_b32 v150, 0
    v_mov_b32 v151, 0
    v_lshrrev_b32 v13, 5, v0
    v_lshl_add_u32 v13, v13, 4, s55
    s_waitcnt vmcnt(0) lgkmcnt(2)
    v_mfma_f32_32x32x16_bf16 v[96:111], v[44:47], v[152:155], v[96:111]
    ds_read_b128 v[152:155], v13 offset:0
    v_mfma_f32_32x32x16_bf16 v[112:127], v[44:47], v[156:159], v[112:127]
    ds_read_b128 v[156:159], v13 offset:32
    s_waitcnt lgkmcnt(2)
    v_mfma_f32_32x32x16_bf16 v[96:111], v[168:171], v[144:147], v[96:111]
    ds_read_b128 v[144:147], v13 offset:64
    v_mfma_f32_32x32x16_bf16 v[112:127], v[168:171], v[148:151], v[112:127]
    ds_read_b128 v[148:151], v13 offset:96
    v_mov_b32 v9, 0x3f803f80
    v_add_u32 v11, s55, v1
    v_mov_b32 v12, 0x358637bd
    s_waitcnt lgkmcnt(3)
    s_nop 4
    v_pk_mul_f32 v[96:97], v[96:97], v[152:153]
    v_pk_mul_f32 v[98:99], v[98:99], v[154:155]
    s_waitcnt lgkmcnt(2)
    v_pk_mul_f32 v[100:101], v[100:101], v[156:157]
    v_pk_mul_f32 v[102:103], v[102:103], v[158:159]
    v_exp_f32 v160, v96 clamp
    v_max_f32 v96, 0, v96
    v_exp_f32 v161, v97 clamp
    v_max_f32 v97, 0, v97
    v_exp_f32 v162, v98 clamp
    v_max_f32 v98, 0, v98
    v_exp_f32 v163, v99 clamp
    v_max_f32 v99, 0, v99
    v_exp_f32 v164, v100 clamp
    v_max_f32 v100, 0, v100
    v_exp_f32 v165, v101 clamp
    v_max_f32 v101, 0, v101
    v_exp_f32 v166, v102 clamp
    v_max_f32 v102, 0, v102
    v_exp_f32 v167, v103 clamp
    v_max_f32 v103, 0, v103
    v_pk_fma_f32 v[96:97], v[96:97], s[56:57], v[160:161] op_sel:[0,1,0] op_sel_hi:[1,1,1]
    v_pk_fma_f32 v[98:99], v[98:99], s[56:57], v[162:163] op_sel:[0,1,0] op_sel_hi:[1,1,1]
    v_pk_fma_f32 v[100:101], v[100:101], s[56:57], v[164:165] op_sel:[0,1,0] op_sel_hi:[1,1,1]
    v_pk_fma_f32 v[102:103], v[102:103], s[56:57], v[166:167] op_sel:[0,1,0] op_sel_hi:[1,1,1]
    v_pk_add_f32 v[96:97], v[96:97], v[12:13] op_sel_hi:[1,0]
    v_pk_add_f32 v[98:99], v[98:99], v[12:13] op_sel_hi:[1,0]
    v_pk_add_f32 v[100:101], v[100:101], v[12:13] op_sel_hi:[1,0]
    v_pk_add_f32 v[102:103], v[102:103], v[12:13] op_sel_hi:[1,0]
    v_cvt_pk_bf16_f32 v96, v96, v97
    v_cvt_pk_bf16_f32 v97, v98, v99
    v_cvt_pk_bf16_f32 v98, v100, v101
    v_cvt_pk_bf16_f32 v99, v102, v103
    v_pk_mul_f32 v[112:113], v[112:113], v[152:153]
    v_pk_mul_f32 v[114:115], v[114:115], v[154:155]
    v_pk_mul_f32 v[116:117], v[116:117], v[156:157]
    v_pk_mul_f32 v[118:119], v[118:119], v[158:159]
    v_cvt_pk_bf16_f32 v112, v112, v113
    v_cvt_pk_bf16_f32 v113, v114, v115
    v_cvt_pk_bf16_f32 v114, v116, v117
    v_cvt_pk_bf16_f32 v115, v118, v119
    v_cndmask_b32 v112, v112, v9, s[60:61]
    v_cndmask_b32 v113, v113, v9, s[60:61]
    v_cndmask_b32 v114, v114, v9, s[60:61]
    v_cndmask_b32 v115, v115, v9, s[60:61]
    s_waitcnt lgkmcnt(1)
    v_pk_mul_f32 v[104:105], v[104:105], v[144:145]
    v_pk_mul_f32 v[106:107], v[106:107], v[146:147]
    s_waitcnt lgkmcnt(0)
    v_pk_mul_f32 v[108:109], v[108:109], v[148:149]
    v_pk_mul_f32 v[110:111], v[110:111], v[150:151]
    v_exp_f32 v160, v104 clamp
    v_max_f32 v104, 0, v104
    v_exp_f32 v161, v105 clamp
    v_max_f32 v105, 0, v105
    v_exp_f32 v162, v106 clamp
    v_max_f32 v106, 0, v106
    v_exp_f32 v163, v107 clamp
    v_max_f32 v107, 0, v107
    v_exp_f32 v164, v108 clamp
    v_max_f32 v108, 0, v108
    v_exp_f32 v165, v109 clamp
    v_max_f32 v109, 0, v109
    v_exp_f32 v166, v110 clamp
    v_max_f32 v110, 0, v110
    v_exp_f32 v167, v111 clamp
    v_max_f32 v111, 0, v111
    v_pk_fma_f32 v[104:105], v[104:105], s[56:57], v[160:161] op_sel:[0,1,0] op_sel_hi:[1,1,1]
    v_pk_fma_f32 v[106:107], v[106:107], s[56:57], v[162:163] op_sel:[0,1,0] op_sel_hi:[1,1,1]
    v_pk_fma_f32 v[108:109], v[108:109], s[56:57], v[164:165] op_sel:[0,1,0] op_sel_hi:[1,1,1]
    v_pk_fma_f32 v[110:111], v[110:111], s[56:57], v[166:167] op_sel:[0,1,0] op_sel_hi:[1,1,1]
    v_pk_add_f32 v[104:105], v[104:105], v[12:13] op_sel_hi:[1,0]
    v_pk_add_f32 v[106:107], v[106:107], v[12:13] op_sel_hi:[1,0]
    v_pk_add_f32 v[108:109], v[108:109], v[12:13] op_sel_hi:[1,0]
    v_pk_add_f32 v[110:111], v[110:111], v[12:13] op_sel_hi:[1,0]
    v_cvt_pk_bf16_f32 v100, v104, v105
    v_cvt_pk_bf16_f32 v101, v106, v107
    v_cvt_pk_bf16_f32 v102, v108, v109
    v_cvt_pk_bf16_f32 v103, v110, v111
    v_pk_mul_f32 v[120:121], v[120:121], v[144:145]
    v_pk_mul_f32 v[122:123], v[122:123], v[146:147]
    v_pk_mul_f32 v[124:125], v[124:125], v[148:149]
    v_pk_mul_f32 v[126:127], v[126:127], v[150:151]
    v_cvt_pk_bf16_f32 v116, v120, v121
    v_cvt_pk_bf16_f32 v117, v122, v123
    v_cvt_pk_bf16_f32 v118, v124, v125
    v_cvt_pk_bf16_f32 v119, v126, v127
    v_cndmask_b32 v116, v116, v9, s[60:61]
    v_cndmask_b32 v117, v117, v9, s[60:61]
    v_cndmask_b32 v118, v118, v9, s[60:61]
    v_cndmask_b32 v119, v119, v9, s[60:61]
    v_mfma_f32_32x32x16_bf16 v[144:159], v[96:99], v[112:115], 0
    s_nop 0
    v_mfma_f32_32x32x16_bf16 v[144:159], v[100:103], v[116:119], v[144:159]
    s_mov_b32 s52, 0x80808080
    s_mov_b32 s53, 0x80808080
    s_nop 9
    ds_write_b128 v11, v[144:147] offset:0
    ds_write_b128 v11, v[148:151] offset:1024
    ds_write_b128 v11, v[152:155] offset:2048
    ds_write_b128 v11, v[156:159] offset:3072
    v_lshlrev_b32 v11, 3, v0
    s_waitcnt lgkmcnt(0)
    s_barrier
    ds_read_b128 v[96:99], v172 offset:0
    ds_read_b128 v[100:103], v172 offset:4096
    ds_read_b128 v[104:107], v172 offset:8192
    ds_read_b128 v[108:111], v172 offset:12288
    ds_read_b64_tr_b16 v[152:153], v2 offset:8192
    ds_read_b64_tr_b16 v[154:155], v2 offset:8704
    ds_read_b64_tr_b16 v[156:157], v2 offset:9216
    ds_read_b64_tr_b16 v[158:159], v2 offset:9728
    ds_read_b64_tr_b16 v[144:145], v2 offset:10240
    ds_read_b64_tr_b16 v[146:147], v2 offset:10752
    ds_read_b64_tr_b16 v[148:149], v2 offset:11264
    ds_read_b64_tr_b16 v[150:151], v2 offset:11776
    s_waitcnt lgkmcnt(10)
    v_pk_add_f32 v[96:97], v[96:97], v[100:101]
    v_pk_add_f32 v[98:99], v[98:99], v[102:103]
    s_waitcnt lgkmcnt(8)
    v_pk_add_f32 v[104:105], v[104:105], v[108:109]
    v_pk_add_f32 v[106:107], v[106:107], v[110:111]
    v_pk_add_f32 v[96:97], v[96:97], v[104:105]
    v_pk_add_f32 v[98:99], v[98:99], v[106:107]
    v_cvt_pk_bf16_f32 v96, v96, v97
    v_cvt_pk_bf16_f32 v97, v98, v99
    v_cndmask_b32 v96, v96, v4, s[52:53]
    v_cndmask_b32 v97, v97, v4, s[52:53]
    buffer_store_dwordx2 v[96:97], v11, s[40:43], s79 offen sc1
    s_waitcnt lgkmcnt(4)
    v_mfma_f32_32x32x16_bf16 v[128:143], v[152:155], v[48:51], v[128:143]
    ds_read_b64_tr_b16 v[152:153], v2 offset:12288
    ds_read_b64_tr_b16 v[154:155], v2 offset:12800
    s_add_u32 s51, s75, s66
    buffer_load_dwordx4 v[160:163], v1, s[36:39], s51 offen offset:0 sc1
    v_mfma_f32_32x32x16_bf16 v[128:143], v[156:159], v[52:55], v[128:143]
    ds_read_b64_tr_b16 v[156:157], v2 offset:13312
    ds_read_b64_tr_b16 v[158:159], v2 offset:13824
    buffer_load_dwordx4 v[164:167], v1, s[36:39], s51 offen offset:1024 sc1
    s_waitcnt lgkmcnt(4)
    v_mfma_f32_32x32x16_bf16 v[128:143], v[144:147], v[56:59], v[128:143]
    ds_read_b64_tr_b16 v[144:145], v2 offset:14336
    ds_read_b64_tr_b16 v[146:147], v2 offset:14848
    s_mul_i32 s51, s48, 888832
    s_add_u32 s36, s36, s51
    s_addc_u32 s37, s37, 0
    s_sub_u32 s38, s38, s51
    v_mfma_f32_32x32x16_bf16 v[128:143], v[148:151], v[60:63], v[128:143]
    ds_read_b64_tr_b16 v[148:149], v2 offset:15360
    ds_read_b64_tr_b16 v[150:151], v2 offset:15872
    s_cmp_eq_u32 s46, 3
    s_cselect_b32 s88, 0xffff0000, 0
    s_cselect_b32 s89, 0xffff0000, 0
    s_waitcnt lgkmcnt(4)
    v_mfma_f32_32x32x16_bf16 v[128:143], v[152:155], v[64:67], v[128:143]
    ds_read_b64_tr_b16 v[152:153], v2 offset:16384
    ds_read_b64_tr_b16 v[154:155], v2 offset:16896
    v_lshrrev_b32 v101, 5, v0
    v_and_b32 v102, 15, v0
    v_mfma_f32_32x32x16_bf16 v[128:143], v[156:159], v[68:71], v[128:143]
    ds_read_b64_tr_b16 v[156:157], v2 offset:17408
    ds_read_b64_tr_b16 v[158:159], v2 offset:17920
    v_lshl_add_u32 v101, v102, 1, v101
    v_bfe_u32 v100, v0, 4, 1
    s_waitcnt lgkmcnt(4)
    v_mfma_f32_32x32x16_bf16 v[128:143], v[144:147], v[72:75], v[128:143]
    ds_read_b64_tr_b16 v[144:145], v2 offset:18432
    ds_read_b64_tr_b16 v[146:147], v2 offset:18944
    v_lshrrev_b32 v102, 3, v101
    v_sub_u32 v102, v101, v102
    v_and_b32 v101, 7, v101
    v_mfma_f32_32x32x16_bf16 v[128:143], v[148:151], v[76:79], v[128:143]
    ds_read_b64_tr_b16 v[148:149], v2 offset:19456
    ds_read_b64_tr_b16 v[150:151], v2 offset:19968
    v_cmp_eq_u32 vcc, 7, v101
    s_nop 1
    v_cndmask_b32 v102, v102, 31, vcc
    s_waitcnt lgkmcnt(4)
    v_mfma_f32_32x32x16_bf16 v[128:143], v[152:155], v[80:83], v[128:143]
    ds_read_b64_tr_b16 v[152:153], v2 offset:20480
    ds_read_b64_tr_b16 v[154:155], v2 offset:20992
    v_lshl_add_u32 v100, v100, 5, v102
    s_lshl_b32 s53, s46, 3
    v_mfma_f32_32x32x16_bf16 v[128:143], v[156:159], v[84:87], v[128:143]
    ds_read_b64_tr_b16 v[156:157], v2 offset:21504
    ds_read_b64_tr_b16 v[158:159], v2 offset:22016
    v_lshlrev_b32 v100, 5, v100
    v_add_u32 v100, s53, v100
    v_and_b32 v101, 1, v102
    s_waitcnt lgkmcnt(4)
    v_mfma_f32_32x32x16_bf16 v[128:143], v[144:147], v[88:91], v[128:143]
    ds_read_b64_tr_b16 v[144:145], v2 offset:22528
    ds_read_b64_tr_b16 v[146:147], v2 offset:23040
    v_lshlrev_b32 v101, 10, v101
    v_lshrrev_b32 v102, 1, v102
    v_mfma_f32_32x32x16_bf16 v[128:143], v[148:151], v[92:95], v[128:143]
    ds_read_b64_tr_b16 v[148:149], v2 offset:23552
    ds_read_b64_tr_b16 v[150:151], v2 offset:24064
    v_cmp_gt_u32 vcc, 4, v102
    v_lshl_add_u32 v101, v102, 3, v101
    v_add_u32 v101, 896, v101
    s_waitcnt lgkmcnt(4)
    v_mfma_f32_32x32x16_bf16 v[128:143], v[152:155], v[16:19], v[128:143]
    ds_read_b64_tr_b16 v[152:153], v2 offset:24576
    ds_read_b64_tr_b16 v[154:155], v2 offset:25088
    s_and_b64 vcc, vcc, s[88:89]
    v_cndmask_b32 v100, v100, v101, vcc
    v_mfma_f32_32x32x16_bf16 v[128:143], v[156:159], v[20:23], v[128:143]
    ds_read_b64_tr_b16 v[156:157], v2 offset:25600
    ds_read_b64_tr_b16 v[158:159], v2 offset:26112
    v_add_u32 v100, 160000, v100
    v_bfe_u32 v101, v0, 3, 1
    s_waitcnt lgkmcnt(4)
    v_mfma_f32_32x32x16_bf16 v[128:143], v[144:147], v[24:27], v[128:143]
    ds_read_b64_tr_b16 v[144:145], v2 offset:26624
    ds_read_b64_tr_b16 v[146:147], v2 offset:27136
    v_and_b32 v102, 3, v0
    v_lshl_add_u32 v101, v101, 2, v102
    v_cmp_eq_u32 vcc, 7, v101
    v_mfma_f32_32x32x16_bf16 v[128:143], v[148:151], v[28:31], v[128:143]
    ds_read_b64_tr_b16 v[148:149], v2 offset:27648
    ds_read_b64_tr_b16 v[150:151], v2 offset:28160
    v_bfe_u32 v102, v0, 4, 1
    v_mad_u32_u24 v101, v102, 14, v101
    s_waitcnt lgkmcnt(4)
    v_mfma_f32_32x32x16_bf16 v[128:143], v[152:155], v[32:35], v[128:143]
    ds_read_b64 v[152:153], v10 offset:0
    v_mov_b32 v154, 0
    v_mov_b32 v155, 0
    v_bfe_u32 v102, v0, 2, 1
    v_mad_u32_u24 v101, v102, 7, v101
    v_mfma_f32_32x32x16_bf16 v[128:143], v[156:159], v[36:39], v[128:143]
    v_cndmask_b32 v101, v101, 28, vcc
    v_and_b32 v102, 32, v0
    v_add_u32 v101, v101, v102
    s_waitcnt lgkmcnt(1)
    v_mfma_f32_32x32x16_bf16 v[128:143], v[144:147], v[40:43], v[128:143]
    v_lshlrev_b32 v101, 5, v101
    v_add_u32 v101, 160000, v101
    v_mfma_f32_32x32x16_bf16 v[128:143], v[148:151], v[44:47], v[128:143]
    s_and_b32 s22, s47, 0x1fff
    s_or_b32 s22, s22, 0x4000
    s_lshl_b32 s23, s22, 16
    s_waitcnt lgkmcnt(0)
    v_mfma_f32_32x32x16_bf16 v[128:143], v[152:155], v[168:171], v[128:143]
    s_add_u32 s86, s78, 0
    buffer_load_dwordx4 v[48:51], v1, s[40:43], s86 offen offset:0 sc1
    buffer_load_dwordx4 v[52:55], v1, s[40:43], s86 offen offset:1024 sc1
    buffer_load_dwordx4 v[56:59], v1, s[40:43], s86 offen offset:2048 sc1
    buffer_load_dwordx4 v[60:63], v1, s[40:43], s86 offen offset:3072 sc1
    s_add_u32 s86, s78, 4096
    buffer_load_dwordx4 v[64:67], v1, s[40:43], s86 offen offset:0 sc1
    buffer_load_dwordx4 v[68:71], v1, s[40:43], s86 offen offset:1024 sc1
    buffer_load_dwordx4 v[72:75], v1, s[40:43], s86 offen offset:2048 sc1
    buffer_load_dwordx4 v[76:79], v1, s[40:43], s86 offen offset:3072 sc1
    v_mov_b32 v98, 0x3f80
    v_mov_b32 v99, 0x3f800000
    v_pk_mul_f32 v[128:129], v[128:129], v[6:7] op_sel_hi:[1,0]
    v_pk_mul_f32 v[130:131], v[130:131], v[6:7] op_sel_hi:[1,0]
    v_pk_mul_f32 v[132:133], v[132:133], v[6:7] op_sel_hi:[1,0]
    v_pk_mul_f32 v[134:135], v[134:135], v[6:7] op_sel_hi:[1,0]
    v_exp_f32 v32, v128 clamp
    v_max_f32 v128, 0, v128
    v_exp_f32 v33, v129 clamp
    v_max_f32 v129, 0, v129
    v_exp_f32 v34, v130 clamp
    v_max_f32 v130, 0, v130
    v_exp_f32 v35, v131 clamp
    v_max_f32 v131, 0, v131
    v_exp_f32 v36, v132 clamp
    v_max_f32 v132, 0, v132
    v_exp_f32 v37, v133 clamp
    v_max_f32 v133, 0, v133
    v_exp_f32 v38, v134 clamp
    v_max_f32 v134, 0, v134
    v_exp_f32 v39, v135 clamp
    v_max_f32 v135, 0, v135
    v_pk_fma_f32 v[128:129], v[128:129], s[56:57], v[32:33] op_sel:[0,1,0] op_sel_hi:[1,1,1]
    v_pk_fma_f32 v[130:131], v[130:131], s[56:57], v[34:35] op_sel:[0,1,0] op_sel_hi:[1,1,1]
    v_pk_fma_f32 v[132:133], v[132:133], s[56:57], v[36:37] op_sel:[0,1,0] op_sel_hi:[1,1,1]
    v_pk_fma_f32 v[134:135], v[134:135], s[56:57], v[38:39] op_sel:[0,1,0] op_sel_hi:[1,1,1]
    v_pk_add_f32 v[128:129], v[128:129], v[12:13] op_sel_hi:[1,0]
    v_pk_add_f32 v[130:131], v[130:131], v[12:13] op_sel_hi:[1,0]
    v_pk_add_f32 v[132:133], v[132:133], v[12:13] op_sel_hi:[1,0]
    v_pk_add_f32 v[134:135], v[134:135], v[12:13] op_sel_hi:[1,0]
    v_cvt_pk_bf16_f32 v104, v128, v129
    v_cvt_pk_bf16_f32 v105, v130, v131
    v_cvt_pk_bf16_f32 v106, v132, v133
    v_cvt_pk_bf16_f32 v107, v134, v135
    v_pk_mul_f32 v[136:137], v[136:137], v[6:7] op_sel_hi:[1,0]
    v_pk_mul_f32 v[138:139], v[138:139], v[6:7] op_sel_hi:[1,0]
    v_pk_mul_f32 v[140:141], v[140:141], v[6:7] op_sel_hi:[1,0]
    v_pk_mul_f32 v[142:143], v[142:143], v[6:7] op_sel_hi:[1,0]
    v_exp_f32 v32, v136 clamp
    v_max_f32 v136, 0, v136
    v_exp_f32 v33, v137 clamp
    v_max_f32 v137, 0, v137
    v_exp_f32 v34, v138 clamp
    v_max_f32 v138, 0, v138
    v_exp_f32 v35, v139 clamp
    v_max_f32 v139, 0, v139
    v_exp_f32 v36, v140 clamp
    v_max_f32 v140, 0, v140
    v_exp_f32 v37, v141 clamp
    v_max_f32 v141, 0, v141
    v_exp_f32 v38, v142 clamp
    v_max_f32 v142, 0, v142
    v_exp_f32 v39, v143 clamp
    v_max_f32 v143, 0, v143
    v_pk_fma_f32 v[136:137], v[136:137], s[56:57], v[32:33] op_sel:[0,1,0] op_sel_hi:[1,1,1]
    v_pk_fma_f32 v[138:139], v[138:139], s[56:57], v[34:35] op_sel:[0,1,0] op_sel_hi:[1,1,1]
    v_pk_fma_f32 v[140:141], v[140:141], s[56:57], v[36:37] op_sel:[0,1,0] op_sel_hi:[1,1,1]
    v_pk_fma_f32 v[142:143], v[142:143], s[56:57], v[38:39] op_sel:[0,1,0] op_sel_hi:[1,1,1]
    v_pk_add_f32 v[136:137], v[136:137], v[12:13] op_sel_hi:[1,0]
    v_pk_add_f32 v[138:139], v[138:139], v[12:13] op_sel_hi:[1,0]
    v_pk_add_f32 v[140:141], v[140:141], v[12:13] op_sel_hi:[1,0]
    v_pk_add_f32 v[142:143], v[142:143], v[12:13] op_sel_hi:[1,0]
    v_cvt_pk_bf16_f32 v108, v136, v137
    v_cvt_pk_bf16_f32 v109, v138, v139
    v_cvt_pk_bf16_f32 v110, v140, v141
    v_cvt_pk_bf16_f32 v111, v142, v143
    v_cndmask_b32 v110, v110, 0, s[62:63]
    v_cndmask_b32 v111, v111, 0, s[62:63]
    v_and_b32 v10, 15, v0
    v_lshlrev_b32 v10, 11, v10
    v_add_u32 v10, 2044, v10
    v_lshrrev_b32 v3, 5, v0
    v_mul_u32_u24 v3, 7, v3
    v_bfe_u32 v11, v0, 2, 2
    v_add_u32 v3, v3, v11
    v_mul_u32_u24 v3, 64, v3
    v_bfe_u32 v11, v0, 4, 1
    v_lshl_add_u32 v3, v11, 5, v3
    v_and_b32 v11, 3, v0
    v_lshl_add_u32 v3, v11, 3, v3
    v_add_u32 v3, 114688, v3
    v_lshrrev_b32 v172, 5, v0
    v_lshlrev_b32 v172, 2, v172
    v_and_b32 v173, 31, v0
    v_sub_u32 v120, v173, v172
    v_mov_b32 v121, 0x3f80
    v_mov_b32 v122, 0x3f800000
    v_cmp_eq_u32 vcc, 0, v120
    v_cmp_eq_u32 s[88:89], 1, v120
    s_nop 0
    v_cndmask_b32 v172, 0, v121, vcc
    v_cndmask_b32 v172, v172, v122, s[88:89]
    v_cmp_eq_u32 vcc, 2, v120
    v_cmp_eq_u32 s[88:89], 3, v120
    s_nop 0
    v_cndmask_b32 v173, 0, v121, vcc
    v_cndmask_b32 v173, v173, v122, s[88:89]
    v_cmp_eq_u32 vcc, 8, v120
    v_cmp_eq_u32 s[88:89], 9, v120
    s_nop 0
    v_cndmask_b32 v174, 0, v121, vcc
    v_cndmask_b32 v174, v174, v122, s[88:89]
    v_cmp_eq_u32 vcc, 10, v120
    v_cmp_eq_u32 s[88:89], 11, v120
    s_nop 0
    v_cndmask_b32 v175, 0, v121, vcc
    v_cndmask_b32 v175, v175, v122, s[88:89]
    s_lshl_b32 s51, s68, 15
    s_lshl_b32 s53, s73, 10
    s_add_u32 s51, s51, s53
    s_add_u32 s34, s51, 131072
    s_lshl_b32 s51, s44, 2
    s_add_u32 s51, s51, s68
    s_mul_i32 s51, s51, 28672
    s_lshl_b32 s53, s73, 5
    s_add_u32 s28, s51, s53
    s_lshl_b32 s51, s69, 15
    s_lshl_b32 s53, s73, 10
    s_add_u32 s51, s51, s53
    s_add_u32 s35, s51, 131072
    s_lshl_b32 s51, s44, 2
    s_add_u32 s51, s51, s69
    s_mul_i32 s51, s51, 28672
    s_lshl_b32 s53, s73, 5
    s_add_u32 s29, s51, s53
    s_add_u32 s55, s75, 131072
    s_lshr_b32 s56, s45, 2
    s_lshl_b32 s56, s56, 10
    s_and_b32 s52, s45, 3
    s_lshl_b32 s52, s52, 2
    s_add_u32 s56, s56, s52
    s_add_u32 s56, s56, s74
    s_add_u32 s56, s56, 159744
    s_waitcnt vmcnt(8)
    v_and_b32 v31, 0xffff0000, v167
    v_lshlrev_b32 v30, 16, v167
    v_and_b32 v29, 0xffff0000, v166
    v_lshlrev_b32 v28, 16, v166
    v_and_b32 v27, 0xffff0000, v165
    v_lshlrev_b32 v26, 16, v165
    v_and_b32 v25, 0xffff0000, v164
    v_lshlrev_b32 v24, 16, v164
    v_and_b32 v23, 0xffff0000, v163
    v_lshlrev_b32 v22, 16, v163
    v_and_b32 v21, 0xffff0000, v162
    v_lshlrev_b32 v20, 16, v162
    v_and_b32 v19, 0xffff0000, v161
    v_lshlrev_b32 v18, 16, v161
    v_and_b32 v17, 0xffff0000, v160
    v_lshlrev_b32 v16, 16, v160
    s_mov_b32 s88, 0x88888888
    s_mov_b32 s89, 0x88888888
Lsweep_66:
    v_mov_b32 v11, 0
    s_waitcnt vmcnt(7)
    v_dot2_f32_bf16 v80, v48, v98, 0
    v_dot2_f32_bf16 v81, v48, v99, 0
    v_dot2_f32_bf16 v82, v49, v98, 0
    v_dot2_f32_bf16 v83, v49, v99, 0
    v_dot2_f32_bf16 v84, v50, v98, 0
    v_dot2_f32_bf16 v85, v50, v99, 0
    v_dot2_f32_bf16 v86, v51, v98, 0
    v_dot2_f32_bf16 v87, v51, v99, 0
    v_bitop3_b32 v11, v50, s47, v11 bitop3:0xbe
    v_bitop3_b32 v11, v51, s47, v11 bitop3:0xbe
    s_waitcnt vmcnt(6)
    v_dot2_f32_bf16 v80, v52, v98, v80
    v_dot2_f32_bf16 v81, v52, v99, v81
    v_dot2_f32_bf16 v82, v53, v98, v82
    v_dot2_f32_bf16 v83, v53, v99, v83
    v_dot2_f32_bf16 v84, v54, v98, v84
    v_dot2_f32_bf16 v85, v54, v99, v85
    v_dot2_f32_bf16 v86, v55, v98, v86
    v_dot2_f32_bf16 v87, v55, v99, v87
    v_bitop3_b32 v11, v54, s47, v11 bitop3:0xbe
    v_bitop3_b32 v11, v55, s47, v11 bitop3:0xbe
    s_waitcnt vmcnt(5)
    v_dot2_f32_bf16 v80, v56, v98, v80
    v_dot2_f32_bf16 v81, v56, v99, v81
    v_dot2_f32_bf16 v82, v57, v98, v82
    v_dot2_f32_bf16 v83, v57, v99, v83
    v_dot2_f32_bf16 v84, v58, v98, v84
    v_dot2_f32_bf16 v85, v58, v99, v85
    v_dot2_f32_bf16 v86, v59, v98, v86
    v_dot2_f32_bf16 v87, v59, v99, v87
    v_bitop3_b32 v11, v58, s47, v11 bitop3:0xbe
    v_bitop3_b32 v11, v59, s47, v11 bitop3:0xbe
    s_waitcnt vmcnt(4)
    v_dot2_f32_bf16 v80, v60, v98, v80
    v_dot2_f32_bf16 v81, v60, v99, v81
    v_dot2_f32_bf16 v82, v61, v98, v82
    v_dot2_f32_bf16 v83, v61, v99, v83
    v_dot2_f32_bf16 v84, v62, v98, v84
    v_dot2_f32_bf16 v85, v62, v99, v85
    v_dot2_f32_bf16 v86, v63, v98, v86
    v_dot2_f32_bf16 v87, v63, v99, v87
    v_bitop3_b32 v11, v62, s47, v11 bitop3:0xbe
    v_bitop3_b32 v11, v63, s47, v11 bitop3:0xbe
    s_waitcnt vmcnt(3)
    v_dot2_f32_bf16 v80, v64, v98, v80
    v_dot2_f32_bf16 v81, v64, v99, v81
    v_dot2_f32_bf16 v82, v65, v98, v82
    v_dot2_f32_bf16 v83, v65, v99, v83
    v_dot2_f32_bf16 v84, v66, v98, v84
    v_dot2_f32_bf16 v85, v66, v99, v85
    v_dot2_f32_bf16 v86, v67, v98, v86
    v_dot2_f32_bf16 v87, v67, v99, v87
    v_bitop3_b32 v11, v66, s47, v11 bitop3:0xbe
    v_bitop3_b32 v11, v67, s47, v11 bitop3:0xbe
    s_waitcnt vmcnt(2)
    v_dot2_f32_bf16 v80, v68, v98, v80
    v_dot2_f32_bf16 v81, v68, v99, v81
    v_dot2_f32_bf16 v82, v69, v98, v82
    v_dot2_f32_bf16 v83, v69, v99, v83
    v_dot2_f32_bf16 v84, v70, v98, v84
    v_dot2_f32_bf16 v85, v70, v99, v85
    v_dot2_f32_bf16 v86, v71, v98, v86
    v_dot2_f32_bf16 v87, v71, v99, v87
    v_bitop3_b32 v11, v70, s47, v11 bitop3:0xbe
    v_bitop3_b32 v11, v71, s47, v11 bitop3:0xbe
    s_waitcnt vmcnt(1)
    v_dot2_f32_bf16 v80, v72, v98, v80
    v_dot2_f32_bf16 v81, v72, v99, v81
    v_dot2_f32_bf16 v82, v73, v98, v82
    v_dot2_f32_bf16 v83, v73, v99, v83
    v_dot2_f32_bf16 v84, v74, v98, v84
    v_dot2_f32_bf16 v85, v74, v99, v85
    v_dot2_f32_bf16 v86, v75, v98, v86
    v_dot2_f32_bf16 v87, v75, v99, v87
    v_bitop3_b32 v11, v74, s47, v11 bitop3:0xbe
    v_bitop3_b32 v11, v75, s47, v11 bitop3:0xbe
    s_waitcnt vmcnt(0)
    v_dot2_f32_bf16 v80, v76, v98, v80
    v_dot2_f32_bf16 v81, v76, v99, v81
    v_dot2_f32_bf16 v82, v77, v98, v82
    v_dot2_f32_bf16 v83, v77, v99, v83
    v_dot2_f32_bf16 v84, v78, v98, v84
    v_dot2_f32_bf16 v85, v78, v99, v85
    v_dot2_f32_bf16 v86, v79, v98, v86
    v_dot2_f32_bf16 v87, v79, v99, v87
    v_bitop3_b32 v11, v78, s47, v11 bitop3:0xbe
    v_bitop3_b32 v11, v79, s47, v11 bitop3:0xbe
    v_cmp_ne_u32 vcc, 0, v11
    s_and_b64 vcc, vcc, s[88:89]
    s_cbranch_vccnz Lresweep_67
    v_permlane32_swap_b32 v80, v84
    v_permlane32_swap_b32 v81, v85
    v_permlane32_swap_b32 v82, v86
    v_permlane32_swap_b32 v83, v87
    v_pk_add_f32 v[80:81], v[80:81], v[84:85]
    v_pk_add_f32 v[82:83], v[82:83], v[86:87]
    v_cvt_pk_bf16_f32 v80, v80, v81
    v_cvt_pk_bf16_f32 v81, v82, v83
    ds_write_b64 v100, v[80:81]
    s_waitcnt lgkmcnt(0)
    s_barrier
    ds_read_b128 v[72:75], v101
    ds_read_b128 v[76:79], v101 offset:16
    ds_read_b64_tr_b16 v[144:145], v3 offset:0
    ds_read_b64_tr_b16 v[146:147], v3 offset:256
    ds_read_b64_tr_b16 v[148:149], v3 offset:896
    ds_read_b64_tr_b16 v[150:151], v3 offset:1152
    ds_read_b64_tr_b16 v[152:153], v3 offset:1792
    ds_read_b64_tr_b16 v[154:155], v3 offset:2048
    ds_read_b64_tr_b16 v[156:157], v3 offset:2688
    ds_read_b64_tr_b16 v[158:159], v3 offset:2944
    s_waitcnt lgkmcnt(9)
    v_mfma_f32_32x32x16_bf16 v[80:95], v[72:75], v[104:107], 0
    s_waitcnt lgkmcnt(8)
    v_cndmask_b32 v78, v78, 0, s[62:63]
    v_cndmask_b32 v79, v79, 0, s[62:63]
    s_nop 1
    v_mfma_f32_32x32x16_bf16 v[80:95], v[76:79], v[108:111], v[80:95]
    s_nop 11
    v_add_f32 v120, 0x358637bd, v87
    v_rcp_f32 v120, v120
    s_nop 0
    v_mul_f32 v120, s57, v120
    v_pk_mul_f32 v[80:81], v[80:81], v[120:121] op_sel_hi:[1,0]
    v_pk_mul_f32 v[82:83], v[82:83], v[120:121] op_sel_hi:[1,0]
    v_pk_mul_f32 v[84:85], v[84:85], v[120:121] op_sel_hi:[1,0]
    v_pk_mul_f32 v[86:87], v[86:87], v[120:121] op_sel_hi:[1,0]
    v_pk_mul_f32 v[88:89], v[88:89], v[120:121] op_sel_hi:[1,0]
    v_pk_mul_f32 v[90:91], v[90:91], v[120:121] op_sel_hi:[1,0]
    v_pk_mul_f32 v[92:93], v[92:93], v[120:121] op_sel_hi:[1,0]
    v_pk_mul_f32 v[94:95], v[94:95], v[120:121] op_sel_hi:[1,0]
    v_mov_b32 v87, s23
    v_mov_b32 v95, s23
    v_cvt_pk_bf16_f32 v80, v80, v81
    v_cvt_pk_bf16_f32 v81, v82, v83
    v_cvt_pk_bf16_f32 v82, v84, v85
    v_cvt_pk_bf16_f32 v83, v86, v87
    v_cvt_pk_bf16_f32 v84, v88, v89
    v_cvt_pk_bf16_f32 v85, v90, v91
    v_cvt_pk_bf16_f32 v86, v92, v93
    v_cvt_pk_bf16_f32 v87, v94, v95
    s_cmp_lg_u32 s48, 0
    s_cbranch_scc1 Lslow_68
    buffer_store_dwordx4 v[80:83], v1, s[36:39], s75 offen offset:0 nt
    buffer_store_dwordx4 v[84:87], v1, s[36:39], s75 offen offset:1024 nt
Lback_69:
    s_cmp_ge_u32 s45, 14
    s_cbranch_scc1 L_fin
Ls2_70:
    s_sleep 5
    buffer_load_dword v9, v10, s[36:39], s74 offen sc1
    v_mov_b32 v11, 0
    s_waitcnt vmcnt(0)
    v_lshrrev_b32 v9, 16, v9
    v_cmp_ne_u32 vcc, s22, v9
    s_cbranch_vccnz Lspin_72
Lgot_73:
    s_add_u32 s51, s74, 0
    buffer_load_dwordx4 v[32:35], v1, s[36:39], s51 offen offset:0 sc1
    buffer_load_dwordx4 v[36:39], v1, s[36:39], s51 offen offset:1024 sc1
    buffer_load_dwordx4 v[40:43], v1, s[36:39], s51 offen offset:2048 sc1
    buffer_load_dwordx4 v[44:47], v1, s[36:39], s51 offen offset:3072 sc1
    s_add_u32 s51, s74, 4096
    buffer_load_dwordx4 v[48:51], v1, s[36:39], s51 offen offset:0 sc1
    buffer_load_dwordx4 v[52:55], v1, s[36:39], s51 offen offset:1024 sc1
    buffer_load_dwordx4 v[56:59], v1, s[36:39], s51 offen offset:2048 sc1
    buffer_load_dwordx4 v[60:63], v1, s[36:39], s51 offen offset:3072 sc1
    s_add_u32 s51, s74, 8192
    buffer_load_dwordx4 v[64:67], v1, s[36:39], s51 offen offset:0 sc1
    buffer_load_dwordx4 v[68:71], v1, s[36:39], s51 offen offset:1024 sc1
    s_waitcnt vmcnt(9)
    v_bitop3_b32 v11, v35, s23, v11 bitop3:0xbe
    v_and_b32 v35, 0xffff, v35
    buffer_load_dwordx4 v[72:75], v1, s[36:39], s51 offen offset:2048 sc1
    s_waitcnt lgkmcnt(6)
    v_mfma_f32_32x32x16_bf16 v[16:31], v[144:147], v[32:35], v[16:31]
    ds_read_b64_tr_b16 v[144:145], v3 offset:3584
    ds_read_b64_tr_b16 v[146:147], v3 offset:3840
    s_waitcnt vmcnt(9)
    v_bitop3_b32 v11, v39, s23, v11 bitop3:0xbe
    v_and_b32 v39, 0xffff, v39
    buffer_load_dwordx4 v[76:79], v1, s[36:39], s51 offen offset:3072 sc1
    s_waitcnt lgkmcnt(6)
    v_mfma_f32_32x32x16_bf16 v[16:31], v[148:151], v[36:39], v[16:31]
    ds_read_b64_tr_b16 v[148:149], v3 offset:4480
    ds_read_b64_tr_b16 v[150:151], v3 offset:4736
    s_waitcnt vmcnt(9)
    v_bitop3_b32 v11, v43, s23, v11 bitop3:0xbe
    v_and_b32 v43, 0xffff, v43
    s_add_u32 s51, s74, 12288
    buffer_load_dwordx4 v[80:83], v1, s[36:39], s51 offen offset:0 sc1
    s_waitcnt lgkmcnt(6)
    v_mfma_f32_32x32x16_bf16 v[16:31], v[152:155], v[40:43], v[16:31]
    ds_read_b64_tr_b16 v[152:153], v3 offset:5376
    ds_read_b64_tr_b16 v[154:155], v3 offset:5632
    s_waitcnt vmcnt(9)
    v_bitop3_b32 v11, v47, s23, v11 bitop3:0xbe
    v_and_b32 v47, 0xffff, v47
    buffer_load_dwordx4 v[84:87], v1, s[36:39], s51 offen offset:1024 sc1
    s_waitcnt lgkmcnt(6)
    v_mfma_f32_32x32x16_bf16 v[16:31], v[156:159], v[44:47], v[16:31]
    ds_read_b64_tr_b16 v[156:157], v3 offset:6272
    ds_read_b64_tr_b16 v[158:159], v3 offset:6528
    s_waitcnt vmcnt(9)
    v_bitop3_b32 v11, v51, s23, v11 bitop3:0xbe
    v_and_b32 v51, 0xffff, v51
    buffer_load_dwordx4 v[88:91], v1, s[36:39], s51 offen offset:2048 sc1
    s_waitcnt lgkmcnt(6)
    v_mfma_f32_32x32x16_bf16 v[16:31], v[144:147], v[48:51], v[16:31]
    ds_read_b64_tr_b16 v[144:145], v3 offset:7168
    ds_read_b64_tr_b16 v[146:147], v3 offset:7424
    s_waitcnt vmcnt(9)
    v_bitop3_b32 v11, v55, s23, v11 bitop3:0xbe
    v_and_b32 v55, 0xffff, v55
    buffer_load_dwordx4 v[92:95], v1, s[36:39], s51 offen offset:3072 sc1
    s_waitcnt lgkmcnt(6)
    v_mfma_f32_32x32x16_bf16 v[16:31], v[148:151], v[52:55], v[16:31]
    ds_read_b64_tr_b16 v[148:149], v3 offset:8064
    ds_read_b64_tr_b16 v[150:151], v3 offset:8320
    s_waitcnt vmcnt(9)
    v_bitop3_b32 v11, v59, s23, v11 bitop3:0xbe
    v_and_b32 v59, 0xffff, v59
    s_add_u32 s51, s74, 16384
    buffer_load_dwordx4 v[96:99], v1, s[36:39], s51 offen offset:0 sc1
    s_waitcnt lgkmcnt(6)
    v_mfma_f32_32x32x16_bf16 v[16:31], v[152:155], v[56:59], v[16:31]
    ds_read_b64_tr_b16 v[152:153], v3 offset:8960
    ds_read_b64_tr_b16 v[154:155], v3 offset:9216
    s_waitcnt vmcnt(9)
    v_bitop3_b32 v11, v63, s23, v11 bitop3:0xbe
    v_and_b32 v63, 0xffff, v63
    buffer_load_dwordx4 v[100:103], v1, s[36:39], s51 offen offset:1024 sc1
    s_waitcnt lgkmcnt(6)
    v_mfma_f32_32x32x16_bf16 v[16:31], v[156:159], v[60:63], v[16:31]
    ds_read_b64_tr_b16 v[156:157], v3 offset:9856
    ds_read_b64_tr_b16 v[158:159], v3 offset:10112
    s_waitcnt vmcnt(9)
    v_bitop3_b32 v11, v67, s23, v11 bitop3:0xbe
    v_and_b32 v67, 0xffff, v67
    buffer_load_dwordx4 v[104:107], v1, s[36:39], s51 offen offset:2048 sc1
    s_waitcnt lgkmcnt(6)
    v_mfma_f32_32x32x16_bf16 v[16:31], v[144:147], v[64:67], v[16:31]
    ds_read_b64_tr_b16 v[144:145], v3 offset:10752
    ds_read_b64_tr_b16 v[146:147], v3 offset:11008
    s_waitcnt vmcnt(9)
    v_bitop3_b32 v11, v71, s23, v11 bitop3:0xbe
    v_and_b32 v71, 0xffff, v71
    buffer_load_dwordx4 v[108:111], v1, s[36:39], s51 offen offset:3072 sc1
    s_waitcnt lgkmcnt(6)
    v_mfma_f32_32x32x16_bf16 v[16:31], v[148:151], v[68:71], v[16:31]
    ds_read_b64_tr_b16 v[148:149], v3 offset:11648
    ds_read_b64_tr_b16 v[150:151], v3 offset:11904
    s_waitcnt vmcnt(9)
    v_bitop3_b32 v11, v75, s23, v11 bitop3:0xbe
    v_and_b32 v75, 0xffff, v75
    s_add_u32 s51, s74, 20480
    buffer_load_dwordx4 v[112:115], v1, s[36:39], s51 offen offset:0 sc1
    s_waitcnt lgkmcnt(6)
    v_mfma_f32_32x32x16_bf16 v[16:31], v[152:155], v[72:75], v[16:31]
    ds_read_b64_tr_b16 v[152:153], v3 offset:12544
    ds_read_b64_tr_b16 v[154:155], v3 offset:12800
    s_waitcnt vmcnt(9)
    v_bitop3_b32 v11, v79, s23, v11 bitop3:0xbe
    v_and_b32 v79, 0xffff, v79
    buffer_load_dwordx4 v[116:119], v1, s[36:39], s51 offen offset:1024 sc1
    s_waitcnt lgkmcnt(6)
    v_mfma_f32_32x32x16_bf16 v[16:31], v[156:159], v[76:79], v[16:31]
    ds_read_b64_tr_b16 v[156:157], v3 offset:13440
    ds_read_b64_tr_b16 v[158:159], v3 offset:13696
    s_waitcnt vmcnt(9)
    v_bitop3_b32 v11, v83, s23, v11 bitop3:0xbe
    v_and_b32 v83, 0xffff, v83
    buffer_load_dwordx4 v[120:123], v1, s[36:39], s51 offen offset:2048 sc1
    s_waitcnt lgkmcnt(6)
    v_mfma_f32_32x32x16_bf16 v[16:31], v[144:147], v[80:83], v[16:31]
    ds_read_b64_tr_b16 v[144:145], v3 offset:14336
    ds_read_b64_tr_b16 v[146:147], v3 offset:14592
    s_waitcnt vmcnt(9)
    v_bitop3_b32 v11, v87, s23, v11 bitop3:0xbe
    v_and_b32 v87, 0xffff, v87
    buffer_load_dwordx4 v[124:127], v1, s[36:39], s51 offen offset:3072 sc1
    s_waitcnt lgkmcnt(6)
    v_mfma_f32_32x32x16_bf16 v[16:31], v[148:151], v[84:87], v[16:31]
    ds_read_b64_tr_b16 v[148:149], v3 offset:15232
    ds_read_b64_tr_b16 v[150:151], v3 offset:15488
    s_waitcnt vmcnt(9)
    v_bitop3_b32 v11, v91, s23, v11 bitop3:0xbe
    v_and_b32 v91, 0xffff, v91
    s_add_u32 s51, s74, 24576
    buffer_load_dwordx4 v[128:131], v1, s[36:39], s51 offen offset:0 sc1
    s_waitcnt lgkmcnt(6)
    v_mfma_f32_32x32x16_bf16 v[16:31], v[152:155], v[88:91], v[16:31]
    ds_read_b64_tr_b16 v[152:153], v3 offset:16128
    ds_read_b64_tr_b16 v[154:155], v3 offset:16384
    s_waitcnt vmcnt(9)
    v_bitop3_b32 v11, v95, s23, v11 bitop3:0xbe
    v_and_b32 v95, 0xffff, v95
    buffer_load_dwordx4 v[132:135], v1, s[36:39], s51 offen offset:1024 sc1
    s_waitcnt lgkmcnt(6)
    v_mfma_f32_32x32x16_bf16 v[16:31], v[156:159], v[92:95], v[16:31]
    ds_read_b64_tr_b16 v[156:157], v3 offset:17024
    ds_read_b64_tr_b16 v[158:159], v3 offset:17280
    s_waitcnt vmcnt(9)
    v_bitop3_b32 v11, v99, s23, v11 bitop3:0xbe
    v_and_b32 v99, 0xffff, v99
    buffer_load_dwordx4 v[136:139], v1, s[36:39], s51 offen offset:2048 sc1
    s_waitcnt lgkmcnt(6)
    v_mfma_f32_32x32x16_bf16 v[16:31], v[144:147], v[96:99], v[16:31]
    ds_read_b64_tr_b16 v[144:145], v3 offset:17920
    ds_read_b64_tr_b16 v[146:147], v3 offset:18176
    s_waitcnt vmcnt(9)
    v_bitop3_b32 v11, v103, s23, v11 bitop3:0xbe
    v_and_b32 v103, 0xffff, v103
    buffer_load_dwordx4 v[140:143], v1, s[36:39], s51 offen offset:3072 sc1
    s_waitcnt lgkmcnt(6)
    v_mfma_f32_32x32x16_bf16 v[16:31], v[148:151], v[100:103], v[16:31]
    ds_read_b64_tr_b16 v[148:149], v3 offset:18816
    ds_read_b64_tr_b16 v[150:151], v3 offset:19072
    s_waitcnt vmcnt(9)
    v_bitop3_b32 v11, v107, s23, v11 bitop3:0xbe
    v_and_b32 v107, 0xffff, v107
    s_add_u32 s51, s74, 28672
    buffer_load_dwordx4 v[32:35], v1, s[36:39], s51 offen offset:0 sc1
    s_waitcnt lgkmcnt(6)
    v_mfma_f32_32x32x16_bf16 v[16:31], v[152:155], v[104:107], v[16:31]
    ds_read_b64_tr_b16 v[152:153], v3 offset:19712
    ds_read_b64_tr_b16 v[154:155], v3 offset:19968
    s_waitcnt vmcnt(9)
    v_bitop3_b32 v11, v111, s23, v11 bitop3:0xbe
    v_and_b32 v111, 0xffff, v111
    buffer_load_dwordx4 v[36:39], v1, s[36:39], s51 offen offset:1024 sc1
    s_waitcnt lgkmcnt(6)
    v_mfma_f32_32x32x16_bf16 v[16:31], v[156:159], v[108:111], v[16:31]
    ds_read_b64_tr_b16 v[156:157], v3 offset:20608
    ds_read_b64_tr_b16 v[158:159], v3 offset:20864
    s_waitcnt vmcnt(9)
    v_bitop3_b32 v11, v115, s23, v11 bitop3:0xbe
    v_and_b32 v115, 0xffff, v115
    buffer_load_dwordx4 v[40:43], v1, s[36:39], s51 offen offset:2048 sc1
    s_waitcnt lgkmcnt(6)
    v_mfma_f32_32x32x16_bf16 v[16:31], v[144:147], v[112:115], v[16:31]
    ds_read_b64_tr_b16 v[144:145], v3 offset:21504
    ds_read_b64_tr_b16 v[146:147], v3 offset:21760
    s_waitcnt vmcnt(9)
    v_bitop3_b32 v11, v119, s23, v11 bitop3:0xbe
    v_and_b32 v119, 0xffff, v119
    buffer_load_dwordx4 v[44:47], v1, s[36:39], s51 offen offset:3072 sc1
    s_waitcnt lgkmcnt(6)
    v_mfma_f32_32x32x16_bf16 v[16:31], v[148:151], v[116:119], v[16:31]
    ds_read_b64_tr_b16 v[148:149], v3 offset:22400
    ds_read_b64_tr_b16 v[150:151], v3 offset:22656
    s_waitcnt vmcnt(9)
    v_bitop3_b32 v11, v123, s23, v11 bitop3:0xbe
    v_and_b32 v123, 0xffff, v123
    s_waitcnt lgkmcnt(6)
    s_nop 0
    v_mfma_f32_32x32x16_bf16 v[16:31], v[152:155], v[120:123], v[16:31]
    ds_read_b64_tr_b16 v[152:153], v3 offset:23296
    ds_read_b64_tr_b16 v[154:155], v3 offset:23552
    s_waitcnt vmcnt(8)
    v_bitop3_b32 v11, v127, s23, v11 bitop3:0xbe
    v_and_b32 v127, 0xffff, v127
    s_waitcnt lgkmcnt(6)
    s_nop 0
    v_mfma_f32_32x32x16_bf16 v[16:31], v[156:159], v[124:127], v[16:31]
    ds_read_b64_tr_b16 v[156:157], v3 offset:24192
    ds_read_b64_tr_b16 v[158:159], v3 offset:24448
    s_waitcnt vmcnt(7)
    v_bitop3_b32 v11, v131, s23, v11 bitop3:0xbe
    v_and_b32 v131, 0xffff, v131
    s_waitcnt lgkmcnt(6)
    s_nop 0
    v_mfma_f32_32x32x16_bf16 v[16:31], v[144:147], v[128:131], v[16:31]
    ds_read_b64_tr_b16 v[144:145], v3 offset:25088
    ds_read_b64_tr_b16 v[146:147], v3 offset:25344
    s_waitcnt vmcnt(6)
    v_bitop3_b32 v11, v135, s23, v11 bitop3:0xbe
    v_and_b32 v135, 0xffff, v135
    s_waitcnt lgkmcnt(6)
    s_nop 0
    v_mfma_f32_32x32x16_bf16 v[16:31], v[148:151], v[132:135], v[16:31]
    ds_read_b64_tr_b16 v[148:149], v3 offset:25984
    ds_read_b64_tr_b16 v[150:151], v3 offset:26240
    s_waitcnt vmcnt(5)
    v_bitop3_b32 v11, v139, s23, v11 bitop3:0xbe
    v_and_b32 v139, 0xffff, v139
    s_waitcnt lgkmcnt(6)
    s_nop 0
    v_mfma_f32_32x32x16_bf16 v[16:31], v[152:155], v[136:139], v[16:31]
    ds_read_b64_tr_b16 v[152:153], v3 offset:26880
    ds_read_b64_tr_b16 v[154:155], v3 offset:27136
    s_waitcnt vmcnt(4)
    v_bitop3_b32 v11, v143, s23, v11 bitop3:0xbe
    v_and_b32 v143, 0xffff, v143
    s_waitcnt lgkmcnt(6)
    s_nop 0
    v_mfma_f32_32x32x16_bf16 v[16:31], v[156:159], v[140:143], v[16:31]
    ds_read_b64_tr_b16 v[156:157], v3 offset:27776
    ds_read_b64_tr_b16 v[158:159], v3 offset:28032
    s_waitcnt vmcnt(3)
    v_bitop3_b32 v11, v35, s23, v11 bitop3:0xbe
    v_and_b32 v35, 0xffff, v35
    s_waitcnt lgkmcnt(6)
    s_nop 0
    v_mfma_f32_32x32x16_bf16 v[16:31], v[144:147], v[32:35], v[16:31]
    s_waitcnt vmcnt(2)
    v_bitop3_b32 v11, v39, s23, v11 bitop3:0xbe
    v_and_b32 v39, 0xffff, v39
    v_and_b32 v13, 15, v0
    v_min_u32 v13, 13, v13
    v_lshlrev_b32 v13, 2, v13
    v_lshrrev_b32 v14, 4, v0
    v_lshl_add_u32 v13, v14, 7, v13
    s_waitcnt lgkmcnt(4)
    v_mfma_f32_32x32x16_bf16 v[16:31], v[148:151], v[36:39], v[16:31]
    s_waitcnt vmcnt(1)
    v_bitop3_b32 v11, v43, s23, v11 bitop3:0xbe
    v_and_b32 v43, 0xffff, v43
    s_waitcnt lgkmcnt(2)
    s_nop 0
    v_mfma_f32_32x32x16_bf16 v[16:31], v[152:155], v[40:43], v[16:31]
    s_waitcnt vmcnt(0)
    v_bitop3_b32 v11, v47, s23, v11 bitop3:0xbe
    v_and_b32 v47, 0xffff, v47
    s_waitcnt lgkmcnt(0)
    s_nop 0
    v_mfma_f32_32x32x16_bf16 v[16:31], v[156:159], v[44:47], v[16:31]
    v_cmp_lt_u32 vcc, 0xffff, v11
    s_cbranch_vccnz Ls2again_71
    v_mov_b32 v10, v13
    s_nop 8
    v_cvt_pk_bf16_f32 v32, v16, v17
    v_cvt_pk_bf16_f32 v33, v18, v19
    v_cvt_pk_bf16_f32 v34, v20, v21
    v_cvt_pk_bf16_f32 v35, v22, v23
    v_cvt_pk_bf16_f32 v36, v24, v25
    v_cvt_pk_bf16_f32 v37, v26, v27
    v_cvt_pk_bf16_f32 v38, v28, v29
    v_cvt_pk_bf16_f32 v39, v30, v31
    s_cmp_lg_u32 s48, 0
    s_cbranch_scc1 Lslow_74
    buffer_store_dwordx4 v[32:35], v1, s[36:39], s55 offen offset:0 nt
    buffer_store_dwordx4 v[36:39], v1, s[36:39], s55 offen offset:1024 nt
Lback_75:
    v_mov_b32 v13, 0x3f803f80
    v_dot2_f32_bf16 v11, v32, v13, 0
    v_dot2_f32_bf16 v12, v32, v32, 0
    v_dot2_f32_bf16 v11, v33, v13, v11
    v_dot2_f32_bf16 v12, v33, v33, v12
    v_dot2_f32_bf16 v11, v34, v13, v11
    v_dot2_f32_bf16 v12, v34, v34, v12
    v_dot2_f32_bf16 v11, v35, v13, v11
    v_dot2_f32_bf16 v12, v35, v35, v12
    v_dot2_f32_bf16 v11, v36, v13, v11
    v_dot2_f32_bf16 v12, v36, v36, v12
    v_dot2_f32_bf16 v11, v37, v13, v11
    v_dot2_f32_bf16 v12, v37, v37, v12
    v_dot2_f32_bf16 v11, v38, v13, v11
    v_dot2_f32_bf16 v12, v38, v38, v12
    v_dot2_f32_bf16 v11, v39, v13, v11
    v_dot2_f32_bf16 v12, v39, v39, v12
    s_nop 2
    v_permlane32_swap_b32 v11, v12
    v_add_f32 v11, v11, v12
    s_cmp_lg_u32 s48, 0
    s_cbranch_scc1 Lslow_76
    buffer_store_dword v11, v1, s[36:39], s56 offen
Lback_77:
    s_waitcnt vmcnt(0)
    s_mov_b64 exec, 1
    s_cmp_lg_u32 s48, 0
    s_cbranch_scc1 Lslow_78
    buffer_store_dword v4, off, s[36:39], s77 offset:512
Lback_79:
    s_mov_b64 exec, -1
    s_mov_b32 s55, 885248
    s_lshl_b32 s56, s46, 11
    v_mov_b32 v76, v7
    v_mov_b32 v77, v8
    v_mov_b32 v78, 0
    v_mov_b32 v79, 0
    v_mov_b32 v74, 0
    v_mov_b32 v75, 0
    v_lshlrev_b32 v3, 3, v0
    v_add_u32 v3, 143616, v3
    v_and_b32 v14, 31, v0
    v_lshlrev_b32 v14, 4, v14
    v_add_u32 v14, 144128, v14
    v_add_u32 v105, 57344, v1
    s_lshl_b32 s54, s46, 7
    s_add_u32 s54, s54, 162816
    v_lshrrev_b32 v104, 5, v0
    v_lshl_add_u32 v104, v104, 6, s54
    s_add_u32 s52, s74, 159744
    s_cmp_lg_u32 s46, 0
    s_cbranch_scc1 Lnp_80
    s_sleep 2
    buffer_load_dword v9, v10, s[36:39], s55 offen sc1
    s_waitcnt vmcnt(0)
    v_cmp_ne_u32 vcc, s47, v9
    s_cbranch_vccnz Lspin_81
Lgot_82:
Lnp_80:
    s_barrier
    s_add_u32 m0, s56, 0
    s_nop 0
    buffer_load_dwordx4 v1, s[36:39], s4 offen sc1 lds
    buffer_load_dwordx4 v1, s[36:39], s4 offen offset:1024 sc1 lds
    s_add_u32 m0, s56, 8192
    s_nop 0
    buffer_load_dwordx4 v1, s[36:39], s5 offen sc1 lds
    buffer_load_dwordx4 v1, s[36:39], s5 offen offset:1024 sc1 lds
    buffer_load_dwordx4 v[108:111], v1, s[36:39], s52 offen offset:0 sc1
    buffer_load_dwordx4 v[112:115], v1, s[36:39], s52 offen offset:1024 sc1
    buffer_load_dwordx4 v[116:119], v1, s[36:39], s52 offen offset:2048 sc1
    buffer_load_dwordx4 v[120:123], v1, s[36:39], s52 offen offset:3072 sc1
    s_waitcnt vmcnt(6)
    s_barrier
    ds_read_b128 v[48:51], v1 offset:0
    ds_read_b128 v[52:55], v1 offset:1024
    ds_read_b128 v[56:59], v1 offset:2048
    ds_read_b128 v[60:63], v1 offset:3072
    ds_read_b128 v[64:67], v1 offset:4096
    ds_read_b128 v[68:71], v1 offset:5120
    s_waitcnt lgkmcnt(4)
    v_mfma_f32_32x32x16_bf16 v[16:31], a[224:227], v[48:51], 0
    s_add_u32 m0, s56, 16384
    s_nop 0
    buffer_load_dwordx4 v1, s[36:39], s6 offen sc1 lds
    buffer_load_dwordx4 v1, s[36:39], s6 offen offset:1024 sc1 lds
    v_mfma_f32_32x32x16_bf16 v[16:31], a[228:231], v[52:55], v[16:31]
    ds_read_b128 v[48:51], v1 offset:6144
    ds_read_b128 v[52:55], v1 offset:7168
    s_waitcnt lgkmcnt(4)
    v_mfma_f32_32x32x16_bf16 v[16:31], a[232:235], v[56:59], v[16:31]
    v_mfma_f32_32x32x16_bf16 v[16:31], a[236:239], v[60:63], v[16:31]
    s_waitcnt vmcnt(6)
    s_barrier
    ds_read_b128 v[56:59], v1 offset:8192
    ds_read_b128 v[60:63], v1 offset:9216
    s_waitcnt lgkmcnt(4)
    v_mfma_f32_32x32x16_bf16 v[16:31], a[240:243], v[64:67], v[16:31]
    v_mfma_f32_32x32x16_bf16 v[16:31], a[244:247], v[68:71], v[16:31]
    ds_read_b128 v[64:67], v1 offset:10240
    ds_read_b128 v[68:71], v1 offset:11264
    s_waitcnt lgkmcnt(4)
    v_mfma_f32_32x32x16_bf16 v[16:31], a[248:251], v[48:51], v[16:31]
    s_add_u32 m0, s56, 24576
    s_nop 0
    buffer_load_dwordx4 v1, s[36:39], s7 offen sc1 lds
    buffer_load_dwordx4 v1, s[36:39], s7 offen offset:1024 sc1 lds
    v_mfma_f32_32x32x16_bf16 v[16:31], a[252:255], v[52:55], v[16:31]
    ds_read_b128 v[48:51], v1 offset:12288
    ds_read_b128 v[52:55], v1 offset:13312
    s_waitcnt lgkmcnt(4)
    v_mfma_f32_32x32x16_bf16 v[16:31], v[176:179], v[56:59], v[16:31]
    v_mfma_f32_32x32x16_bf16 v[16:31], v[180:183], v[60:63], v[16:31]
    ds_read_b128 v[56:59], v1 offset:14336
    ds_read_b128 v[60:63], v1 offset:15360
    s_waitcnt lgkmcnt(4)
    v_mfma_f32_32x32x16_bf16 v[16:31], v[184:187], v[64:67], v[16:31]
    s_add_u32 m0, s56, 32768
    s_nop 0
    buffer_load_dwordx4 v1, s[36:39], s8 offen sc1 lds
    buffer_load_dwordx4 v1, s[36:39], s8 offen offset:1024 sc1 lds
    s_waitcnt vmcnt(9)
    v_add_f32 v108, v108, v109
    v_add_f32 v110, v110, v111
    s_waitcnt vmcnt(8)
    v_add_f32 v112, v112, v113
    v_add_f32 v114, v114, v115
    v_mfma_f32_32x32x16_bf16 v[16:31], v[188:191], v[68:71], v[16:31]
    s_waitcnt vmcnt(4)
    s_barrier
    ds_read_b128 v[64:67], v1 offset:16384
    ds_read_b128 v[68:71], v1 offset:17408
    v_add_f32 v116, v116, v117
    v_add_f32 v118, v118, v119
    v_add_f32 v120, v120, v121
    v_add_f32 v108, v108, v110
    s_waitcnt lgkmcnt(4)
    v_mfma_f32_32x32x16_bf16 v[16:31], v[192:195], v[48:51], v[16:31]
    v_add_f32 v112, v112, v114
    v_add_f32 v116, v116, v118
    v_add_f32 v108, v108, v112
    v_add_f32 v116, v116, v120
    v_mfma_f32_32x32x16_bf16 v[16:31], v[196:199], v[52:55], v[16:31]
    ds_read_b128 v[48:51], v1 offset:18432
    ds_read_b128 v[52:55], v1 offset:19456
    v_add_f32 v80, v108, v116
    v_mov_b32 v12, v80
    v_mov_b32 v5, v80
    s_nop 1
    v_permlane32_swap_b32 v5, v12
    s_waitcnt lgkmcnt(4)
    v_mfma_f32_32x32x16_bf16 v[16:31], v[200:203], v[56:59], v[16:31]
    s_add_u32 m0, s56, 40960
    s_nop 0
    buffer_load_dwordx4 v1, s[36:39], s9 offen sc1 lds
    buffer_load_dwordx4 v1, s[36:39], s9 offen offset:1024 sc1 lds
    v_mul_f32 v5, 0x3b124925, v5
    v_mul_f32 v12, 0x3b124925, v12
    v_fma_f32 v12, -v5, v5, v12
    v_max_f32 v12, 0, v12
    v_mfma_f32_32x32x16_bf16 v[16:31], v[204:207], v[60:63], v[16:31]
    ds_read_b128 v[56:59], v1 offset:20480
    ds_read_b128 v[60:63], v1 offset:21504
    v_add_f32 v13, 0x3727c5ac, v12
    v_rsq_f32 v6, v13
    s_nop 0
    v_mul_f32 v13, v6, v6
    s_waitcnt lgkmcnt(4)
    v_mfma_f32_32x32x16_bf16 v[16:31], v[208:211], v[64:67], v[16:31]
    v_fmaak_f32 v12, v12, v13, 0x3727c5ac
    v_rsq_f32 v12, v12
    v_mfma_f32_32x32x16_bf16 v[16:31], v[212:215], v[68:71], v[16:31]
    ds_read_b128 v[64:67], v1 offset:22528
    ds_read_b128 v[68:71], v1 offset:23552
    v_mul_f32 v6, v6, v12
    v_rcp_f32 v102, v6
    v_mul_f32 v100, s70, v6
    s_waitcnt lgkmcnt(4)
    v_mfma_f32_32x32x16_bf16 v[16:31], v[216:219], v[48:51], v[16:31]
    s_add_u32 m0, s56, 49152
    s_nop 0
    buffer_load_dwordx4 v1, s[36:39], s10 offen sc1 lds
    buffer_load_dwordx4 v1, s[36:39], s10 offen offset:1024 sc1 lds
    v_mul_f32 v80, v6, v6
    v_mul_f32 v101, s71, v6
    v_mul_f32 v101, v101, v80
    v_sub_f32 v5, 0, v5
    v_mfma_f32_32x32x16_bf16 v[16:31], v[220:223], v[52:55], v[16:31]
    s_waitcnt vmcnt(6)
    s_barrier
    ds_read_b128 v[48:51], v1 offset:24576
    ds_read_b128 v[52:55], v1 offset:25600
    v_cndmask_b32 v5, v5, v102, s[62:63]
    v_cvt_pk_bf16_f32 v83, v5, v5
    v_and_b32 v80, 0xffff0000, v83
    v_sub_f32 v80, v5, v80
    s_waitcnt lgkmcnt(4)
    v_mfma_f32_32x32x16_bf16 v[16:31], v[224:227], v[56:59], v[16:31]
    v_cvt_pk_bf16_f32 v82, v5, v80
    v_and_b32 v83, 0xffff, v83
    v_cndmask_b32 v83, v83, 0, s[62:63]
    s_lshl_b32 s55, s46, 10
    v_mfma_f32_32x32x16_bf16 v[16:31], v[228:231], v[60:63], v[16:31]
    ds_read_b128 v[56:59], v1 offset:26624
    ds_read_b128 v[60:63], v1 offset:27648
    v_add_u32 v11, s55, v3
    v_add_u32 v12, s55, v14
    ds_write_b64 v11, v[82:83]
    s_waitcnt lgkmcnt(5)
    v_mfma_f32_32x32x16_bf16 v[16:31], v[232:235], v[64:67], v[16:31]
    s_add_u32 m0, s56, 57344
    s_nop 0
    buffer_load_dwordx4 v1, s[36:39], s11 offen sc1 lds
    buffer_load_dwordx4 v1, s[36:39], s11 offen offset:1024 sc1 lds
    ds_write_b128 v12, v[100:103]
    v_mfma_f32_32x32x16_bf16 v[16:31], v[236:239], v[68:71], v[16:31]
    ds_read_b128 v[64:67], v1 offset:28672
    ds_read_b128 v[68:71], v1 offset:29696
    s_waitcnt lgkmcnt(6)
    v_mfma_f32_32x32x16_bf16 v[16:31], v[240:243], v[48:51], v[16:31]
    v_mfma_f32_32x32x16_bf16 v[16:31], v[244:247], v[52:55], v[16:31]
    ds_read_b128 v[48:51], v1 offset:30720
    ds_read_b128 v[52:55], v1 offset:31744
    s_waitcnt lgkmcnt(6)
    v_mfma_f32_32x32x16_bf16 v[16:31], v[248:251], v[56:59], v[16:31]
    s_add_u32 m0, s56, 65536
    s_nop 0
    buffer_load_dwordx4 v1, s[36:39], s12 offen sc1 lds
    buffer_load_dwordx4 v1, s[36:39], s12 offen offset:1024 sc1 lds
    v_mfma_f32_32x32x16_bf16 v[16:31], v[252:255], v[60:63], v[16:31]
    s_waitcnt vmcnt(6) lgkmcnt(4)
    s_barrier
    ds_read_b128 v[56:59], v1 offset:32768
    ds_read_b128 v[60:63], v1 offset:33792
    ds_read_b64 v[72:73], v3 offset:0
    ds_read_b128 v[96:99], v14 offset:0
    s_waitcnt lgkmcnt(6)
    v_mfma_f32_32x32x16_bf16 v[32:47], a[224:227], v[64:67], 0
    v_mfma_f32_32x32x16_bf16 v[32:47], a[228:231], v[68:71], v[32:47]
    ds_read_b128 v[64:67], v1 offset:34816
    ds_read_b128 v[68:71], v1 offset:35840
    s_waitcnt lgkmcnt(6)
    v_mfma_f32_32x32x16_bf16 v[32:47], a[232:235], v[48:51], v[32:47]
    s_waitcnt lgkmcnt(3)
    v_mfma_f32_32x32x16_bf16 v[16:31], v[76:79], v[72:75], v[16:31]
    s_add_u32 m0, s56, 73728
    s_nop 0
    buffer_load_dwordx4 v1, s[36:39], s13 offen sc1 lds
    buffer_load_dwordx4 v1, s[36:39], s13 offen offset:1024 sc1 lds
    v_mfma_f32_32x32x16_bf16 v[32:47], a[236:239], v[52:55], v[32:47]
    ds_read_b128 v[48:51], v1 offset:36864
    ds_read_b128 v[52:55], v1 offset:37888
    v_mfma_f32_32x32x16_bf16 v[32:47], a[240:243], v[56:59], v[32:47]
    v_mfma_f32_32x32x16_bf16 v[32:47], a[244:247], v[60:63], v[32:47]
    ds_read_b128 v[56:59], v1 offset:38912
    ds_read_b128 v[60:63], v1 offset:39936
    s_nop 0
    v_pk_mul_f32 v[80:81], v[16:17], v[16:17]
    v_pk_mul_f32 v[82:83], v[18:19], v[18:19]
    v_pk_mul_f32 v[84:85], v[20:21], v[20:21]
    v_pk_mul_f32 v[86:87], v[22:23], v[22:23]
    v_pk_mul_f32 v[88:89], v[24:25], v[24:25]
    v_pk_mul_f32 v[90:91], v[26:27], v[26:27]
    v_pk_mul_f32 v[92:93], v[28:29], v[28:29]
    v_pk_mul_f32 v[94:95], v[30:31], v[30:31]
    s_waitcnt lgkmcnt(6)
    v_pk_fma_f32 v[80:81], v[80:81], v[96:97], v[96:97] op_sel:[0,1,0] op_sel_hi:[1,1,0]
    v_pk_fma_f32 v[82:83], v[82:83], v[96:97], v[96:97] op_sel:[0,1,0] op_sel_hi:[1,1,0]
    v_pk_fma_f32 v[84:85], v[84:85], v[96:97], v[96:97] op_sel:[0,1,0] op_sel_hi:[1,1,0]
    v_pk_fma_f32 v[86:87], v[86:87], v[96:97], v[96:97] op_sel:[0,1,0] op_sel_hi:[1,1,0]
    v_pk_fma_f32 v[88:89], v[88:89], v[96:97], v[96:97] op_sel:[0,1,0] op_sel_hi:[1,1,0]
    v_pk_fma_f32 v[90:91], v[90:91], v[96:97], v[96:97] op_sel:[0,1,0] op_sel_hi:[1,1,0]
    v_pk_fma_f32 v[92:93], v[92:93], v[96:97], v[96:97] op_sel:[0,1,0] op_sel_hi:[1,1,0]
    v_pk_fma_f32 v[94:95], v[94:95], v[96:97], v[96:97] op_sel:[0,1,0] op_sel_hi:[1,1,0]
    v_pk_mul_f32 v[80:81], v[80:81], v[16:17]
    v_pk_mul_f32 v[82:83], v[82:83], v[18:19]
    v_pk_mul_f32 v[84:85], v[84:85], v[20:21]
    v_pk_mul_f32 v[86:87], v[86:87], v[22:23]
    v_pk_mul_f32 v[88:89], v[88:89], v[24:25]
    v_pk_mul_f32 v[90:91], v[90:91], v[26:27]
    v_pk_mul_f32 v[92:93], v[92:93], v[28:29]
    v_pk_mul_f32 v[94:95], v[94:95], v[30:31]
    s_waitcnt lgkmcnt(4)
    v_mfma_f32_32x32x16_bf16 v[32:47], a[248:251], v[64:67], v[32:47]
    s_add_u32 m0, s56, 81920
    s_nop 0
    buffer_load_dwordx4 v1, s[36:39], s14 offen sc1 lds
    buffer_load_dwordx4 v1, s[36:39], s14 offen offset:1024 sc1 lds
    v_exp_f32 v80, v80
    v_exp_f32 v81, v81
    v_exp_f32 v82, v82
    v_mfma_f32_32x32x16_bf16 v[32:47], a[252:255], v[68:71], v[32:47]
    ds_read_b128 v[64:67], v1 offset:40960
    ds_read_b128 v[68:71], v1 offset:41984
    v_exp_f32 v83, v83
    v_exp_f32 v84, v84
    s_waitcnt lgkmcnt(4)
    v_mfma_f32_32x32x16_bf16 v[32:47], v[176:179], v[48:51], v[32:47]
    v_exp_f32 v85, v85
    v_exp_f32 v86, v86
    v_exp_f32 v87, v87
    v_mfma_f32_32x32x16_bf16 v[32:47], v[180:183], v[52:55], v[32:47]
    ds_read_b128 v[48:51], v1 offset:43008
    ds_read_b128 v[52:55], v1 offset:44032
    v_fma_f32 v80, v80, v98, v98
    v_fma_f32 v81, v81, v98, v98
    v_fma_f32 v82, v82, v98, v98
    v_fma_f32 v83, v83, v98, v98
    s_waitcnt lgkmcnt(4)
    v_mfma_f32_32x32x16_bf16 v[32:47], v[184:187], v[56:59], v[32:47]
    s_add_u32 m0, s56, 90112
    s_nop 0
    buffer_load_dwordx4 v1, s[36:39], s15 offen sc1 lds
    buffer_load_dwordx4 v1, s[36:39], s15 offen offset:1024 sc1 lds
    v_rcp_f32 v80, v80
    v_rcp_f32 v81, v81
    v_rcp_f32 v82, v82
    v_mfma_f32_32x32x16_bf16 v[32:47], v[188:191], v[60:63], v[32:47]
    ds_read_b128 v[56:59], v1 offset:45056
    ds_read_b128 v[60:63], v1 offset:46080
    v_rcp_f32 v83, v83
    v_exp_f32 v88, v88
    v_exp_f32 v89, v89
    s_waitcnt lgkmcnt(4)
    v_mfma_f32_32x32x16_bf16 v[32:47], v[192:195], v[64:67], v[32:47]
    v_exp_f32 v90, v90
    v_exp_f32 v91, v91
    v_mfma_f32_32x32x16_bf16 v[32:47], v[196:199], v[68:71], v[32:47]
    ds_read_b128 v[64:67], v1 offset:47104
    ds_read_b128 v[68:71], v1 offset:48128
    v_fma_f32 v84, v84, v98, v98
    v_fma_f32 v85, v85, v98, v98
    v_fma_f32 v86, v86, v98, v98
    v_fma_f32 v87, v87, v98, v98
    v_mul_f32 v16, v16, v80
    v_mul_f32 v17, v17, v81
    s_waitcnt lgkmcnt(4)
    v_mfma_f32_32x32x16_bf16 v[32:47], v[200:203], v[48:51], v[32:47]
    s_add_u32 m0, s56, 98304
    s_nop 0
    buffer_load_dwordx4 v1, s[36:39], s20 offen sc1 lds
    buffer_load_dwordx4 v1, s[36:39], s20 offen offset:1024 sc1 lds
    v_mul_f32 v18, v18, v82
    v_mul_f32 v19, v19, v83
    v_cvt_pk_bf16_f32 v16, v16, v17
    v_cvt_pk_bf16_f32 v17, v18, v19
    v_mfma_f32_32x32x16_bf16 v[32:47], v[204:207], v[52:55], v[32:47]
    s_waitcnt vmcnt(6)
    s_barrier
    ds_read_b128 v[48:51], v1 offset:49152
    ds_read_b128 v[52:55], v1 offset:50176
    v_rcp_f32 v84, v84
    v_rcp_f32 v85, v85
    v_rcp_f32 v86, v86
    s_waitcnt lgkmcnt(4)
    v_mfma_f32_32x32x16_bf16 v[32:47], v[208:211], v[56:59], v[32:47]
    v_rcp_f32 v87, v87
    v_exp_f32 v92, v92
    v_exp_f32 v93, v93
    v_mfma_f32_32x32x16_bf16 v[32:47], v[212:215], v[60:63], v[32:47]
    ds_read_b128 v[56:59], v1 offset:51200
    ds_read_b128 v[60:63], v1 offset:52224
    v_exp_f32 v94, v94
    v_exp_f32 v95, v95
    s_waitcnt lgkmcnt(4)
    v_mfma_f32_32x32x16_bf16 v[32:47], v[216:219], v[64:67], v[32:47]
    s_add_u32 m0, s56, 106496
    s_nop 0
    buffer_load_dwordx4 v1, s[36:39], s21 offen sc1 lds
    buffer_load_dwordx4 v1, s[36:39], s21 offen offset:1024 sc1 lds
    v_fma_f32 v88, v88, v98, v98
    v_fma_f32 v89, v89, v98, v98
    v_fma_f32 v90, v90, v98, v98
    v_fma_f32 v91, v91, v98, v98
    v_mul_f32 v20, v20, v84
    v_mfma_f32_32x32x16_bf16 v[32:47], v[220:223], v[68:71], v[32:47]
    ds_read_b128 v[64:67], v1 offset:53248
    ds_read_b128 v[68:71], v1 offset:54272
    v_mul_f32 v21, v21, v85
    v_mul_f32 v22, v22, v86
    v_mul_f32 v23, v23, v87
    v_cvt_pk_bf16_f32 v18, v20, v21
    v_cvt_pk_bf16_f32 v19, v22, v23
    s_waitcnt lgkmcnt(4)
    v_mfma_f32_32x32x16_bf16 v[32:47], v[224:227], v[48:51], v[32:47]
    v_rcp_f32 v88, v88
    v_rcp_f32 v89, v89
    v_rcp_f32 v90, v90
    v_mfma_f32_32x32x16_bf16 v[32:47], v[228:231], v[52:55], v[32:47]
    ds_read_b128 v[48:51], v1 offset:55296
    ds_read_b128 v[52:55], v1 offset:56320
    v_rcp_f32 v91, v91
    v_fma_f32 v92, v92, v98, v98
    v_fma_f32 v93, v93, v98, v98
    v_fma_f32 v94, v94, v98, v98
    s_waitcnt lgkmcnt(4)
    v_mfma_f32_32x32x16_bf16 v[32:47], v[232:235], v[56:59], v[32:47]
    v_fma_f32 v95, v95, v98, v98
    v_mul_f32 v24, v24, v88
    v_mul_f32 v25, v25, v89
    v_mul_f32 v26, v26, v90
    v_mul_f32 v27, v27, v91
    v_mfma_f32_32x32x16_bf16 v[32:47], v[236:239], v[60:63], v[32:47]
    ds_read_b128 v[56:59], v105 offset:0
    ds_read_b128 v[60:63], v105 offset:1024
    v_cvt_pk_bf16_f32 v20, v24, v25
    v_cvt_pk_bf16_f32 v21, v26, v27
    v_rcp_f32 v92, v92
    v_rcp_f32 v93, v93
    s_waitcnt lgkmcnt(4)
    v_mfma_f32_32x32x16_bf16 v[32:47], v[240:243], v[64:67], v[32:47]
    v_rcp_f32 v94, v94
    v_rcp_f32 v95, v95
    v_mul_f32 v28, v28, v92
    v_mfma_f32_32x32x16_bf16 v[32:47], v[244:247], v[68:71], v[32:47]
    ds_read_b128 v[64:67], v105 offset:2048
    ds_read_b128 v[68:71], v105 offset:3072
    ds_read_b64 v[72:73], v3 offset:1024
    ds_read_b128 v[100:103], v14 offset:1024
    v_mul_f32 v29, v29, v93
    v_mul_f32 v30, v30, v94
    v_mul_f32 v31, v31, v95
    v_cvt_pk_bf16_f32 v22, v28, v29
    v_cvt_pk_bf16_f32 v23, v30, v31
    s_waitcnt lgkmcnt(6)
    v_mfma_f32_32x32x16_bf16 v[32:47], v[248:251], v[48:51], v[32:47]
    s_add_u32 s55, s84, 0
    s_cmp_lg_u32 s48, 0
    s_cbranch_scc1 Lslow_83
    buffer_store_dwordx4 v[16:19], v1, s[36:39], s55 offen offset:0 nt
    buffer_store_dwordx4 v[20:23], v1, s[36:39], s55 offen offset:1024 nt
Lback_84:
    v_mfma_f32_32x32x16_bf16 v[32:47], v[252:255], v[52:55], v[32:47]
    ds_read_b128 v[48:51], v105 offset:4096
    ds_read_b128 v[52:55], v105 offset:5120
    s_waitcnt lgkmcnt(3)
    v_mfma_f32_32x32x16_bf16 v[32:47], v[76:79], v[72:75], v[32:47]
    v_mfma_f32_32x32x16_bf16 v[16:31], a[224:227], v[56:59], 0
    v_mfma_f32_32x32x16_bf16 v[16:31], a[228:231], v[60:63], v[16:31]
    ds_read_b128 v[56:59], v105 offset:6144
    ds_read_b128 v[60:63], v105 offset:7168
    v_mfma_f32_32x32x16_bf16 v[16:31], a[232:235], v[64:67], v[16:31]
    s_nop 6
    v_pk_mul_f32 v[80:81], v[32:33], v[32:33]
    v_pk_mul_f32 v[82:83], v[34:35], v[34:35]
    v_pk_mul_f32 v[84:85], v[36:37], v[36:37]
    v_pk_mul_f32 v[86:87], v[38:39], v[38:39]
    v_pk_mul_f32 v[88:89], v[40:41], v[40:41]
    v_pk_mul_f32 v[90:91], v[42:43], v[42:43]
    v_pk_mul_f32 v[92:93], v[44:45], v[44:45]
    v_pk_mul_f32 v[94:95], v[46:47], v[46:47]
    s_waitcnt lgkmcnt(4)
    v_pk_fma_f32 v[80:81], v[80:81], v[100:101], v[100:101] op_sel:[0,1,0] op_sel_hi:[1,1,0]
    v_pk_fma_f32 v[82:83], v[82:83], v[100:101], v[100:101] op_sel:[0,1,0] op_sel_hi:[1,1,0]
    v_pk_fma_f32 v[84:85], v[84:85], v[100:101], v[100:101] op_sel:[0,1,0] op_sel_hi:[1,1,0]
    v_pk_fma_f32 v[86:87], v[86:87], v[100:101], v[100:101] op_sel:[0,1,0] op_sel_hi:[1,1,0]
    v_pk_fma_f32 v[88:89], v[88:89], v[100:101], v[100:101] op_sel:[0,1,0] op_sel_hi:[1,1,0]
    v_pk_fma_f32 v[90:91], v[90:91], v[100:101], v[100:101] op_sel:[0,1,0] op_sel_hi:[1,1,0]
    v_pk_fma_f32 v[92:93], v[92:93], v[100:101], v[100:101] op_sel:[0,1,0] op_sel_hi:[1,1,0]
    v_pk_fma_f32 v[94:95], v[94:95], v[100:101], v[100:101] op_sel:[0,1,0] op_sel_hi:[1,1,0]
    v_pk_mul_f32 v[80:81], v[80:81], v[32:33]
    v_pk_mul_f32 v[82:83], v[82:83], v[34:35]
    v_pk_mul_f32 v[84:85], v[84:85], v[36:37]
    v_pk_mul_f32 v[86:87], v[86:87], v[38:39]
    v_pk_mul_f32 v[88:89], v[88:89], v[40:41]
    v_pk_mul_f32 v[90:91], v[90:91], v[42:43]
    v_pk_mul_f32 v[92:93], v[92:93], v[44:45]
    v_pk_mul_f32 v[94:95], v[94:95], v[46:47]
    v_mfma_f32_32x32x16_bf16 v[16:31], a[236:239], v[68:71], v[16:31]
    ds_read_b128 v[64:67], v105 offset:8192
    ds_read_b128 v[68:71], v105 offset:9216
    v_exp_f32 v80, v80
    v_exp_f32 v81, v81
    s_waitcnt lgkmcnt(4)
    v_mfma_f32_32x32x16_bf16 v[16:31], a[240:243], v[48:51], v[16:31]
    v_exp_f32 v82, v82
    v_exp_f32 v83, v83
    v_exp_f32 v84, v84
    v_mfma_f32_32x32x16_bf16 v[16:31], a[244:247], v[52:55], v[16:31]
    ds_read_b128 v[48:51], v105 offset:10240
    ds_read_b128 v[52:55], v105 offset:11264
    v_exp_f32 v85, v85
    v_exp_f32 v86, v86
    s_waitcnt lgkmcnt(4)
    v_mfma_f32_32x32x16_bf16 v[16:31], a[248:251], v[56:59], v[16:31]
    v_exp_f32 v87, v87
    v_fma_f32 v80, v80, v102, v102
    v_fma_f32 v81, v81, v102, v102
    v_mfma_f32_32x32x16_bf16 v[16:31], a[252:255], v[60:63], v[16:31]
    ds_read_b128 v[56:59], v105 offset:12288
    ds_read_b128 v[60:63], v105 offset:13312
    v_fma_f32 v82, v82, v102, v102
    v_fma_f32 v83, v83, v102, v102
    v_rcp_f32 v80, v80
    s_waitcnt lgkmcnt(4)
    v_mfma_f32_32x32x16_bf16 v[16:31], v[176:179], v[64:67], v[16:31]
    s_waitcnt vmcnt(0)
    s_mov_b64 exec, 1
    s_cmp_lg_u32 s48, 0
    s_cbranch_scc1 Lslow_87
    buffer_store_dword v4, off, s[36:39], s77 offset:1536
Lback_88:
    s_mov_b64 exec, -1
    v_rcp_f32 v81, v81
    v_rcp_f32 v82, v82
    v_rcp_f32 v83, v83
    v_mfma_f32_32x32x16_bf16 v[16:31], v[180:183], v[68:71], v[16:31]
    ds_read_b128 v[64:67], v105 offset:14336
    ds_read_b128 v[68:71], v105 offset:15360
    v_exp_f32 v88, v88
    v_exp_f32 v89, v89
    s_waitcnt lgkmcnt(4)
    v_mfma_f32_32x32x16_bf16 v[16:31], v[184:187], v[48:51], v[16:31]
    v_exp_f32 v90, v90
    v_exp_f32 v91, v91
    v_mfma_f32_32x32x16_bf16 v[16:31], v[188:191], v[52:55], v[16:31]
    ds_read_b128 v[48:51], v105 offset:16384
    ds_read_b128 v[52:55], v105 offset:17408
    v_fma_f32 v84, v84, v102, v102
    v_fma_f32 v85, v85, v102, v102
    v_fma_f32 v86, v86, v102, v102
    v_fma_f32 v87, v87, v102, v102
    v_mul_f32 v32, v32, v80
    s_waitcnt lgkmcnt(4)
    v_mfma_f32_32x32x16_bf16 v[16:31], v[192:195], v[56:59], v[16:31]
    v_mul_f32 v33, v33, v81
    v_mul_f32 v34, v34, v82
    v_mul_f32 v35, v35, v83
    v_cvt_pk_bf16_f32 v32, v32, v33
    v_mfma_f32_32x32x16_bf16 v[16:31], v[196:199], v[60:63], v[16:31]
    ds_read_b128 v[56:59], v105 offset:18432
    ds_read_b128 v[60:63], v105 offset:19456
    v_cvt_pk_bf16_f32 v33, v34, v35
    v_rcp_f32 v84, v84
    v_rcp_f32 v85, v85
    s_waitcnt lgkmcnt(4)
    v_mfma_f32_32x32x16_bf16 v[16:31], v[200:203], v[64:67], v[16:31]
    v_rcp_f32 v86, v86
    v_rcp_f32 v87, v87
    v_mfma_f32_32x32x16_bf16 v[16:31], v[204:207], v[68:71], v[16:31]
    ds_read_b128 v[64:67], v105 offset:20480
    ds_read_b128 v[68:71], v105 offset:21504
    v_exp_f32 v92, v92
    v_exp_f32 v93, v93
    v_exp_f32 v94, v94
    s_waitcnt lgkmcnt(4)
    v_mfma_f32_32x32x16_bf16 v[16:31], v[208:211], v[48:51], v[16:31]
    v_exp_f32 v95, v95
    v_fma_f32 v88, v88, v102, v102
    v_fma_f32 v89, v89, v102, v102
    v_mfma_f32_32x32x16_bf16 v[16:31], v[212:215], v[52:55], v[16:31]
    ds_read_b128 v[48:51], v105 offset:22528
    ds_read_b128 v[52:55], v105 offset:23552
    v_fma_f32 v90, v90, v102, v102
    v_fma_f32 v91, v91, v102, v102
    v_mul_f32 v36, v36, v84
    v_mul_f32 v37, v37, v85
    s_waitcnt lgkmcnt(4)
    v_mfma_f32_32x32x16_bf16 v[16:31], v[216:219], v[56:59], v[16:31]
    v_mul_f32 v38, v38, v86
    v_mul_f32 v39, v39, v87
    v_cvt_pk_bf16_f32 v34, v36, v37
    v_cvt_pk_bf16_f32 v35, v38, v39
    v_mfma_f32_32x32x16_bf16 v[16:31], v[220:223], v[60:63], v[16:31]
    s_barrier
    ds_read_b128 v[56:59], v105 offset:24576
    ds_read_b128 v[60:63], v105 offset:25600
    v_rcp_f32 v88, v88
    v_rcp_f32 v89, v89
    v_rcp_f32 v90, v90
    s_waitcnt lgkmcnt(4)
    v_mfma_f32_32x32x16_bf16 v[16:31], v[224:227], v[64:67], v[16:31]
    v_rcp_f32 v91, v91
    v_fma_f32 v92, v92, v102, v102
    v_fma_f32 v93, v93, v102, v102
    v_mfma_f32_32x32x16_bf16 v[16:31], v[228:231], v[68:71], v[16:31]
    ds_read_b128 v[64:67], v105 offset:26624
    ds_read_b128 v[68:71], v105 offset:27648
    v_fma_f32 v94, v94, v102, v102
    v_fma_f32 v95, v95, v102, v102
    v_mul_f32 v40, v40, v88
    v_mul_f32 v41, v41, v89
    s_waitcnt lgkmcnt(4)
    v_mfma_f32_32x32x16_bf16 v[16:31], v[232:235], v[48:51], v[16:31]
    v_mul_f32 v42, v42, v90
    v_mul_f32 v43, v43, v91
    v_cvt_pk_bf16_f32 v36, v40, v41
    v_cvt_pk_bf16_f32 v37, v42, v43
    v_mfma_f32_32x32x16_bf16 v[16:31], v[236:239], v[52:55], v[16:31]
    ds_read_b128 v[48:51], v105 offset:28672
    ds_read_b128 v[52:55], v105 offset:29696
    v_rcp_f32 v92, v92
    v_rcp_f32 v93, v93
    v_rcp_f32 v94, v94
    s_waitcnt lgkmcnt(4)
    v_mfma_f32_32x32x16_bf16 v[16:31], v[240:243], v[56:59], v[16:31]
    v_rcp_f32 v95, v95
    v_mul_f32 v44, v44, v92
    v_mul_f32 v45, v45, v93
    v_mfma_f32_32x32x16_bf16 v[16:31], v[244:247], v[60:63], v[16:31]
    ds_read_b128 v[56:59], v105 offset:30720
    ds_read_b128 v[60:63], v105 offset:31744
    ds_read_b64 v[72:73], v3 offset:2048
    ds_read_b128 v[96:99], v14 offset:2048
    v_mul_f32 v46, v46, v94
    v_mul_f32 v47, v47, v95
    v_cvt_pk_bf16_f32 v38, v44, v45
    v_cvt_pk_bf16_f32 v39, v46, v47
    s_waitcnt lgkmcnt(6)
    v_mfma_f32_32x32x16_bf16 v[16:31], v[248:251], v[64:67], v[16:31]
    s_add_u32 s55, s84, 114688
    s_cmp_lg_u32 s48, 0
    s_cbranch_scc1 Lslow_85
    buffer_store_dwordx4 v[32:35], v1, s[36:39], s55 offen offset:0 nt
    buffer_store_dwordx4 v[36:39], v1, s[36:39], s55 offen offset:1024 nt
Lback_86:
    v_mfma_f32_32x32x16_bf16 v[16:31], v[252:255], v[68:71], v[16:31]
    ds_read_b128 v[64:67], v105 offset:32768
    ds_read_b128 v[68:71], v105 offset:33792
    s_waitcnt lgkmcnt(3)
    v_mfma_f32_32x32x16_bf16 v[16:31], v[76:79], v[72:75], v[16:31]
    v_mfma_f32_32x32x16_bf16 v[32:47], a[224:227], v[48:51], 0
    v_mfma_f32_32x32x16_bf16 v[32:47], a[228:231], v[52:55], v[32:47]
    ds_read_b128 v[48:51], v105 offset:34816
    ds_read_b128 v[52:55], v105 offset:35840
    v_mfma_f32_32x32x16_bf16 v[32:47], a[232:235], v[56:59], v[32:47]
    s_nop 6
    v_pk_mul_f32 v[80:81], v[16:17], v[16:17]
    v_pk_mul_f32 v[82:83], v[18:19], v[18:19]
    v_pk_mul_f32 v[84:85], v[20:21], v[20:21]
    v_pk_mul_f32 v[86:87], v[22:23], v[22:23]
    v_pk_mul_f32 v[88:89], v[24:25], v[24:25]
    v_pk_mul_f32 v[90:91], v[26:27], v[26:27]
    v_pk_mul_f32 v[92:93], v[28:29], v[28:29]
    v_pk_mul_f32 v[94:95], v[30:31], v[30:31]
    s_waitcnt lgkmcnt(4)
    v_pk_fma_f32 v[80:81], v[80:81], v[96:97], v[96:97] op_sel:[0,1,0] op_sel_hi:[1,1,0]
    v_pk_fma_f32 v[82:83], v[82:83], v[96:97], v[96:97] op_sel:[0,1,0] op_sel_hi:[1,1,0]
    v_pk_fma_f32 v[84:85], v[84:85], v[96:97], v[96:97] op_sel:[0,1,0] op_sel_hi:[1,1,0]
    v_pk_fma_f32 v[86:87], v[86:87], v[96:97], v[96:97] op_sel:[0,1,0] op_sel_hi:[1,1,0]
    v_pk_fma_f32 v[88:89], v[88:89], v[96:97], v[96:97] op_sel:[0,1,0] op_sel_hi:[1,1,0]
    v_pk_fma_f32 v[90:91], v[90:91], v[96:97], v[96:97] op_sel:[0,1,0] op_sel_hi:[1,1,0]
    v_pk_fma_f32 v[92:93], v[92:93], v[96:97], v[96:97] op_sel:[0,1,0] op_sel_hi:[1,1,0]
    v_pk_fma_f32 v[94:95], v[94:95], v[96:97], v[96:97] op_sel:[0,1,0] op_sel_hi:[1,1,0]
    v_pk_mul_f32 v[80:81], v[80:81], v[16:17]
    v_pk_mul_f32 v[82:83], v[82:83], v[18:19]
    v_pk_mul_f32 v[84:85], v[84:85], v[20:21]
    v_pk_mul_f32 v[86:87], v[86:87], v[22:23]
    v_pk_mul_f32 v[88:89], v[88:89], v[24:25]
    v_pk_mul_f32 v[90:91], v[90:91], v[26:27]
    v_pk_mul_f32 v[92:93], v[92:93], v[28:29]
    v_pk_mul_f32 v[94:95], v[94:95], v[30:31]
    v_mfma_f32_32x32x16_bf16 v[32:47], a[236:239], v[60:63], v[32:47]
    ds_read_b128 v[56:59], v105 offset:36864
    ds_read_b128 v[60:63], v105 offset:37888
    v_exp_f32 v80, v80
    v_exp_f32 v81, v81
    s_waitcnt lgkmcnt(4)
    v_mfma_f32_32x32x16_bf16 v[32:47], a[240:243], v[64:67], v[32:47]
    v_exp_f32 v82, v82
    v_exp_f32 v83, v83
    v_exp_f32 v84, v84
    v_mfma_f32_32x32x16_bf16 v[32:47], a[244:247], v[68:71], v[32:47]
    ds_read_b128 v[64:67], v105 offset:38912
    ds_read_b128 v[68:71], v105 offset:39936
    v_exp_f32 v85, v85
    v_exp_f32 v86, v86
    s_waitcnt lgkmcnt(4)
    v_mfma_f32_32x32x16_bf16 v[32:47], a[248:251], v[48:51], v[32:47]
    v_exp_f32 v87, v87
    v_fma_f32 v80, v80, v98, v98
    v_fma_f32 v81, v81, v98, v98
    v_mfma_f32_32x32x16_bf16 v[32:47], a[252:255], v[52:55], v[32:47]
    ds_read_b128 v[48:51], v105 offset:40960
    ds_read_b128 v[52:55], v105 offset:41984
    v_fma_f32 v82, v82, v98, v98
    v_fma_f32 v83, v83, v98, v98
    v_rcp_f32 v80, v80
    s_waitcnt lgkmcnt(4)
    v_mfma_f32_32x32x16_bf16 v[32:47], v[176:179], v[56:59], v[32:47]
    s_waitcnt vmcnt(0)
    s_mov_b64 exec, 1
    s_cmp_lg_u32 s48, 0
    s_cbranch_scc1 Lslow_91
    buffer_store_dword v4, off, s[36:39], s77 offset:2048
Lback_92:
    s_mov_b64 exec, -1
    v_rcp_f32 v81, v81
    v_rcp_f32 v82, v82
    v_rcp_f32 v83, v83
    v_mfma_f32_32x32x16_bf16 v[32:47], v[180:183], v[60:63], v[32:47]
    ds_read_b128 v[56:59], v105 offset:43008
    ds_read_b128 v[60:63], v105 offset:44032
    v_exp_f32 v88, v88
    v_exp_f32 v89, v89
    s_waitcnt lgkmcnt(4)
    v_mfma_f32_32x32x16_bf16 v[32:47], v[184:187], v[64:67], v[32:47]
    v_exp_f32 v90, v90
    v_exp_f32 v91, v91
    v_mfma_f32_32x32x16_bf16 v[32:47], v[188:191], v[68:71], v[32:47]
    ds_read_b128 v[64:67], v105 offset:45056
    ds_read_b128 v[68:71], v105 offset:46080
    v_fma_f32 v84, v84, v98, v98
    v_fma_f32 v85, v85, v98, v98
    v_fma_f32 v86, v86, v98, v98
    v_fma_f32 v87, v87, v98, v98
    v_mul_f32 v16, v16, v80
    s_waitcnt lgkmcnt(4)
    v_mfma_f32_32x32x16_bf16 v[32:47], v[192:195], v[48:51], v[32:47]
    v_mul_f32 v17, v17, v81
    v_mul_f32 v18, v18, v82
    v_mul_f32 v19, v19, v83
    v_cvt_pk_bf16_f32 v16, v16, v17
    v_mfma_f32_32x32x16_bf16 v[32:47], v[196:199], v[52:55], v[32:47]
    ds_read_b128 v[48:51], v105 offset:47104
    ds_read_b128 v[52:55], v105 offset:48128
    v_cvt_pk_bf16_f32 v17, v18, v19
    v_rcp_f32 v84, v84
    v_rcp_f32 v85, v85
    s_waitcnt lgkmcnt(4)
    v_mfma_f32_32x32x16_bf16 v[32:47], v[200:203], v[56:59], v[32:47]
    v_rcp_f32 v86, v86
    v_rcp_f32 v87, v87
    v_mfma_f32_32x32x16_bf16 v[32:47], v[204:207], v[60:63], v[32:47]
    ds_read_b128 v[56:59], v105 offset:49152
    ds_read_b128 v[60:63], v105 offset:50176
    v_exp_f32 v92, v92
    v_exp_f32 v93, v93
    v_exp_f32 v94, v94
    s_waitcnt lgkmcnt(4)
    v_mfma_f32_32x32x16_bf16 v[32:47], v[208:211], v[64:67], v[32:47]
    v_and_b32 v10, 15, v0
    v_min_u32 v10, 13, v10
    v_lshlrev_b32 v10, 2, v10
    buffer_load_dword v9, v10, s[36:39], s82 offen sc1
    v_exp_f32 v95, v95
    v_fma_f32 v88, v88, v98, v98
    v_fma_f32 v89, v89, v98, v98
    v_mfma_f32_32x32x16_bf16 v[32:47], v[212:215], v[68:71], v[32:47]
    ds_read_b128 v[64:67], v105 offset:51200
    ds_read_b128 v[68:71], v105 offset:52224
    v_fma_f32 v90, v90, v98, v98
    v_fma_f32 v91, v91, v98, v98
    v_mul_f32 v20, v20, v84
    v_mul_f32 v21, v21, v85
    s_waitcnt lgkmcnt(4)
    v_mfma_f32_32x32x16_bf16 v[32:47], v[216:219], v[48:51], v[32:47]
    v_mul_f32 v22, v22, v86
    v_mul_f32 v23, v23, v87
    v_cvt_pk_bf16_f32 v18, v20, v21
    v_cvt_pk_bf16_f32 v19, v22, v23
    v_mfma_f32_32x32x16_bf16 v[32:47], v[220:223], v[52:55], v[32:47]
    ds_read_b128 v[48:51], v105 offset:53248
    ds_read_b128 v[52:55], v105 offset:54272
    v_rcp_f32 v88, v88
    v_rcp_f32 v89, v89
    v_rcp_f32 v90, v90
    s_waitcnt lgkmcnt(4)
    v_mfma_f32_32x32x16_bf16 v[32:47], v[224:227], v[56:59], v[32:47]
    v_rcp_f32 v91, v91
    v_fma_f32 v92, v92, v98, v98
    v_fma_f32 v93, v93, v98, v98
    v_mfma_f32_32x32x16_bf16 v[32:47], v[228:231], v[60:63], v[32:47]
    ds_read_b128 v[56:59], v105 offset:55296
    ds_read_b128 v[60:63], v105 offset:56320
    v_fma_f32 v94, v94, v98, v98
    v_fma_f32 v95, v95, v98, v98
    v_mul_f32 v24, v24, v88
    v_mul_f32 v25, v25, v89
    s_waitcnt lgkmcnt(4)
    v_mfma_f32_32x32x16_bf16 v[32:47], v[232:235], v[64:67], v[32:47]
    v_mul_f32 v26, v26, v90
    v_mul_f32 v27, v27, v91
    v_cvt_pk_bf16_f32 v20, v24, v25
    v_cvt_pk_bf16_f32 v21, v26, v27
    v_mfma_f32_32x32x16_bf16 v[32:47], v[236:239], v[68:71], v[32:47]
    v_rcp_f32 v92, v92
    v_rcp_f32 v93, v93
    v_rcp_f32 v94, v94
    s_waitcnt lgkmcnt(2)
    v_mfma_f32_32x32x16_bf16 v[32:47], v[240:243], v[48:51], v[32:47]
    s_waitcnt vmcnt(0)
    v_cmp_ne_u32 vcc, s47, v9
    s_cbranch_vccnz Lspin_93
Lgot_94:
    s_add_u32 s72, s80, 0
    buffer_load_dwordx4 v[108:111], v1, s[36:39], s72 offen offset:0 sc1
    v_rcp_f32 v95, v95
    v_mul_f32 v28, v28, v92
    v_mul_f32 v29, v29, v93
    v_mfma_f32_32x32x16_bf16 v[32:47], v[244:247], v[52:55], v[32:47]
    ds_read_b64 v[72:73], v3 offset:3072
    ds_read_b128 v[100:103], v14 offset:3072
    buffer_load_dwordx4 v[112:115], v1, s[36:39], s72 offen offset:1024 sc1
    v_mul_f32 v30, v30, v94
    v_mul_f32 v31, v31, v95
    v_cvt_pk_bf16_f32 v22, v28, v29
    v_cvt_pk_bf16_f32 v23, v30, v31
    s_waitcnt lgkmcnt(2)
    v_mfma_f32_32x32x16_bf16 v[32:47], v[248:251], v[56:59], v[32:47]
    s_add_u32 s72, s80, 8192
    buffer_load_dwordx4 v[116:119], v1, s[36:39], s72 offen offset:0 sc1
    s_add_u32 s55, s84, 229376
    s_cmp_lg_u32 s48, 0
    s_cbranch_scc1 Lslow_89
    buffer_store_dwordx4 v[16:19], v1, s[36:39], s55 offen offset:0 nt
    buffer_store_dwordx4 v[20:23], v1, s[36:39], s55 offen offset:1024 nt
Lback_90:
    v_mfma_f32_32x32x16_bf16 v[32:47], v[252:255], v[60:63], v[32:47]
    s_waitcnt lgkmcnt(1)
    v_mfma_f32_32x32x16_bf16 v[32:47], v[76:79], v[72:75], v[32:47]
    buffer_load_dwordx4 v[120:123], v1, s[36:39], s72 offen offset:1024 sc1
    s_waitcnt lgkmcnt(0)
    s_barrier
    buffer_load_dwordx4 v[96:99], v1, s[36:39], s34 offen sc1
    s_nop 7
    v_pk_mul_f32 v[80:81], v[32:33], v[32:33]
    v_pk_mul_f32 v[82:83], v[34:35], v[34:35]
    v_pk_mul_f32 v[84:85], v[36:37], v[36:37]
    v_pk_mul_f32 v[86:87], v[38:39], v[38:39]
    v_pk_mul_f32 v[88:89], v[40:41], v[40:41]
    v_pk_mul_f32 v[90:91], v[42:43], v[42:43]
    v_pk_mul_f32 v[92:93], v[44:45], v[44:45]
    v_pk_mul_f32 v[94:95], v[46:47], v[46:47]
    v_pk_fma_f32 v[80:81], v[80:81], v[100:101], v[100:101] op_sel:[0,1,0] op_sel_hi:[1,1,0]
    v_pk_fma_f32 v[82:83], v[82:83], v[100:101], v[100:101] op_sel:[0,1,0] op_sel_hi:[1,1,0]
    v_pk_fma_f32 v[84:85], v[84:85], v[100:101], v[100:101] op_sel:[0,1,0] op_sel_hi:[1,1,0]
    s_add_u32 s72, s80, 16384
    buffer_load_dwordx4 v[124:127], v1, s[36:39], s72 offen offset:0 sc1
    v_pk_fma_f32 v[86:87], v[86:87], v[100:101], v[100:101] op_sel:[0,1,0] op_sel_hi:[1,1,0]
    v_pk_fma_f32 v[88:89], v[88:89], v[100:101], v[100:101] op_sel:[0,1,0] op_sel_hi:[1,1,0]
    v_pk_fma_f32 v[90:91], v[90:91], v[100:101], v[100:101] op_sel:[0,1,0] op_sel_hi:[1,1,0]
    v_pk_fma_f32 v[92:93], v[92:93], v[100:101], v[100:101] op_sel:[0,1,0] op_sel_hi:[1,1,0]
    v_pk_fma_f32 v[94:95], v[94:95], v[100:101], v[100:101] op_sel:[0,1,0] op_sel_hi:[1,1,0]
    v_pk_mul_f32 v[80:81], v[80:81], v[32:33]
    v_pk_mul_f32 v[82:83], v[82:83], v[34:35]
    v_pk_mul_f32 v[84:85], v[84:85], v[36:37]
    v_pk_mul_f32 v[86:87], v[86:87], v[38:39]
    v_pk_mul_f32 v[88:89], v[88:89], v[40:41]
    v_pk_mul_f32 v[90:91], v[90:91], v[42:43]
    v_pk_mul_f32 v[92:93], v[92:93], v[44:45]
    buffer_load_dwordx4 v[128:131], v1, s[36:39], s72 offen offset:1024 sc1
    v_pk_mul_f32 v[94:95], v[94:95], v[46:47]
    v_exp_f32 v80, v80
    v_exp_f32 v81, v81
    v_exp_f32 v82, v82
    v_exp_f32 v83, v83
    v_exp_f32 v84, v84
    s_add_u32 s72, s80, 24576
    buffer_load_dwordx4 v[132:135], v1, s[36:39], s72 offen offset:0 sc1
    v_exp_f32 v85, v85
    v_exp_f32 v86, v86
    v_exp_f32 v87, v87
    v_exp_f32 v88, v88
    v_exp_f32 v89, v89
    v_exp_f32 v90, v90
    buffer_load_dwordx4 v[136:139], v1, s[36:39], s72 offen offset:1024 sc1
    v_exp_f32 v91, v91
    v_exp_f32 v92, v92
    v_exp_f32 v93, v93
    v_exp_f32 v94, v94
    v_exp_f32 v95, v95
    s_waitcnt vmcnt(6)
    s_add_u32 s72, s80, 32768
    buffer_load_dwordx4 v[140:143], v1, s[36:39], s72 offen offset:0 sc1
    s_mov_b64 exec, 1
    s_cmp_lg_u32 s48, 0
    s_cbranch_scc1 Lslow_97
    buffer_store_dword v4, off, s[36:39], s77 offset:2560
Lback_98:
    s_mov_b64 exec, -1
    ds_read_b128 v[48:51], v104 offset:0
    ds_read_b128 v[52:55], v104 offset:16
    ds_read_b128 v[56:59], v104 offset:32
    ds_read_b128 v[60:63], v104 offset:48
    v_pk_fma_f32 v[80:81], v[80:81], v[102:103], v[102:103] op_sel_hi:[1,0,0]
    v_pk_fma_f32 v[82:83], v[82:83], v[102:103], v[102:103] op_sel_hi:[1,0,0]
    v_pk_fma_f32 v[84:85], v[84:85], v[102:103], v[102:103] op_sel_hi:[1,0,0]
    v_pk_fma_f32 v[86:87], v[86:87], v[102:103], v[102:103] op_sel_hi:[1,0,0]
    buffer_load_dwordx4 v[144:147], v1, s[36:39], s72 offen offset:1024 sc1
    v_pk_fma_f32 v[88:89], v[88:89], v[102:103], v[102:103] op_sel_hi:[1,0,0]
    v_pk_fma_f32 v[90:91], v[90:91], v[102:103], v[102:103] op_sel_hi:[1,0,0]
    v_pk_fma_f32 v[92:93], v[92:93], v[102:103], v[102:103] op_sel_hi:[1,0,0]
    v_pk_fma_f32 v[94:95], v[94:95], v[102:103], v[102:103] op_sel_hi:[1,0,0]
    v_rcp_f32 v80, v80
    v_rcp_f32 v81, v81
    v_rcp_f32 v82, v82
    v_rcp_f32 v83, v83
    s_add_u32 s72, s80, 40960
    buffer_load_dwordx4 v[148:151], v1, s[36:39], s72 offen offset:0 sc1
    v_rcp_f32 v84, v84
    v_rcp_f32 v85, v85
    v_rcp_f32 v86, v86
    v_rcp_f32 v87, v87
    v_rcp_f32 v88, v88
    buffer_load_dwordx4 v[152:155], v1, s[36:39], s72 offen offset:1024 sc1
    v_rcp_f32 v89, v89
    v_rcp_f32 v90, v90
    v_rcp_f32 v91, v91
    v_rcp_f32 v92, v92
    v_rcp_f32 v93, v93
    v_rcp_f32 v94, v94
    s_add_u32 s72, s80, 49152
    buffer_load_dwordx4 v[156:159], v1, s[36:39], s72 offen offset:0 sc1
    v_rcp_f32 v95, v95
    v_pk_mul_f32 v[32:33], v[32:33], v[80:81]
    v_pk_mul_f32 v[34:35], v[34:35], v[82:83]
    v_pk_mul_f32 v[36:37], v[36:37], v[84:85]
    v_pk_mul_f32 v[38:39], v[38:39], v[86:87]
    v_pk_mul_f32 v[40:41], v[40:41], v[88:89]
    v_pk_mul_f32 v[42:43], v[42:43], v[90:91]
    v_pk_mul_f32 v[44:45], v[44:45], v[92:93]
    v_pk_mul_f32 v[46:47], v[46:47], v[94:95]
    v_cvt_pk_bf16_f32 v32, v32, v33
    v_cvt_pk_bf16_f32 v33, v34, v35
    buffer_load_dwordx4 v[160:163], v1, s[36:39], s72 offen offset:1024 sc1
    v_cvt_pk_bf16_f32 v34, v36, v37
    v_cvt_pk_bf16_f32 v35, v38, v39
    v_cvt_pk_bf16_f32 v36, v40, v41
    v_cvt_pk_bf16_f32 v37, v42, v43
    v_cvt_pk_bf16_f32 v38, v44, v45
    v_cvt_pk_bf16_f32 v39, v46, v47
    s_add_u32 s55, s84, 344064
    s_cmp_lg_u32 s48, 0
    s_cbranch_scc1 Lslow_95
    buffer_store_dwordx4 v[32:35], v1, s[36:39], s55 offen offset:0 nt
    buffer_store_dwordx4 v[36:39], v1, s[36:39], s55 offen offset:1024 nt
Lback_96:
    s_waitcnt vmcnt(13) lgkmcnt(0)
    v_mfma_f32_32x32x16_bf16 v[48:63], v[172:175], v[96:99], v[48:63]
    v_mfma_f32_32x32x16_bf16 v[48:63], a[0:3], v[108:111], v[48:63]
    s_add_u32 s72, s80, 57344
    buffer_load_dwordx4 v[164:167], v1, s[36:39], s72 offen offset:0 sc1
    v_mfma_f32_32x32x16_bf16 v[64:79], a[4:7], v[108:111], 0
    v_mfma_f32_32x32x16_bf16 v[48:63], a[8:11], v[112:115], v[48:63]
    buffer_load_dwordx4 v[168:171], v1, s[36:39], s72 offen offset:1024 sc1
    v_mfma_f32_32x32x16_bf16 v[64:79], a[12:15], v[112:115], v[64:79]
    v_mfma_f32_32x32x16_bf16 v[48:63], a[16:19], v[116:119], v[48:63]
    s_add_u32 s72, s80, 65536
    buffer_load_dwordx4 v[108:111], v1, s[36:39], s72 offen offset:0 sc1
    v_mfma_f32_32x32x16_bf16 v[64:79], a[20:23], v[116:119], v[64:79]
    v_mfma_f32_32x32x16_bf16 v[48:63], a[24:27], v[120:123], v[48:63]
    buffer_load_dwordx4 v[112:115], v1, s[36:39], s72 offen offset:1024 sc1
    v_mfma_f32_32x32x16_bf16 v[64:79], a[28:31], v[120:123], v[64:79]
    s_waitcnt vmcnt(16)
    v_mfma_f32_32x32x16_bf16 v[48:63], a[32:35], v[124:127], v[48:63]
    s_add_u32 s72, s80, 73728
    buffer_load_dwordx4 v[116:119], v1, s[36:39], s72 offen offset:0 sc1
    v_mfma_f32_32x32x16_bf16 v[64:79], a[36:39], v[124:127], v[64:79]
    s_waitcnt vmcnt(16)
    v_mfma_f32_32x32x16_bf16 v[48:63], a[40:43], v[128:131], v[48:63]
    buffer_load_dwordx4 v[120:123], v1, s[36:39], s72 offen offset:1024 sc1
    v_mfma_f32_32x32x16_bf16 v[64:79], a[44:47], v[128:131], v[64:79]
    s_waitcnt vmcnt(16)
    v_mfma_f32_32x32x16_bf16 v[48:63], a[48:51], v[132:135], v[48:63]
    s_add_u32 s72, s80, 81920
    buffer_load_dwordx4 v[124:127], v1, s[36:39], s72 offen offset:0 sc1
    s_waitcnt vmcnt(7)
    s_mov_b64 exec, 1
    s_cmp_lg_u32 s48, 0
    s_cbranch_scc1 Lslow_101
    buffer_store_dword v4, off, s[36:39], s77 offset:3072
Lback_102:
    s_mov_b64 exec, -1
    v_mfma_f32_32x32x16_bf16 v[64:79], a[52:55], v[132:135], v[64:79]
    v_mfma_f32_32x32x16_bf16 v[48:63], a[56:59], v[136:139], v[48:63]
    buffer_load_dwordx4 v[128:131], v1, s[36:39], s72 offen offset:1024 sc1
    v_mfma_f32_32x32x16_bf16 v[64:79], a[60:63], v[136:139], v[64:79]
    v_mfma_f32_32x32x16_bf16 v[48:63], a[64:67], v[140:143], v[48:63]
    s_add_u32 s72, s80, 90112
    buffer_load_dwordx4 v[132:135], v1, s[36:39], s72 offen offset:0 sc1
    v_mfma_f32_32x32x16_bf16 v[64:79], a[68:71], v[140:143], v[64:79]
    v_mfma_f32_32x32x16_bf16 v[48:63], a[72:75], v[144:147], v[48:63]
    buffer_load_dwordx4 v[136:139], v1, s[36:39], s72 offen offset:1024 sc1
    v_mfma_f32_32x32x16_bf16 v[64:79], a[76:79], v[144:147], v[64:79]
    v_mfma_f32_32x32x16_bf16 v[48:63], a[80:83], v[148:151], v[48:63]
    s_add_u32 s72, s80, 98304
    buffer_load_dwordx4 v[140:143], v1, s[36:39], s72 offen offset:0 sc1
    buffer_load_dword v9, v10, s[36:39], s83 offen sc1
    v_mfma_f32_32x32x16_bf16 v[64:79], a[84:87], v[148:151], v[64:79]
    v_mfma_f32_32x32x16_bf16 v[48:63], a[88:91], v[152:155], v[48:63]
    buffer_load_dwordx4 v[144:147], v1, s[36:39], s72 offen offset:1024 sc1
    v_mfma_f32_32x32x16_bf16 v[64:79], a[92:95], v[152:155], v[64:79]
    v_mfma_f32_32x32x16_bf16 v[48:63], a[96:99], v[156:159], v[48:63]
    s_add_u32 s72, s80, 106496
    buffer_load_dwordx4 v[148:151], v1, s[36:39], s72 offen offset:0 sc1
    v_mfma_f32_32x32x16_bf16 v[64:79], a[100:103], v[156:159], v[64:79]
    v_mfma_f32_32x32x16_bf16 v[48:63], a[104:107], v[160:163], v[48:63]
    buffer_load_dwordx4 v[152:155], v1, s[36:39], s72 offen offset:1024 sc1
    v_mfma_f32_32x32x16_bf16 v[64:79], a[108:111], v[160:163], v[64:79]
    s_waitcnt vmcnt(15)
    v_mfma_f32_32x32x16_bf16 v[48:63], a[112:115], v[164:167], v[48:63]
    v_mfma_f32_32x32x16_bf16 v[64:79], a[116:119], v[164:167], v[64:79]
    s_waitcnt vmcnt(14)
    v_mfma_f32_32x32x16_bf16 v[48:63], a[120:123], v[168:171], v[48:63]
    s_xor_b32 s54, s46, 2
    s_mul_i32 s54, s54, 6144
    s_add_u32 s54, s54, 88064
    v_add_u32 v3, s54, v1
    v_mfma_f32_32x32x16_bf16 v[64:79], a[124:127], v[168:171], v[64:79]
    s_waitcnt vmcnt(13)
    v_mfma_f32_32x32x16_bf16 v[48:63], a[128:131], v[108:111], v[48:63]
    s_waitcnt vmcnt(3)
    v_cmp_ne_u32 vcc, s47, v9
    s_cbranch_vccnz Lspin_99
Lgot_100:
    s_add_u32 s72, s81, 0
    buffer_load_dwordx4 v[156:159], v1, s[36:39], s72 offen offset:0 sc1
    s_xor_b32 s54, s46, 1
    s_mul_i32 s54, s54, 6144
    s_add_u32 s54, s54, 86016
    v_add_u32 v11, s54, v1
    v_mfma_f32_32x32x16_bf16 v[64:79], a[132:135], v[108:111], v[64:79]
    v_mfma_f32_32x32x16_bf16 v[48:63], a[136:139], v[112:115], v[48:63]
    buffer_load_dwordx4 v[160:163], v1, s[36:39], s72 offen offset:1024 sc1
    s_xor_b32 s54, s46, 3
    s_mul_i32 s54, s54, 6144
    s_add_u32 s54, s54, 90112
    v_add_u32 v12, s54, v1
    v_mfma_f32_32x32x16_bf16 v[64:79], a[140:143], v[112:115], v[64:79]
    v_mfma_f32_32x32x16_bf16 v[48:63], a[144:147], v[116:119], v[48:63]
    s_add_u32 s72, s81, 8192
    buffer_load_dwordx4 v[164:167], v1, s[36:39], s72 offen offset:0 sc1
    s_mul_i32 s54, s46, 6144
    s_add_u32 s54, s54, 86016
    v_add_u32 v14, s54, v1
    v_mfma_f32_32x32x16_bf16 v[64:79], a[148:151], v[116:119], v[64:79]
    v_mfma_f32_32x32x16_bf16 v[48:63], a[152:155], v[120:123], v[48:63]
    buffer_load_dwordx4 v[168:171], v1, s[36:39], s72 offen offset:1024 sc1
    v_mfma_f32_32x32x16_bf16 v[64:79], a[156:159], v[120:123], v[64:79]
    v_mfma_f32_32x32x16_bf16 v[48:63], a[160:163], v[124:127], v[48:63]
    s_add_u32 s72, s81, 16384
    buffer_load_dwordx4 v[108:111], v1, s[36:39], s72 offen offset:0 sc1
    buffer_load_dwordx4 v[96:99], v1, s[36:39], s35 offen sc1
    v_mfma_f32_32x32x16_bf16 v[64:79], a[164:167], v[124:127], v[64:79]
    v_mfma_f32_32x32x16_bf16 v[48:63], a[168:171], v[128:131], v[48:63]
    buffer_load_dwordx4 v[112:115], v1, s[36:39], s72 offen offset:1024 sc1
    v_mfma_f32_32x32x16_bf16 v[64:79], a[172:175], v[128:131], v[64:79]
    v_mfma_f32_32x32x16_bf16 v[48:63], a[176:179], v[132:135], v[48:63]
    s_add_u32 s72, s81, 24576
    buffer_load_dwordx4 v[116:119], v1, s[36:39], s72 offen offset:0 sc1
    v_and_b32 v10, 31, v0
    v_mul_u32_u24 v10, 896, v10
    v_lshrrev_b32 v9, 5, v0
    v_lshl_add_u32 v10, v9, 4, v10
    v_mfma_f32_32x32x16_bf16 v[64:79], a[180:183], v[132:135], v[64:79]
    v_mfma_f32_32x32x16_bf16 v[48:63], a[184:187], v[136:139], v[48:63]
    buffer_load_dwordx4 v[120:123], v1, s[36:39], s72 offen offset:1024 sc1
    ds_read_b128 v[16:19], v104 offset:0
    ds_read_b128 v[20:23], v104 offset:16
    ds_read_b128 v[24:27], v104 offset:32
    ds_read_b128 v[28:31], v104 offset:48
    v_mfma_f32_32x32x16_bf16 v[64:79], a[188:191], v[136:139], v[64:79]
    v_mfma_f32_32x32x16_bf16 v[48:63], a[192:195], v[140:143], v[48:63]
    s_add_u32 s72, s81, 32768
    buffer_load_dwordx4 v[124:127], v1, s[36:39], s72 offen offset:0 sc1
    v_mfma_f32_32x32x16_bf16 v[64:79], a[196:199], v[140:143], v[64:79]
    s_waitcnt vmcnt(12)
    v_mfma_f32_32x32x16_bf16 v[48:63], a[200:203], v[144:147], v[48:63]
    buffer_load_dwordx4 v[128:131], v1, s[36:39], s72 offen offset:1024 sc1
    v_mfma_f32_32x32x16_bf16 v[64:79], a[204:207], v[144:147], v[64:79]
    s_waitcnt vmcnt(12)
    v_mfma_f32_32x32x16_bf16 v[48:63], a[208:211], v[148:151], v[48:63]
    s_add_u32 s72, s81, 40960
    buffer_load_dwordx4 v[132:135], v1, s[36:39], s72 offen offset:0 sc1
    v_mfma_f32_32x32x16_bf16 v[64:79], a[212:215], v[148:151], v[64:79]
    s_waitcnt vmcnt(12)
    v_mfma_f32_32x32x16_bf16 v[48:63], a[216:219], v[152:155], v[48:63]
    buffer_load_dwordx4 v[136:139], v1, s[36:39], s72 offen offset:1024 sc1
    v_mfma_f32_32x32x16_bf16 v[64:79], a[220:223], v[152:155], v[64:79]
    s_waitcnt vmcnt(7) lgkmcnt(0)
    v_mfma_f32_32x32x16_bf16 v[16:31], v[172:175], v[96:99], v[16:31]
    v_mfma_f32_32x32x16_bf16 v[16:31], a[0:3], v[156:159], v[16:31]
    s_add_u32 s72, s81, 49152
    buffer_load_dwordx4 v[140:143], v1, s[36:39], s72 offen offset:0 sc1
    v_mfma_f32_32x32x16_bf16 v[32:47], a[4:7], v[156:159], 0
    v_mfma_f32_32x32x16_bf16 v[16:31], a[8:11], v[160:163], v[16:31]
    buffer_load_dwordx4 v[144:147], v1, s[36:39], s72 offen offset:1024 sc1
    s_nop 1
    ds_write_b128 v3, v[56:59]
    v_mfma_f32_32x32x16_bf16 v[32:47], a[12:15], v[160:163], v[32:47]
    ds_write_b128 v3, v[60:63] offset:1024
    v_mfma_f32_32x32x16_bf16 v[16:31], a[16:19], v[164:167], v[16:31]
    s_add_u32 s72, s81, 57344
    buffer_load_dwordx4 v[148:151], v1, s[36:39], s72 offen offset:0 sc1
    ds_write_b128 v11, v[64:67]
    v_mfma_f32_32x32x16_bf16 v[32:47], a[20:23], v[164:167], v[32:47]
    v_mfma_f32_32x32x16_bf16 v[16:31], a[24:27], v[168:171], v[16:31]
    buffer_load_dwordx4 v[152:155], v1, s[36:39], s72 offen offset:1024 sc1
    ds_write_b128 v11, v[68:71] offset:1024
    v_mfma_f32_32x32x16_bf16 v[32:47], a[28:31], v[168:171], v[32:47]
    ds_write_b128 v12, v[72:75]
    v_mfma_f32_32x32x16_bf16 v[16:31], a[32:35], v[108:111], v[16:31]
    s_add_u32 s72, s81, 65536
    buffer_load_dwordx4 v[156:159], v1, s[36:39], s72 offen offset:0 sc1
    ds_write_b128 v12, v[76:79] offset:1024
    v_mfma_f32_32x32x16_bf16 v[32:47], a[36:39], v[108:111], v[32:47]
    s_waitcnt vmcnt(11)
    v_mfma_f32_32x32x16_bf16 v[16:31], a[40:43], v[112:115], v[16:31]
    buffer_load_dwordx4 v[160:163], v1, s[36:39], s72 offen offset:1024 sc1
    v_mfma_f32_32x32x16_bf16 v[32:47], a[44:47], v[112:115], v[32:47]
    s_waitcnt vmcnt(11)
    v_mfma_f32_32x32x16_bf16 v[16:31], a[48:51], v[116:119], v[16:31]
    s_add_u32 s72, s81, 73728
    buffer_load_dwordx4 v[164:167], v1, s[36:39], s72 offen offset:0 sc1
    v_mfma_f32_32x32x16_bf16 v[32:47], a[52:55], v[116:119], v[32:47]
    s_waitcnt lgkmcnt(0)
    s_barrier
    ds_read_b128 v[80:83], v14 offset:0
    ds_read_b128 v[84:87], v14 offset:1024
    ds_read_b128 v[88:91], v14 offset:2048
    ds_read_b128 v[92:95], v14 offset:3072
    ds_read_b128 v[96:99], v14 offset:4096
    ds_read_b128 v[100:103], v14 offset:5120
    s_waitcnt vmcnt(11)
    v_mfma_f32_32x32x16_bf16 v[16:31], a[56:59], v[120:123], v[16:31]
    buffer_load_dwordx4 v[168:171], v1, s[36:39], s72 offen offset:1024 sc1
    v_mfma_f32_32x32x16_bf16 v[32:47], a[60:63], v[120:123], v[32:47]
    s_waitcnt vmcnt(11)
    v_mfma_f32_32x32x16_bf16 v[16:31], a[64:67], v[124:127], v[16:31]
    s_add_u32 s72, s81, 81920
    buffer_load_dwordx4 v[108:111], v1, s[36:39], s72 offen offset:0 sc1
    v_mfma_f32_32x32x16_bf16 v[32:47], a[68:71], v[124:127], v[32:47]
    s_waitcnt lgkmcnt(5)
    v_add_f32 v48, v48, v80
    v_add_f32 v49, v49, v81
    s_waitcnt vmcnt(11)
    v_mfma_f32_32x32x16_bf16 v[16:31], a[72:75], v[128:131], v[16:31]
    buffer_load_dwordx4 v[112:115], v1, s[36:39], s72 offen offset:1024 sc1
    v_add_f32 v50, v50, v82
    v_add_f32 v51, v51, v83
    v_mfma_f32_32x32x16_bf16 v[32:47], a[76:79], v[128:131], v[32:47]
    s_waitcnt lgkmcnt(4)
    v_add_f32 v52, v52, v84
    v_add_f32 v53, v53, v85
    s_waitcnt vmcnt(11)
    v_mfma_f32_32x32x16_bf16 v[16:31], a[80:83], v[132:135], v[16:31]
    s_add_u32 s72, s81, 90112
    buffer_load_dwordx4 v[116:119], v1, s[36:39], s72 offen offset:0 sc1
    v_add_f32 v54, v54, v86
    v_add_f32 v55, v55, v87
    v_mfma_f32_32x32x16_bf16 v[32:47], a[84:87], v[132:135], v[32:47]
    s_waitcnt lgkmcnt(1)
    v_add_f32 v88, v88, v96
    v_add_f32 v89, v89, v97
    s_waitcnt vmcnt(11)
    v_mfma_f32_32x32x16_bf16 v[16:31], a[88:91], v[136:139], v[16:31]
    buffer_load_dwordx4 v[120:123], v1, s[36:39], s72 offen offset:1024 sc1
    v_add_f32 v90, v90, v98
    v_add_f32 v91, v91, v99
    v_mfma_f32_32x32x16_bf16 v[32:47], a[92:95], v[136:139], v[32:47]
    s_waitcnt lgkmcnt(0)
    v_add_f32 v92, v92, v100
    v_add_f32 v93, v93, v101
    s_waitcnt vmcnt(11)
    v_mfma_f32_32x32x16_bf16 v[16:31], a[96:99], v[140:143], v[16:31]
    s_add_u32 s72, s81, 98304
    buffer_load_dwordx4 v[124:127], v1, s[36:39], s72 offen offset:0 sc1
    v_add_f32 v94, v94, v102
    v_add_f32 v95, v95, v103
    v_mfma_f32_32x32x16_bf16 v[32:47], a[100:103], v[140:143], v[32:47]
    v_add_f32 v48, v48, v88
    s_waitcnt vmcnt(11)
    v_mfma_f32_32x32x16_bf16 v[16:31], a[104:107], v[144:147], v[16:31]
    buffer_load_dwordx4 v[128:131], v1, s[36:39], s72 offen offset:1024 sc1
    v_add_f32 v49, v49, v89
    v_add_f32 v50, v50, v90
    v_mfma_f32_32x32x16_bf16 v[32:47], a[108:111], v[144:147], v[32:47]
    v_add_f32 v51, v51, v91
    v_add_f32 v52, v52, v92
    s_waitcnt vmcnt(11)
    v_mfma_f32_32x32x16_bf16 v[16:31], a[112:115], v[148:151], v[16:31]
    s_add_u32 s72, s81, 106496
    buffer_load_dwordx4 v[132:135], v1, s[36:39], s72 offen offset:0 sc1
    v_add_f32 v53, v53, v93
    v_add_f32 v54, v54, v94
    v_mfma_f32_32x32x16_bf16 v[32:47], a[116:119], v[148:151], v[32:47]
    v_add_f32 v55, v55, v95
    v_cvt_pk_bf16_f32 v48, v48, v49
    s_waitcnt vmcnt(11)
    v_mfma_f32_32x32x16_bf16 v[16:31], a[120:123], v[152:155], v[16:31]
    buffer_load_dwordx4 v[136:139], v1, s[36:39], s72 offen offset:1024 sc1
    v_cvt_pk_bf16_f32 v49, v50, v51
    v_cvt_pk_bf16_f32 v50, v52, v53
    v_mfma_f32_32x32x16_bf16 v[32:47], a[124:127], v[152:155], v[32:47]
    v_cvt_pk_bf16_f32 v51, v54, v55
    v_permlane32_swap_b32 v48, v50
    s_waitcnt vmcnt(11)
    v_mfma_f32_32x32x16_bf16 v[16:31], a[128:131], v[156:159], v[16:31]
    v_permlane32_swap_b32 v49, v51
    buffer_store_dwordx4 v[48:51], v10, s[24:27], s28 offen
    v_mfma_f32_32x32x16_bf16 v[32:47], a[132:135], v[156:159], v[32:47]
    s_waitcnt vmcnt(11)
    v_mfma_f32_32x32x16_bf16 v[16:31], a[136:139], v[160:163], v[16:31]
    s_barrier
    v_mfma_f32_32x32x16_bf16 v[32:47], a[140:143], v[160:163], v[32:47]
    s_waitcnt vmcnt(10)
    v_mfma_f32_32x32x16_bf16 v[16:31], a[144:147], v[164:167], v[16:31]
    v_mfma_f32_32x32x16_bf16 v[32:47], a[148:151], v[164:167], v[32:47]
    s_waitcnt vmcnt(9)
    v_mfma_f32_32x32x16_bf16 v[16:31], a[152:155], v[168:171], v[16:31]
    v_mfma_f32_32x32x16_bf16 v[32:47], a[156:159], v[168:171], v[32:47]
    s_waitcnt vmcnt(8)
    v_mfma_f32_32x32x16_bf16 v[32:47], a[164:167], v[108:111], v[32:47]
    s_waitcnt vmcnt(7)
    v_mfma_f32_32x32x16_bf16 v[32:47], a[172:175], v[112:115], v[32:47]
    s_waitcnt vmcnt(6)
    v_mfma_f32_32x32x16_bf16 v[32:47], a[180:183], v[116:119], v[32:47]
    s_waitcnt vmcnt(5)
    v_mfma_f32_32x32x16_bf16 v[32:47], a[188:191], v[120:123], v[32:47]
    s_waitcnt vmcnt(4)
    v_mfma_f32_32x32x16_bf16 v[32:47], a[196:199], v[124:127], v[32:47]
    s_waitcnt vmcnt(3)
    v_mfma_f32_32x32x16_bf16 v[32:47], a[204:207], v[128:131], v[32:47]
    s_waitcnt vmcnt(2)
    v_mfma_f32_32x32x16_bf16 v[32:47], a[212:215], v[132:135], v[32:47]
    s_waitcnt vmcnt(1)
    v_mfma_f32_32x32x16_bf16 v[32:47], a[220:223], v[136:139], v[32:47]
    v_mfma_f32_32x32x16_bf16 v[16:31], a[160:163], v[108:111], v[16:31]
    v_mfma_f32_32x32x16_bf16 v[16:31], a[168:171], v[112:115], v[16:31]
    v_mfma_f32_32x32x16_bf16 v[16:31], a[176:179], v[116:119], v[16:31]
    s_nop 8
    ds_write_b128 v11, v[32:35]
    v_mfma_f32_32x32x16_bf16 v[16:31], a[184:187], v[120:123], v[16:31]
    ds_write_b128 v11, v[36:39] offset:1024
    v_mfma_f32_32x32x16_bf16 v[16:31], a[192:195], v[124:127], v[16:31]
    ds_write_b128 v12, v[40:43]
    v_mfma_f32_32x32x16_bf16 v[16:31], a[200:203], v[128:131], v[16:31]
    ds_write_b128 v12, v[44:47] offset:1024
    v_mfma_f32_32x32x16_bf16 v[16:31], a[208:211], v[132:135], v[16:31]
    v_mfma_f32_32x32x16_bf16 v[16:31], a[216:219], v[136:139], v[16:31]
    s_nop 11
    ds_write_b128 v3, v[24:27]
    ds_write_b128 v3, v[28:31] offset:1024
    s_waitcnt lgkmcnt(0)
    s_barrier
    ds_read_b128 v[80:83], v14 offset:0
    ds_read_b128 v[84:87], v14 offset:1024
    ds_read_b128 v[88:91], v14 offset:2048
    ds_read_b128 v[92:95], v14 offset:3072
    ds_read_b128 v[96:99], v14 offset:4096
    ds_read_b128 v[100:103], v14 offset:5120
    s_waitcnt lgkmcnt(5)
    v_pk_add_f32 v[16:17], v[16:17], v[80:81]
    v_pk_add_f32 v[18:19], v[18:19], v[82:83]
    s_waitcnt lgkmcnt(4)
    v_pk_add_f32 v[20:21], v[20:21], v[84:85]
    v_pk_add_f32 v[22:23], v[22:23], v[86:87]
    s_waitcnt lgkmcnt(1)
    v_pk_add_f32 v[88:89], v[88:89], v[96:97]
    v_pk_add_f32 v[90:91], v[90:91], v[98:99]
    s_waitcnt lgkmcnt(0)
    v_pk_add_f32 v[92:93], v[92:93], v[100:101]
    v_pk_add_f32 v[94:95], v[94:95], v[102:103]
    v_pk_add_f32 v[16:17], v[16:17], v[88:89]
    v_pk_add_f32 v[18:19], v[18:19], v[90:91]
    v_pk_add_f32 v[20:21], v[20:21], v[92:93]
    v_pk_add_f32 v[22:23], v[22:23], v[94:95]
    v_cvt_pk_bf16_f32 v16, v16, v17
    v_cvt_pk_bf16_f32 v17, v18, v19
    v_cvt_pk_bf16_f32 v18, v20, v21
    v_cvt_pk_bf16_f32 v19, v22, v23
    s_nop 0
    v_permlane32_swap_b32 v16, v18
    v_permlane32_swap_b32 v17, v19
    buffer_store_dwordx4 v[16:19], v10, s[24:27], s29 offen
L_layer2:
    s_cmp_lg_u32 s2, 0
    s_cbranch_scc1 L_fin
    s_cmp_lg_u32 s46, 0
    s_cbranch_scc1 L_fin
    s_mov_b64 exec, 1
    buffer_store_dword v4, off, s[40:43], 0 sc1
    s_mov_b64 exec, -1
L_fin:
L_end:
    s_endpgm
Lnostage_3:
    s_waitcnt vmcnt(0)
    s_branch Lstaged_4
Lxcc_10:
    buffer_load_dword v9, v10, s[40:43], s55 offen sc1
    s_add_u32 s50, s50, 1
    s_cmp_gt_u32 s50, 0x40000
    s_cbranch_scc1 L_end
    s_waitcnt vmcnt(0)
    v_subrev_u32 v9, s47, v9
    v_cmp_lt_u32 vcc, 15, v9
    s_cbranch_vccnz Lxcc_10
    s_branch Lxok_11
Lresweep_13:
    s_sleep 4
    s_add_u32 s50, s50, 1
    s_cmp_gt_u32 s50, 0x40000
    s_cbranch_scc1 L_end
    s_add_u32 s86, s78, 0
    buffer_load_dwordx4 v[48:51], v1, s[40:43], s86 offen offset:0 sc1
    buffer_load_dwordx4 v[52:55], v1, s[40:43], s86 offen offset:1024 sc1
    buffer_load_dwordx4 v[56:59], v1, s[40:43], s86 offen offset:2048 sc1
    buffer_load_dwordx4 v[60:63], v1, s[40:43], s86 offen offset:3072 sc1
    s_add_u32 s86, s78, 4096
    buffer_load_dwordx4 v[64:67], v1, s[40:43], s86 offen offset:0 sc1
    buffer_load_dwordx4 v[68:71], v1, s[40:43], s86 offen offset:1024 sc1
    buffer_load_dwordx4 v[72:75], v1, s[40:43], s86 offen offset:2048 sc1
    buffer_load_dwordx4 v[76:79], v1, s[40:43], s86 offen offset:3072 sc1
    s_waitcnt vmcnt(0)
    s_branch Lsweep_12
Lslow_14:
    buffer_store_dwordx4 v[80:83], v1, s[36:39], s75 offen offset:0 sc1
    buffer_store_dwordx4 v[84:87], v1, s[36:39], s75 offen offset:1024 sc1
    s_branch Lback_15
Lskipmlp_16:
    s_getpc_b64 s[88:89]
L_pc3:
    s_sub_u32 s88, s88, L_pc3-L_mlp0
    s_subb_u32 s89, s89, 0
    s_lshr_b32 s52, s44, 3
    s_lshl_b32 s52, s52, 1
    s_and_b32 s51, s45, 1
    s_add_u32 s52, s52, s51
    s_lshl_b32 s52, s52, 2
    s_add_u32 s52, s52, s46
    s_lshl_b32 s52, s52, 11
    v_lshlrev_b32 v11, 7, v0
    v_add_u32 v11, s52, v11
    v_min_u32 v11, L_layer1-L_mlp0-4, v11
    s_mov_b64 exec, 0xffff
    global_load_dword v9, v11, s[88:89]
    s_mov_b64 exec, -1
    s_cmp_lg_u32 s48, 0
    s_cbranch_scc1 Lnowarm_18
    v_lshlrev_b32 v11, 7, v0
    s_and_b32 s51, s45, 1
    s_lshl_b32 s51, s51, 2
    s_add_u32 s51, s51, s46
    s_lshr_b32 s52, s44, 3
    s_lshl_b32 s52, s52, 3
    s_add_u32 s52, s52, s51
    s_lshl_b32 s53, s52, 13
    s_mov_b32 s52, s53
    s_and_b32 s54, s44, 3
    s_xor_b32 s53, s54, 0
    s_lshl_b32 s53, s53, 17
    s_add_u32 s53, s53, s52
    buffer_load_dword v2, v11, s[16:19], s53 offen
    s_xor_b32 s53, s54, 1
    s_lshl_b32 s53, s53, 17
    s_add_u32 s53, s53, s52
    buffer_load_dword v2, v11, s[16:19], s53 offen
    s_xor_b32 s53, s54, 2
    s_lshl_b32 s53, s53, 17
    s_add_u32 s53, s53, s52
    buffer_load_dword v2, v11, s[16:19], s53 offen
    s_xor_b32 s53, s54, 3
    s_lshl_b32 s53, s53, 17
    s_add_u32 s53, s53, s52
    buffer_load_dword v2, v11, s[16:19], s53 offen
    s_xor_b32 s53, s54, 4
    s_lshl_b32 s53, s53, 17
    s_add_u32 s53, s53, s52
    buffer_load_dword v2, v11, s[16:19], s53 offen
    s_xor_b32 s53, s54, 5
    s_lshl_b32 s53, s53, 17
    s_add_u32 s53, s53, s52
    buffer_load_dword v2, v11, s[16:19], s53 offen
    s_xor_b32 s53, s54, 6
    s_lshl_b32 s53, s53, 17
    s_add_u32 s53, s53, s52
    buffer_load_dword v2, v11, s[16:19], s53 offen
    s_xor_b32 s53, s54, 7
    s_lshl_b32 s53, s53, 17
    s_add_u32 s53, s53, s52
    buffer_load_dword v2, v11, s[16:19], s53 offen
    s_xor_b32 s53, s54, 8
    s_lshl_b32 s53, s53, 17
    s_add_u32 s53, s53, s52
    buffer_load_dword v2, v11, s[16:19], s53 offen
    s_xor_b32 s53, s54, 9
    s_lshl_b32 s53, s53, 17
    s_add_u32 s53, s53, s52
    buffer_load_dword v2, v11, s[16:19], s53 offen
    s_xor_b32 s53, s54, 10
    s_lshl_b32 s53, s53, 17
    s_add_u32 s53, s53, s52
    buffer_load_dword v2, v11, s[16:19], s53 offen
    s_xor_b32 s53, s54, 11
    s_lshl_b32 s53, s53, 17
    s_add_u32 s53, s53, s52
    buffer_load_dword v2, v11, s[16:19], s53 offen
    s_xor_b32 s53, s54, 12
    s_lshl_b32 s53, s53, 17
    s_add_u32 s53, s53, s52
    buffer_load_dword v2, v11, s[16:19], s53 offen
    s_xor_b32 s53, s54, 13
    s_lshl_b32 s53, s53, 17
    s_add_u32 s53, s53, s52
    buffer_load_dword v2, v11, s[16:19], s53 offen
    s_xor_b32 s53, s54, 14
    s_lshl_b32 s53, s53, 17
    s_add_u32 s53, s53, s52
    buffer_load_dword v2, v11, s[16:19], s53 offen
    s_xor_b32 s53, s54, 15
    s_lshl_b32 s53, s53, 17
    s_add_u32 s53, s53, s52
    buffer_load_dword v2, v11, s[16:19], s53 offen
    s_lshl_b32 s53, s51, 13
    s_add_u32 s53, s53, 262144
    buffer_load_dword v2, v11, s[36:39], s53 offen sc1
    s_lshl_b32 s53, s51, 13
    s_add_u32 s53, s53, 327680
    buffer_load_dword v2, v11, s[36:39], s53 offen sc1
    s_lshl_b32 s53, s51, 13
    s_add_u32 s53, s53, 393216
    buffer_load_dword v2, v11, s[36:39], s53 offen sc1
    s_lshl_b32 s53, s51, 13
    s_add_u32 s53, s53, 458752
    buffer_load_dword v2, v11, s[36:39], s53 offen sc1
    s_lshl_b32 s53, s51, 13
    s_add_u32 s53, s53, 524288
    buffer_load_dword v2, v11, s[36:39], s53 offen sc1
    s_lshl_b32 s53, s51, 13
    s_add_u32 s53, s53, 589824
    buffer_load_dword v2, v11, s[36:39], s53 offen sc1
    s_lshl_b32 s53, s51, 13
    s_add_u32 s53, s53, 655360
    buffer_load_dword v2, v11, s[36:39], s53 offen sc1
    s_lshl_b32 s53, s51, 12
    s_add_u32 s53, s53, 851968
    s_mov_b32 exec_hi, 0
    buffer_load_dword v2, v11, s[36:39], s53 offen sc1
    s_mov_b64 exec, -1
Lnowarm_18:
    s_waitcnt vmcnt(0) lgkmcnt(0)
    v_and_b32 v10, 31, v0
    v_min_u32 v10, 27, v10
    v_lshlrev_b32 v10, 2, v10
    s_mov_b32 s55, 885760
Lidle_17:
    s_sleep 8
    buffer_load_dword v9, v10, s[36:39], s55 offen sc1
    s_add_u32 s50, s50, 1
    s_cmp_gt_u32 s50, 0x40000
    s_cbranch_scc1 L_end
    s_waitcnt vmcnt(0)
    v_cmp_ne_u32 vcc, s47, v9
    s_cbranch_vccnz Lidle_17
    s_getpc_b64 s[88:89]
L_pc2:
    s_sub_u32 s88, s88, L_pc2-L_layer1
    s_subb_u32 s89, s89, 0
    s_lshr_b32 s52, s44, 3
    s_lshl_b32 s52, s52, 1
    s_and_b32 s51, s45, 1
    s_add_u32 s52, s52, s51
    s_lshl_b32 s52, s52, 2
    s_add_u32 s52, s52, s46
    s_lshl_b32 s52, s52, 11
    v_lshlrev_b32 v11, 7, v0
    v_add_u32 v11, s52, v11
    v_min_u32 v11, L_code_end-L_layer1-4, v11
    s_mov_b64 exec, 0xffff
    global_load_dword v9, v11, s[88:89]
    s_mov_b64 exec, -1
    s_waitcnt vmcnt(0)
    s_branch L_layer1
Lspin_21:
    buffer_load_dword v9, v10, s[36:39], s74 offen sc1
    s_add_u32 s50, s50, 1
    s_cmp_gt_u32 s50, 0x40000
    s_cbranch_scc1 L_end
    s_waitcnt vmcnt(0)
    v_lshrrev_b32 v9, 16, v9
    v_cmp_ne_u32 vcc, s22, v9
    s_cbranch_vccnz Lspin_21
    s_branch Lgot_22
Ls2again_20:
    s_add_u32 s50, s50, 1
    s_cmp_gt_u32 s50, 0x40000
    s_cbranch_scc1 L_end
    s_nop 15
    v_and_b32 v31, 0xffff0000, v167
    v_lshlrev_b32 v30, 16, v167
    v_and_b32 v29, 0xffff0000, v166
    v_lshlrev_b32 v28, 16, v166
    v_and_b32 v27, 0xffff0000, v165
    v_lshlrev_b32 v26, 16, v165
    v_and_b32 v25, 0xffff0000, v164
    v_lshlrev_b32 v24, 16, v164
    v_and_b32 v23, 0xffff0000, v163
    v_lshlrev_b32 v22, 16, v163
    v_and_b32 v21, 0xffff0000, v162
    v_lshlrev_b32 v20, 16, v162
    v_and_b32 v19, 0xffff0000, v161
    v_lshlrev_b32 v18, 16, v161
    v_and_b32 v17, 0xffff0000, v160
    v_lshlrev_b32 v16, 16, v160
    ds_read_b64_tr_b16 v[144:145], v3 offset:0
    ds_read_b64_tr_b16 v[146:147], v3 offset:256
    ds_read_b64_tr_b16 v[148:149], v3 offset:896
    ds_read_b64_tr_b16 v[150:151], v3 offset:1152
    ds_read_b64_tr_b16 v[152:153], v3 offset:1792
    ds_read_b64_tr_b16 v[154:155], v3 offset:2048
    ds_read_b64_tr_b16 v[156:157], v3 offset:2688
    ds_read_b64_tr_b16 v[158:159], v3 offset:2944
    s_waitcnt lgkmcnt(0)
    s_branch Ls2_19
Lslow_23:
    buffer_store_dwordx4 v[32:35], v1, s[36:39], s55 offen offset:0 sc1
    buffer_store_dwordx4 v[36:39], v1, s[36:39], s55 offen offset:1024 sc1
    s_branch Lback_24
Lslow_25:
    buffer_store_dword v11, v1, s[36:39], s56 offen sc1
    s_branch Lback_26
Lslow_27:
    buffer_store_dword v4, off, s[36:39], s77 offset:512 sc1
    s_branch Lback_28
Lspin_30:
    buffer_load_dword v9, v10, s[36:39], s55 offen sc1
    s_add_u32 s50, s50, 1
    s_cmp_gt_u32 s50, 0x40000
    s_cbranch_scc1 L_end
    s_waitcnt vmcnt(0)
    v_cmp_ne_u32 vcc, s47, v9
    s_cbranch_vccnz Lspin_30
    s_branch Lgot_31
Lslow_32:
    buffer_store_dwordx4 v[16:19], v1, s[36:39], s55 offen offset:0 sc1
    buffer_store_dwordx4 v[20:23], v1, s[36:39], s55 offen offset:1024 sc1
    s_branch Lback_33
Lslow_34:
    buffer_store_dwordx4 v[32:35], v1, s[36:39], s55 offen offset:0 sc1
    buffer_store_dwordx4 v[36:39], v1, s[36:39], s55 offen offset:1024 sc1
    s_branch Lback_35
Lslow_36:
    buffer_store_dwordx4 v[16:19], v1, s[36:39], s55 offen offset:0 sc1
    buffer_store_dwordx4 v[20:23], v1, s[36:39], s55 offen offset:1024 sc1
    s_branch Lback_37
Lslow_38:
    buffer_store_dwordx4 v[32:35], v1, s[36:39], s55 offen offset:0 sc1
    buffer_store_dwordx4 v[36:39], v1, s[36:39], s55 offen offset:1024 sc1
    s_branch Lback_39
Lslow_40:
    buffer_store_dword v4, off, s[36:39], s77 offset:1536 sc1
    s_branch Lback_41
Lslow_42:
    buffer_store_dword v4, off, s[36:39], s77 offset:2048 sc1
    s_branch Lback_43
Lslow_44:
    buffer_store_dword v4, off, s[36:39], s77 offset:2560 sc1
    s_branch Lback_45
Lspin_46:
    buffer_load_dword v9, v10, s[36:39], s82 offen sc1
    s_add_u32 s50, s50, 1
    s_cmp_gt_u32 s50, 0x40000
    s_cbranch_scc1 L_end
    s_waitcnt vmcnt(0)
    v_cmp_ne_u32 vcc, s47, v9
    s_cbranch_vccnz Lspin_46
    s_branch Lgot_47
Lspin_48:
    buffer_load_dword v9, v10, s[36:39], s83 offen sc1
    s_add_u32 s50, s50, 1
    s_cmp_gt_u32 s50, 0x40000
    s_cbranch_scc1 L_end
    s_waitcnt vmcnt(0)
    v_cmp_ne_u32 vcc, s47, v9
    s_cbranch_vccnz Lspin_48
    s_branch Lgot_49
Lslow_50:
    buffer_store_dword v4, off, s[36:39], s77 offset:3072 sc1
    s_branch Lback_51
Lslow_52:
    buffer_store_dwordx4 v[48:51], v1, s[36:39], s28 offen sc1
    s_branch Lback_53
Lslow_54:
    buffer_store_dword v80, v1, s[36:39], s30 offen sc1
    s_branch Lback_55
Lslow_56:
    buffer_store_dword v4, off, s[36:39], s32 offset:0 sc1
    s_branch Lback_57
Lslow_58:
    buffer_store_dwordx4 v[16:19], v1, s[36:39], s29 offen sc1
    s_branch Lback_59
Lslow_60:
    buffer_store_dword v80, v1, s[36:39], s31 offen sc1
    s_branch Lback_61
Lslow_62:
    buffer_store_dword v4, off, s[36:39], s33 offset:0 sc1
    s_branch Lback_63
Lspin_64:
    buffer_load_dword v9, v10, s[36:39], s55 offen sc1
    s_add_u32 s50, s50, 1
    s_cmp_gt_u32 s50, 0x40000
    s_cbranch_scc1 L_end
    s_waitcnt vmcnt(0)
    v_cmp_ne_u32 vcc, s47, v9
    s_cbranch_vccnz Lspin_64
    s_branch Lgot_65
Lresweep_67:
    s_sleep 4
    s_add_u32 s50, s50, 1
    s_cmp_gt_u32 s50, 0x40000
    s_cbranch_scc1 L_end
    s_add_u32 s86, s78, 0
    buffer_load_dwordx4 v[48:51], v1, s[40:43], s86 offen offset:0 sc1
    buffer_load_dwordx4 v[52:55], v1, s[40:43], s86 offen offset:1024 sc1
    buffer_load_dwordx4 v[56:59], v1, s[40:43], s86 offen offset:2048 sc1
    buffer_load_dwordx4 v[60:63], v1, s[40:43], s86 offen offset:3072 sc1
    s_add_u32 s86, s78, 4096
    buffer_load_dwordx4 v[64:67], v1, s[40:43], s86 offen offset:0 sc1
    buffer_load_dwordx4 v[68:71], v1, s[40:43], s86 offen offset:1024 sc1
    buffer_load_dwordx4 v[72:75], v1, s[40:43], s86 offen offset:2048 sc1
    buffer_load_dwordx4 v[76:79], v1, s[40:43], s86 offen offset:3072 sc1
    s_waitcnt vmcnt(0)
    s_branch Lsweep_66
Lslow_68:
    buffer_store_dwordx4 v[80:83], v1, s[36:39], s75 offen offset:0 sc1
    buffer_store_dwordx4 v[84:87], v1, s[36:39], s75 offen offset:1024 sc1
    s_branch Lback_69
Lspin_72:
    buffer_load_dword v9, v10, s[36:39], s74 offen sc1
    s_add_u32 s50, s50, 1
    s_cmp_gt_u32 s50, 0x40000
    s_cbranch_scc1 L_end
    s_waitcnt vmcnt(0)
    v_lshrrev_b32 v9, 16, v9
    v_cmp_ne_u32 vcc, s22, v9
    s_cbranch_vccnz Lspin_72
    s_branch Lgot_73
Ls2again_71:
    s_add_u32 s50, s50, 1
    s_cmp_gt_u32 s50, 0x40000
    s_cbranch_scc1 L_end
    s_nop 15
    v_and_b32 v31, 0xffff0000, v167
    v_lshlrev_b32 v30, 16, v167
    v_and_b32 v29, 0xffff0000, v166
    v_lshlrev_b32 v28, 16, v166
    v_and_b32 v27, 0xffff0000, v165
    v_lshlrev_b32 v26, 16, v165
    v_and_b32 v25, 0xffff0000, v164
    v_lshlrev_b32 v24, 16, v164
    v_and_b32 v23, 0xffff0000, v163
    v_lshlrev_b32 v22, 16, v163
    v_and_b32 v21, 0xffff0000, v162
    v_lshlrev_b32 v20, 16, v162
    v_and_b32 v19, 0xffff0000, v161
    v_lshlrev_b32 v18, 16, v161
    v_and_b32 v17, 0xffff0000, v160
    v_lshlrev_b32 v16, 16, v160
    ds_read_b64_tr_b16 v[144:145], v3 offset:0
    ds_read_b64_tr_b16 v[146:147], v3 offset:256
    ds_read_b64_tr_b16 v[148:149], v3 offset:896
    ds_read_b64_tr_b16 v[150:151], v3 offset:1152
    ds_read_b64_tr_b16 v[152:153], v3 offset:1792
    ds_read_b64_tr_b16 v[154:155], v3 offset:2048
    ds_read_b64_tr_b16 v[156:157], v3 offset:2688
    ds_read_b64_tr_b16 v[158:159], v3 offset:2944
    s_waitcnt lgkmcnt(0)
    s_branch Ls2_70
Lslow_74:
    buffer_store_dwordx4 v[32:35], v1, s[36:39], s55 offen offset:0 sc1
    buffer_store_dwordx4 v[36:39], v1, s[36:39], s55 offen offset:1024 sc1
    s_branch Lback_75
Lslow_76:
    buffer_store_dword v11, v1, s[36:39], s56 offen sc1
    s_branch Lback_77
Lslow_78:
    buffer_store_dword v4, off, s[36:39], s77 offset:512 sc1
    s_branch Lback_79
Lspin_81:
    buffer_load_dword v9, v10, s[36:39], s55 offen sc1
    s_add_u32 s50, s50, 1
    s_cmp_gt_u32 s50, 0x40000
    s_cbranch_scc1 L_end
    s_waitcnt vmcnt(0)
    v_cmp_ne_u32 vcc, s47, v9
    s_cbranch_vccnz Lspin_81
    s_branch Lgot_82
Lslow_83:
    buffer_store_dwordx4 v[16:19], v1, s[36:39], s55 offen offset:0 sc1
    buffer_store_dwordx4 v[20:23], v1, s[36:39], s55 offen offset:1024 sc1
    s_branch Lback_84
Lslow_85:
    buffer_store_dwordx4 v[32:35], v1, s[36:39], s55 offen offset:0 sc1
    buffer_store_dwordx4 v[36:39], v1, s[36:39], s55 offen offset:1024 sc1
    s_branch Lback_86
Lslow_87:
    buffer_store_dword v4, off, s[36:39], s77 offset:1536 sc1
    s_branch Lback_88
Lslow_89:
    buffer_store_dwordx4 v[16:19], v1, s[36:39], s55 offen offset:0 sc1
    buffer_store_dwordx4 v[20:23], v1, s[36:39], s55 offen offset:1024 sc1
    s_branch Lback_90
Lslow_91:
    buffer_store_dword v4, off, s[36:39], s77 offset:2048 sc1
    s_branch Lback_92
Lspin_93:
    buffer_load_dword v9, v10, s[36:39], s82 offen sc1
    s_add_u32 s50, s50, 1
    s_cmp_gt_u32 s50, 0x40000
    s_cbranch_scc1 L_end
    s_waitcnt vmcnt(0)
    v_cmp_ne_u32 vcc, s47, v9
    s_cbranch_vccnz Lspin_93
    s_branch Lgot_94
Lslow_95:
    buffer_store_dwordx4 v[32:35], v1, s[36:39], s55 offen offset:0 sc1
    buffer_store_dwordx4 v[36:39], v1, s[36:39], s55 offen offset:1024 sc1
    s_branch Lback_96
Lslow_97:
    buffer_store_dword v4, off, s[36:39], s77 offset:2560 sc1
    s_branch Lback_98
Lspin_99:
    buffer_load_dword v9, v10, s[36:39], s83 offen sc1
    s_add_u32 s50, s50, 1
    s_cmp_gt_u32 s50, 0x40000
    s_cbranch_scc1 L_end
    s_waitcnt vmcnt(0)
    v_cmp_ne_u32 vcc, s47, v9
    s_cbranch_vccnz Lspin_99
    s_branch Lgot_100
Lslow_101:
    buffer_store_dword v4, off, s[36:39], s77 offset:3072 sc1
    s_branch Lback_102
L_code_end:
.section .rodata,"a"
.p2align 6
.amdhsa_kernel interleave_layers__linear_attn_block__mixer_channel_mlp__prompt_kernel
  .amdhsa_next_free_vgpr 512
  .amdhsa_next_free_sgpr 102
  .amdhsa_accum_offset 256
  .amdhsa_group_segment_fixed_size 0
  .amdhsa_kernarg_size 88
  .amdhsa_user_sgpr_count 2
  .amdhsa_user_sgpr_kernarg_segment_ptr 1
  .amdhsa_system_sgpr_workgroup_id_x 1
.end_amdhsa_kernel
```
